```python
import torch

def _softmax(x, axis=-1):
    return torch.softmax(x, dim=axis)
def _gelu(x):
    return torch.nn.functional.gelu(x, approximate="tanh")
def _silu(x):
    return torch.nn.functional.silu(x)
def _sigmoid(x):
    return torch.sigmoid(x)
def _layernorm(x, axis=-1, eps=1e-5):
    m = x.mean(dim=axis, keepdim=True)
    v = x.var(dim=axis, keepdim=True, unbiased=False)
    return (x - m) / torch.sqrt(v + eps)
def _scatter_add(tgt, idx, src, axis=0):
    return tgt.clone().index_add_(axis, idx, src)
def _segment_sum(src, seg, n):
    out = torch.zeros((n,) + src.shape[1:], dtype=src.dtype)
    return out.index_add_(0, seg, src)
def _pad(x, pw):
    flat = tuple(v for pair in reversed(pw) for v in pair)
    return torch.nn.functional.pad(x, flat)

kernel_name = 'standalone__gqa_softmax__near_ridge'

def setup_inputs():

    _w = (lambda a: (lambda t: t.to(torch.bfloat16) if t.is_floating_point() else t)(torch.as_tensor(a)))
    B, Hq, Hkv, Sq, Sk, D = 16, 32, 32, 384, 384, 128
    return {
        "q": _w((lambda *s: torch.randn(*s, dtype=torch.bfloat16) * 0.8)(B, Hq, Sq, D)),
        "k": _w((lambda *s: torch.randn(*s, dtype=torch.bfloat16) * 0.8)(B, Hkv, Sk, D)),
        "v": _w((lambda *s: torch.randn(*s, dtype=torch.bfloat16) * 0.05)(B, Hkv, Sk, D)),
    }

def reference(q, k, v):
    B, Hq, Sq, D = q.shape
    Hkv = k.shape[1]
    rep = Hq // Hkv
    k = (lambda x, n, axis: torch.repeat_interleave(x, n, dim=axis))(k, rep, axis=1)
    v = (lambda x, n, axis: torch.repeat_interleave(x, n, dim=axis))(v, rep, axis=1)
    scale = D ** -0.5
    scores = torch.einsum("bhqd,bhkd->bhqk", q, k) * scale
    p = _softmax(scores, axis=-1)
    return torch.einsum("bhqk,bhkd->bhqd", p, v)
```

```asm
; @launch grid=(256,1,1) block=(256,1,1) lds=149760
.amdgcn_target "amdgcn-amd-amdhsa--gfx950"
.text
.globl standalone__gqa_softmax__near_ridge_kernel
.p2align 8
.type standalone__gqa_softmax__near_ridge_kernel,@function
standalone__gqa_softmax__near_ridge_kernel:
    s_load_dwordx2 s[8:9], s[0:1], 8
    s_load_dwordx2 s[12:13], s[0:1], 16
    s_load_dwordx2 s[16:17], s[0:1], 0
    s_load_dwordx2 s[24:25], s[0:1], 24
    s_cmp_ge_u32 s2, 256
    s_cbranch_scc1 Lend
    v_lshrrev_b32 v1, 6, v0
    v_and_b32 v0, 63, v0
    v_readfirstlane_b32 s3, v1
    s_getpc_b64 s[62:63]
Lpc:
    v_min_u32 v2, 3, v0
    v_lshlrev_b32 v2, 7, v2
    global_load_dword v14, v2, s[62:63] offset:64
    s_lshr_b32 s4, s2, 3
    s_mul_i32 s4, s4, 1536
    s_add_u32 s4, s4, Lmain-Lpc
    v_min_u32 v1, 11, v0
    v_lshl_add_u32 v1, v1, 7, s4
    global_load_dword v15, v1, s[62:63]
    v_lshlrev_b32 v58, 4, v0
    v_add_u32 v57, 1056, v58
    s_mul_i32 s44, s2, 196608
    s_mov_b32 s10, 50332704
    s_mov_b32 s11, 0x20000
    s_mov_b32 s14, 50333728
    s_mov_b32 s15, s11
    s_mul_i32 s45, s3, 4160
    s_lshl_b32 s49, s3, 11
    s_add_u32 s40, s44, s49
    s_mov_b32 m0, s45
    s_waitcnt lgkmcnt(0)
    s_sub_u32 s8, s8, 1056
    s_subb_u32 s9, s9, 0
    buffer_load_dwordx4 v57, s[8:11], s40 offen nt lds
    buffer_load_dwordx4 v58, s[8:11], s40 offen offset:2080 nt lds
    s_sub_u32 s12, s12, 2080
    s_subb_u32 s13, s13, 0
    v_lshrrev_b32 v2, 4, v0
    v_lshlrev_b32 v4, 6, v2
    v_xor_b32 v60, v58, v4
    v_add_u32 v59, 1056, v60
    s_mul_i32 s50, s3, 24576
    s_add_u32 s55, s44, s50
    s_sub_u32 s20, s16, 32
    s_subb_u32 s21, s17, 0
    s_sub_u32 s16, s16, 1056
    s_subb_u32 s17, s17, 0
    s_add_u32 m0, s45, 33280
    s_mov_b64 s[18:19], s[10:11]
    s_mov_b32 s22, 50331680
    s_mov_b32 s23, s11
    buffer_load_dwordx4 v59, s[16:19], s55 offen nt lds
    buffer_load_dwordx4 v59, s[20:23], s55 offen offset:1024 nt lds
    buffer_load_dwordx4 v60, s[16:19], s55 offen offset:2080 nt lds
    buffer_load_dwordx4 v60, s[20:23], s55 offen offset:3104 nt lds
    s_add_u32 m0, s45, 16640
    s_add_u32 s4, s40, 8192
    buffer_load_dwordx4 v57, s[8:11], s4 offen nt lds
    buffer_load_dwordx4 v58, s[8:11], s4 offen offset:2080 nt lds
    s_mov_b32 m0, s45
    s_nop 0
    buffer_load_dwordx4 v57, s[12:15], s40 offen offset:1024 nt lds
    buffer_load_dwordx4 v58, s[12:15], s40 offen offset:3104 nt lds
    s_add_u32 m0, s45, 16640
    s_add_u32 s40, s40, 8192
    buffer_load_dwordx4 v57, s[12:15], s40 offen offset:1024 nt lds
    buffer_load_dwordx4 v58, s[12:15], s40 offen offset:3104 nt lds
    s_branch Lmain
.p2align 12
Lmain:
    s_mov_b32 s26, 50331648
    s_mov_b32 s27, 0x20000
    s_add_u32 s59, s44, 98304
    s_mov_b32 s43, 0x3e0293ee
    s_mov_b32 s58, 0xbe0293ee
    s_mov_b32 s51, 0xf800000
    s_add_u32 s48, s45, 149760
    s_mov_b32 s46, 0
    s_mov_b64 s[52:53], 0
    s_mov_b64 s[96:97], 0
    s_add_u32 s93, s45, 133120
    s_xor_b32 s93, s93, s45
    s_add_u32 s94, s45, 16640
    s_add_u32 s4, s45, 33280
    s_xor_b32 s94, s94, s4
    v_and_b32 v3, 7, v0
    v_mul_u32_u24 v48, 2080, v3
    v_bfe_u32 v3, v0, 3, 1
    v_lshl_add_u32 v48, v3, 8, v48
    v_lshl_add_u32 v48, v2, 4, v48
    v_subrev_u32 v48, s45, v48
    v_bfe_u32 v3, v0, 2, 3
    v_mul_u32_u24 v49, 2080, v3
    v_lshrrev_b32 v3, 5, v0
    v_lshl_add_u32 v49, v3, 8, v49
    v_and_b32 v4, 3, v0
    v_lshl_add_u32 v49, v4, 3, v49
    v_add_u32 v49, 1024, v49
    v_subrev_u32 v49, s45, v49
    v_mov_b32 v11, 0x3f803f80
    v_cmp_eq_u32 vcc, 0, v4
    v_and_b32 v4, 3, v0
    v_bfe_u32 v3, v0, 2, 1
    v_mul_u32_u24 v9, 2080, v3
    v_bfe_u32 v3, v0, 3, 1
    v_lshl_add_u32 v9, v3, 10, v9
    v_lshl_add_u32 v9, v4, 8, v9
    v_lshl_add_u32 v9, v2, 4, v9
    v_add_u32 v9, s4, v9
    v_xor_b32 v3, 0, v4
    v_lshl_add_u32 v52, v3, 6, v9
    v_xor_b32 v3, 1, v4
    v_lshl_add_u32 v53, v3, 6, v9
    v_xor_b32 v3, 2, v4
    v_lshl_add_u32 v54, v3, 6, v9
    v_xor_b32 v3, 3, v4
    v_lshl_add_u32 v55, v3, 6, v9
    v_and_b32 v8, 15, v0
    v_xor_b32 v9, v8, v2
    v_lshlrev_b32 v10, 8, v2
    v_add_u32 v10, s4, v10
    v_lshl_add_u32 v56, v9, 4, v10
    v_xor_b32 v9, 4, v9
    v_lshl_add_u32 v63, v9, 4, v10
    v_lshlrev_b32 v10, 8, v8
    v_and_b32 v9, 1, v2
    v_lshl_add_u32 v10, v9, 3, v10
    v_add_u32 v10, s4, v10
    v_lshrrev_b32 v9, 1, v2
    v_and_b32 v8, 7, v0
    v_xor_b32 v9, v9, v8
    v_xor_b32 v8, 0, v9
    v_lshl_add_u32 v5, v8, 4, v10
    v_xor_b32 v8, 2, v9
    v_lshl_add_u32 v6, v8, 4, v10
    v_xor_b32 v8, 4, v9
    v_lshl_add_u32 v7, v8, 4, v10
    v_xor_b32 v8, 6, v9
    v_lshl_add_u32 v62, v8, 4, v10
    v_cndmask_b32 v11, 0, v11, vcc
    v_accvgpr_write_b32 a248, v11
    v_accvgpr_write_b32 a249, v11
    v_accvgpr_write_b32 a250, v11
    v_accvgpr_write_b32 a251, v11
    v_mov_b32 v0, 0
    v_mov_b32 v61, 0
    s_add_u32 m0, s45, 49920
    s_add_u32 s55, s55, 4096
    buffer_load_dwordx4 v59, s[16:19], s55 offen nt lds
    buffer_load_dwordx4 v59, s[20:23], s55 offen offset:1024 nt lds
    buffer_load_dwordx4 v60, s[16:19], s55 offen offset:2080 nt lds
    buffer_load_dwordx4 v60, s[20:23], s55 offen offset:3104 nt lds
    s_add_u32 m0, s45, 66560
    s_add_u32 s55, s55, 4096
    buffer_load_dwordx4 v59, s[16:19], s55 offen nt lds
    buffer_load_dwordx4 v59, s[20:23], s55 offen offset:1024 nt lds
    buffer_load_dwordx4 v60, s[16:19], s55 offen offset:2080 nt lds
    buffer_load_dwordx4 v60, s[20:23], s55 offen offset:3104 nt lds
    v_add_u32 v46, s45, v48
    v_add_u32 v47, s45, v49
    s_waitcnt vmcnt(14)
    s_barrier
    ds_read_b128 a[0:3], v52
    ds_read_b128 a[4:7], v53
    ds_read_b128 a[8:11], v54
    ds_read_b128 a[12:15], v55
    ds_read_b128 a[96:99], v46
    ds_read_b128 a[100:103], v46 offset:64
    ds_read_b128 a[104:107], v46 offset:128
    ds_read_b128 a[108:111], v46 offset:192
    ds_read_b128 a[112:115], v46 offset:512
    ds_read_b128 a[116:119], v46 offset:576
    ds_read_b128 a[120:123], v46 offset:640
    ds_read_b128 a[124:127], v46 offset:704
    s_waitcnt lgkmcnt(7)
    v_mfma_f32_16x16x32_bf16 v[16:19], a[96:99], a[0:3], 0
    s_waitcnt lgkmcnt(6)
    v_mfma_f32_16x16x32_bf16 v[16:19], a[100:103], a[4:7], v[16:19]
    s_waitcnt lgkmcnt(5)
    v_mfma_f32_16x16x32_bf16 v[16:19], a[104:107], a[8:11], v[16:19]
    s_waitcnt lgkmcnt(4)
    v_mfma_f32_16x16x32_bf16 v[16:19], a[108:111], a[12:15], v[16:19]
    s_waitcnt lgkmcnt(3)
    v_mfma_f32_16x16x32_bf16 v[20:23], a[112:115], a[0:3], 0
    s_waitcnt lgkmcnt(2)
    v_mfma_f32_16x16x32_bf16 v[20:23], a[116:119], a[4:7], v[20:23]
    s_waitcnt lgkmcnt(1)
    v_mfma_f32_16x16x32_bf16 v[20:23], a[120:123], a[8:11], v[20:23]
    s_waitcnt lgkmcnt(0)
    v_mfma_f32_16x16x32_bf16 v[20:23], a[124:127], a[12:15], v[20:23]
    s_add_u32 m0, s45, 83200
    s_add_u32 s55, s55, 4096
    buffer_load_dwordx4 v59, s[16:19], s55 offen nt lds
    buffer_load_dwordx4 v59, s[20:23], s55 offen offset:1024 nt lds
    s_waitcnt vmcnt(14)
    s_barrier
    ds_read_b128 a[128:131], v46 offset:16640
    ds_read_b128 a[132:135], v46 offset:16704
    ds_read_b128 a[136:139], v46 offset:16768
    ds_read_b128 a[140:143], v46 offset:16832
    ds_read_b128 a[144:147], v46 offset:17152
    ds_read_b128 a[148:151], v46 offset:17216
    ds_read_b128 a[152:155], v46 offset:17280
    ds_read_b128 a[156:159], v46 offset:17344
    v_max3_f32 v1, v16, v17, v18
    v_max3_f32 v4, v19, v20, v21
    v_max3_f32 v1, v1, v22, v23
    v_max_f32 v1, v1, v4
    v_mov_b32 v4, v1
    s_nop 1
    v_permlane16_swap_b32 v1, v4
    v_max_f32 v1, v1, v4
    v_mov_b32 v4, v1
    s_nop 1
    v_permlane32_swap_b32 v1, v4
    v_max_f32 v1, v1, v4
    v_mul_f32 v40, s58, v1
    s_waitcnt lgkmcnt(0)
    s_mov_b64 exec, 0
    s_branch Lpad1
Lret1:
    s_mov_b64 exec, -1
    s_mov_b64 exec, 0
    s_branch Lpad2
Lret2:
    s_mov_b64 exec, -1
    v_mfma_f32_16x16x32_bf16 v[24:27], a[128:131], a[0:3], 0
    v_fma_f32 v16, v16, s43, v40
    v_fma_f32 v17, v17, s43, v40
    v_mfma_f32_16x16x32_bf16 v[24:27], a[132:135], a[4:7], v[24:27]
    v_exp_f32 v16, v16
    v_mfma_f32_16x16x32_bf16 v[24:27], a[136:139], a[8:11], v[24:27]
    v_exp_f32 v17, v17
    v_mfma_f32_16x16x32_bf16 v[24:27], a[140:143], a[12:15], v[24:27]
    v_fma_f32 v18, v18, s43, v40
    v_fma_f32 v19, v19, s43, v40
    v_mfma_f32_16x16x32_bf16 v[28:31], a[144:147], a[0:3], 0
    v_exp_f32 v18, v18
    v_mfma_f32_16x16x32_bf16 v[28:31], a[148:151], a[4:7], v[28:31]
    v_mfma_f32_16x16x32_bf16 v[28:31], a[152:155], a[8:11], v[28:31]
    v_exp_f32 v19, v19
    v_mfma_f32_16x16x32_bf16 v[28:31], a[156:159], a[12:15], v[28:31]
    v_fma_f32 v20, v20, s43, v40
    v_fma_f32 v21, v21, s43, v40
    buffer_load_dwordx4 v60, s[16:19], s55 offen offset:2080 nt lds
    buffer_load_dwordx4 v60, s[20:23], s55 offen offset:3104 nt lds
    v_exp_f32 v20, v20
    s_waitcnt vmcnt(12)
    s_barrier
    ds_read_b64_tr_b16 a[160:161], v47
    ds_read_b64_tr_b16 a[162:163], v47 offset:512
    ds_read_b64_tr_b16 a[164:165], v47 offset:32
    ds_read_b64_tr_b16 a[166:167], v47 offset:544
    ds_read_b64_tr_b16 a[168:169], v47 offset:64
    ds_read_b64_tr_b16 a[170:171], v47 offset:576
    ds_read_b64_tr_b16 a[172:173], v47 offset:96
    ds_read_b64_tr_b16 a[174:175], v47 offset:608
    ds_read_b64_tr_b16 a[176:177], v47 offset:128
    ds_read_b64_tr_b16 a[178:179], v47 offset:640
    ds_read_b64_tr_b16 a[180:181], v47 offset:160
    ds_read_b64_tr_b16 a[182:183], v47 offset:672
    ds_read_b64_tr_b16 a[184:185], v47 offset:192
    ds_read_b64_tr_b16 a[186:187], v47 offset:704
    ds_read_b64_tr_b16 a[188:189], v47 offset:224
    ds_read_b64_tr_b16 a[190:191], v47 offset:736
    v_exp_f32 v21, v21
    s_mov_b64 exec, 0
    s_branch Lpad3
Lret3:
    s_mov_b64 exec, -1
    s_waitcnt vmcnt(8)
    v_fma_f32 v22, v22, s43, v40
    v_fma_f32 v23, v23, s43, v40
    ds_read_b128 a[16:19], v52 offset:16640
    ds_read_b128 a[20:23], v53 offset:16640
    ds_read_b128 a[24:27], v54 offset:16640
    v_exp_f32 v22, v22
    ds_read_b128 a[28:31], v55 offset:16640
    v_exp_f32 v23, v23
    v_cvt_pk_bf16_f32 v32, v16, v17
    v_cvt_pk_bf16_f32 v33, v18, v19
    v_cvt_pk_bf16_f32 v34, v20, v21
    v_cvt_pk_bf16_f32 v35, v22, v23
    s_waitcnt lgkmcnt(0)
    v_mfma_f32_16x16x32_bf16 v[16:19], a[96:99], a[16:19], 0
    ds_read_b64_tr_b16 a[192:193], v47 offset:16640
    ds_read_b64_tr_b16 a[194:195], v47 offset:17152
    v_fma_f32 v24, v24, s43, v40
    v_fma_f32 v25, v25, s43, v40
    v_mfma_f32_16x16x32_bf16 v[16:19], a[100:103], a[20:23], v[16:19]
    ds_read_b64_tr_b16 a[196:197], v47 offset:16672
    ds_read_b64_tr_b16 a[198:199], v47 offset:17184
    v_exp_f32 v24, v24
    v_mfma_f32_16x16x32_bf16 v[16:19], a[104:107], a[24:27], v[16:19]
    ds_read_b64_tr_b16 a[200:201], v47 offset:16704
    ds_read_b64_tr_b16 a[202:203], v47 offset:17216
    v_exp_f32 v25, v25
    v_mfma_f32_16x16x32_bf16 v[16:19], a[108:111], a[28:31], v[16:19]
    ds_read_b64_tr_b16 a[204:205], v47 offset:16736
    ds_read_b64_tr_b16 a[206:207], v47 offset:17248
    v_fma_f32 v26, v26, s43, v40
    v_fma_f32 v27, v27, s43, v40
    v_mfma_f32_16x16x32_bf16 v[20:23], a[112:115], a[16:19], 0
    ds_read_b64_tr_b16 a[208:209], v47 offset:16768
    ds_read_b64_tr_b16 a[210:211], v47 offset:17280
    v_exp_f32 v26, v26
    v_mfma_f32_16x16x32_bf16 v[20:23], a[116:119], a[20:23], v[20:23]
    ds_read_b64_tr_b16 a[212:213], v47 offset:16800
    ds_read_b64_tr_b16 a[214:215], v47 offset:17312
    s_add_u32 m0, s45, 99840
    s_add_u32 s55, s55, 4096
    buffer_load_dwordx4 v59, s[16:19], s55 offen nt lds
    v_mfma_f32_16x16x32_bf16 v[20:23], a[120:123], a[24:27], v[20:23]
    ds_read_b64_tr_b16 a[216:217], v47 offset:16832
    ds_read_b64_tr_b16 a[218:219], v47 offset:17344
    v_exp_f32 v27, v27
    v_mfma_f32_16x16x32_bf16 v[20:23], a[124:127], a[28:31], v[20:23]
    ds_read_b64_tr_b16 a[220:221], v47 offset:16864
    ds_read_b64_tr_b16 a[222:223], v47 offset:17376
    v_fma_f32 v28, v28, s43, v40
    v_fma_f32 v29, v29, s43, v40
    v_mfma_f32_16x16x32_bf16 v[64:67], a[160:163], v[32:35], 0
    v_exp_f32 v28, v28
    v_mfma_f32_16x16x32_bf16 v[68:71], a[164:167], v[32:35], 0
    v_exp_f32 v29, v29
    v_mfma_f32_16x16x32_bf16 v[72:75], a[168:171], v[32:35], 0
    buffer_load_dwordx4 v59, s[20:23], s55 offen offset:1024 nt lds
    v_fma_f32 v30, v30, s43, v40
    v_fma_f32 v31, v31, s43, v40
    v_mfma_f32_16x16x32_bf16 v[76:79], a[172:175], v[32:35], 0
    v_mfma_f32_16x16x32_bf16 v[80:83], a[176:179], v[32:35], 0
    v_exp_f32 v30, v30
    v_mfma_f32_16x16x32_bf16 v[84:87], a[180:183], v[32:35], 0
    v_exp_f32 v31, v31
    v_mfma_f32_16x16x32_bf16 v[88:91], a[184:187], v[32:35], 0
    v_cvt_pk_bf16_f32 v36, v24, v25
    v_cvt_pk_bf16_f32 v37, v26, v27
    v_mfma_f32_16x16x32_bf16 v[92:95], a[188:191], v[32:35], 0
    v_cvt_pk_bf16_f32 v38, v28, v29
    v_cvt_pk_bf16_f32 v39, v30, v31
    v_mfma_f32_16x16x32_bf16 a[224:227], a[248:251], v[32:35], 0
    v_max3_f32 v1, v16, v17, v18
    v_max3_f32 v4, v19, v20, v21
    v_max3_f32 v1, v1, v22, v23
    v_max_f32 v1, v1, v4
    v_mov_b32 v4, v1
    s_nop 1
    v_permlane16_swap_b32 v1, v4
    v_max_f32 v1, v1, v4
    v_mov_b32 v4, v1
    s_nop 1
    v_permlane32_swap_b32 v1, v4
    v_max_f32 v1, v1, v4
    v_mul_f32 v41, s58, v1
    s_mov_b64 exec, 0
    s_branch Lpad4
Lret4:
    s_mov_b64 exec, -1
    v_mfma_f32_16x16x32_bf16 v[24:27], a[128:131], a[16:19], 0
    v_fma_f32 v16, v16, s43, v41
    v_fma_f32 v17, v17, s43, v41
    v_mfma_f32_16x16x32_bf16 v[24:27], a[132:135], a[20:23], v[24:27]
    v_exp_f32 v16, v16
    v_mfma_f32_16x16x32_bf16 v[24:27], a[136:139], a[24:27], v[24:27]
    buffer_load_dwordx4 v60, s[16:19], s55 offen offset:2080 nt lds
    v_exp_f32 v17, v17
    v_mfma_f32_16x16x32_bf16 v[24:27], a[140:143], a[28:31], v[24:27]
    v_fma_f32 v18, v18, s43, v41
    v_fma_f32 v19, v19, s43, v41
    v_mfma_f32_16x16x32_bf16 v[28:31], a[144:147], a[16:19], 0
    v_exp_f32 v18, v18
    v_mfma_f32_16x16x32_bf16 v[28:31], a[148:151], a[20:23], v[28:31]
    buffer_load_dwordx4 v60, s[20:23], s55 offen offset:3104 nt lds
    v_mfma_f32_16x16x32_bf16 v[28:31], a[152:155], a[24:27], v[28:31]
    v_exp_f32 v19, v19
    v_mfma_f32_16x16x32_bf16 v[28:31], a[156:159], a[28:31], v[28:31]
    s_waitcnt lgkmcnt(0)
    v_fma_f32 v20, v20, s43, v41
    v_fma_f32 v21, v21, s43, v41
    v_mfma_f32_16x16x32_bf16 v[64:67], a[192:195], v[36:39], v[64:67]
    v_exp_f32 v20, v20
    v_mfma_f32_16x16x32_bf16 v[68:71], a[196:199], v[36:39], v[68:71]
    v_exp_f32 v21, v21
    v_mfma_f32_16x16x32_bf16 v[72:75], a[200:203], v[36:39], v[72:75]
    s_mov_b64 exec, 0
    s_branch Lpad5
Lret5:
    s_mov_b64 exec, -1
    s_waitcnt vmcnt(8)
    v_fma_f32 v22, v22, s43, v41
    v_fma_f32 v23, v23, s43, v41
    v_mfma_f32_16x16x32_bf16 v[76:79], a[204:207], v[36:39], v[76:79]
    ds_read_b128 a[32:35], v52 offset:33280
    ds_read_b128 a[36:39], v53 offset:33280
    v_mfma_f32_16x16x32_bf16 v[80:83], a[208:211], v[36:39], v[80:83]
    ds_read_b128 a[40:43], v54 offset:33280
    v_exp_f32 v22, v22
    v_mfma_f32_16x16x32_bf16 v[84:87], a[212:215], v[36:39], v[84:87]
    ds_read_b128 a[44:47], v55 offset:33280
    v_exp_f32 v23, v23
    v_mfma_f32_16x16x32_bf16 v[88:91], a[216:219], v[36:39], v[88:91]
    v_cvt_pk_bf16_f32 v32, v16, v17
    v_cvt_pk_bf16_f32 v33, v18, v19
    v_mfma_f32_16x16x32_bf16 v[92:95], a[220:223], v[36:39], v[92:95]
    v_cvt_pk_bf16_f32 v34, v20, v21
    v_cvt_pk_bf16_f32 v35, v22, v23
    v_mfma_f32_16x16x32_bf16 a[224:227], a[248:251], v[36:39], a[224:227]
    s_waitcnt lgkmcnt(0)
    v_mfma_f32_16x16x32_bf16 v[16:19], a[96:99], a[32:35], 0
    s_waitcnt lgkmcnt(0)
    v_fma_f32 v24, v24, s43, v41
    v_fma_f32 v25, v25, s43, v41
    v_mfma_f32_16x16x32_bf16 v[16:19], a[100:103], a[36:39], v[16:19]
    s_barrier
    v_exp_f32 v24, v24
    v_mfma_f32_16x16x32_bf16 v[16:19], a[104:107], a[40:43], v[16:19]
    v_exp_f32 v25, v25
    v_mfma_f32_16x16x32_bf16 v[16:19], a[108:111], a[44:47], v[16:19]
    v_fma_f32 v26, v26, s43, v41
    v_fma_f32 v27, v27, s43, v41
    v_mfma_f32_16x16x32_bf16 v[20:23], a[112:115], a[32:35], 0
    v_exp_f32 v26, v26
    v_mfma_f32_16x16x32_bf16 v[20:23], a[116:119], a[36:39], v[20:23]
    s_add_u32 m0, s45, 116480
    s_add_u32 s55, s55, 4096
    buffer_load_dwordx4 v59, s[16:19], s55 offen nt lds
    v_mfma_f32_16x16x32_bf16 v[20:23], a[120:123], a[40:43], v[20:23]
    v_exp_f32 v27, v27
    v_mfma_f32_16x16x32_bf16 v[20:23], a[124:127], a[44:47], v[20:23]
    v_fma_f32 v28, v28, s43, v41
    v_fma_f32 v29, v29, s43, v41
    v_mfma_f32_16x16x32_bf16 v[96:99], a[160:163], v[32:35], 0
    v_exp_f32 v28, v28
    v_mfma_f32_16x16x32_bf16 v[100:103], a[164:167], v[32:35], 0
    v_exp_f32 v29, v29
    v_mfma_f32_16x16x32_bf16 v[104:107], a[168:171], v[32:35], 0
    buffer_load_dwordx4 v59, s[20:23], s55 offen offset:1024 nt lds
    v_fma_f32 v30, v30, s43, v41
    v_fma_f32 v31, v31, s43, v41
    v_mfma_f32_16x16x32_bf16 v[108:111], a[172:175], v[32:35], 0
    v_mfma_f32_16x16x32_bf16 v[112:115], a[176:179], v[32:35], 0
    v_exp_f32 v30, v30
    v_mfma_f32_16x16x32_bf16 v[116:119], a[180:183], v[32:35], 0
    v_exp_f32 v31, v31
    v_mfma_f32_16x16x32_bf16 v[120:123], a[184:187], v[32:35], 0
    v_cvt_pk_bf16_f32 v36, v24, v25
    v_cvt_pk_bf16_f32 v37, v26, v27
    v_mfma_f32_16x16x32_bf16 v[124:127], a[188:191], v[32:35], 0
    v_cvt_pk_bf16_f32 v38, v28, v29
    v_cvt_pk_bf16_f32 v39, v30, v31
    v_mfma_f32_16x16x32_bf16 a[228:231], a[248:251], v[32:35], 0
    v_max3_f32 v1, v16, v17, v18
    v_max3_f32 v4, v19, v20, v21
    v_max3_f32 v1, v1, v22, v23
    v_max_f32 v1, v1, v4
    v_mov_b32 v4, v1
    s_nop 1
    v_permlane16_swap_b32 v1, v4
    v_max_f32 v1, v1, v4
    v_mov_b32 v4, v1
    s_nop 1
    v_permlane32_swap_b32 v1, v4
    v_max_f32 v1, v1, v4
    v_mul_f32 v42, s58, v1
    s_mov_b64 exec, 0
    s_branch Lpad6
Lret6:
    s_mov_b64 exec, -1
    v_mfma_f32_16x16x32_bf16 v[24:27], a[128:131], a[32:35], 0
    v_fma_f32 v16, v16, s43, v42
    v_fma_f32 v17, v17, s43, v42
    v_mfma_f32_16x16x32_bf16 v[24:27], a[132:135], a[36:39], v[24:27]
    v_exp_f32 v16, v16
    v_mfma_f32_16x16x32_bf16 v[24:27], a[136:139], a[40:43], v[24:27]
    buffer_load_dwordx4 v60, s[16:19], s55 offen offset:2080 nt lds
    v_exp_f32 v17, v17
    v_mfma_f32_16x16x32_bf16 v[24:27], a[140:143], a[44:47], v[24:27]
    v_fma_f32 v18, v18, s43, v42
    v_fma_f32 v19, v19, s43, v42
    v_mfma_f32_16x16x32_bf16 v[28:31], a[144:147], a[32:35], 0
    v_exp_f32 v18, v18
    v_mfma_f32_16x16x32_bf16 v[28:31], a[148:151], a[36:39], v[28:31]
    buffer_load_dwordx4 v60, s[20:23], s55 offen offset:3104 nt lds
    v_mfma_f32_16x16x32_bf16 v[28:31], a[152:155], a[40:43], v[28:31]
    v_exp_f32 v19, v19
    v_mfma_f32_16x16x32_bf16 v[28:31], a[156:159], a[44:47], v[28:31]
    v_fma_f32 v20, v20, s43, v42
    v_fma_f32 v21, v21, s43, v42
    v_mfma_f32_16x16x32_bf16 v[96:99], a[192:195], v[36:39], v[96:99]
    v_exp_f32 v20, v20
    v_mfma_f32_16x16x32_bf16 v[100:103], a[196:199], v[36:39], v[100:103]
    v_exp_f32 v21, v21
    v_mfma_f32_16x16x32_bf16 v[104:107], a[200:203], v[36:39], v[104:107]
    s_mov_b64 exec, 0
    s_branch Lpad7
Lret7:
    s_mov_b64 exec, -1
    s_waitcnt vmcnt(8)
    v_fma_f32 v22, v22, s43, v42
    v_fma_f32 v23, v23, s43, v42
    v_mfma_f32_16x16x32_bf16 v[108:111], a[204:207], v[36:39], v[108:111]
    ds_read_b128 a[48:51], v52 offset:49920
    ds_read_b128 a[52:55], v53 offset:49920
    v_mfma_f32_16x16x32_bf16 v[112:115], a[208:211], v[36:39], v[112:115]
    ds_read_b128 a[56:59], v54 offset:49920
    v_exp_f32 v22, v22
    v_mfma_f32_16x16x32_bf16 v[116:119], a[212:215], v[36:39], v[116:119]
    ds_read_b128 a[60:63], v55 offset:49920
    v_exp_f32 v23, v23
    v_mfma_f32_16x16x32_bf16 v[120:123], a[216:219], v[36:39], v[120:123]
    v_cvt_pk_bf16_f32 v32, v16, v17
    v_cvt_pk_bf16_f32 v33, v18, v19
    v_mfma_f32_16x16x32_bf16 v[124:127], a[220:223], v[36:39], v[124:127]
    v_cvt_pk_bf16_f32 v34, v20, v21
    v_cvt_pk_bf16_f32 v35, v22, v23
    v_mfma_f32_16x16x32_bf16 a[228:231], a[248:251], v[36:39], a[228:231]
    s_waitcnt lgkmcnt(0)
    v_mfma_f32_16x16x32_bf16 v[16:19], a[96:99], a[48:51], 0
    v_fma_f32 v24, v24, s43, v42
    v_fma_f32 v25, v25, s43, v42
    v_exp_f32 v24, v24
    v_exp_f32 v25, v25
    v_mfma_f32_16x16x32_bf16 v[16:19], a[100:103], a[52:55], v[16:19]
    v_mfma_f32_16x16x32_bf16 v[16:19], a[104:107], a[56:59], v[16:19]
    v_mfma_f32_16x16x32_bf16 v[16:19], a[108:111], a[60:63], v[16:19]
    v_fma_f32 v26, v26, s43, v42
    v_fma_f32 v27, v27, s43, v42
    v_exp_f32 v26, v26
    v_mfma_f32_16x16x32_bf16 v[20:23], a[112:115], a[48:51], 0
    v_mfma_f32_16x16x32_bf16 v[20:23], a[116:119], a[52:55], v[20:23]
    s_add_u32 m0, s45, 133120
    s_add_u32 s40, s40, 8192
    buffer_load_dwordx4 v57, s[8:11], s40 offen nt lds
    v_mfma_f32_16x16x32_bf16 v[20:23], a[120:123], a[56:59], v[20:23]
    v_exp_f32 v27, v27
    v_fma_f32 v28, v28, s43, v42
    v_fma_f32 v29, v29, s43, v42
    v_mfma_f32_16x16x32_bf16 v[20:23], a[124:127], a[60:63], v[20:23]
    v_mfma_f32_16x16x32_bf16 v[128:131], a[160:163], v[32:35], 0
    v_exp_f32 v28, v28
    v_exp_f32 v29, v29
    v_mfma_f32_16x16x32_bf16 v[132:135], a[164:167], v[32:35], 0
    v_mfma_f32_16x16x32_bf16 v[136:139], a[168:171], v[32:35], 0
    buffer_load_dwordx4 v58, s[8:11], s40 offen offset:2080 nt lds
    v_fma_f32 v30, v30, s43, v42
    v_fma_f32 v31, v31, s43, v42
    v_mfma_f32_16x16x32_bf16 v[140:143], a[172:175], v[32:35], 0
    v_mfma_f32_16x16x32_bf16 v[144:147], a[176:179], v[32:35], 0
    v_exp_f32 v30, v30
    v_exp_f32 v31, v31
    v_mfma_f32_16x16x32_bf16 v[148:151], a[180:183], v[32:35], 0
    v_mfma_f32_16x16x32_bf16 v[152:155], a[184:187], v[32:35], 0
    v_cvt_pk_bf16_f32 v36, v24, v25
    v_cvt_pk_bf16_f32 v37, v26, v27
    v_cvt_pk_bf16_f32 v38, v28, v29
    v_cvt_pk_bf16_f32 v39, v30, v31
    v_mfma_f32_16x16x32_bf16 v[156:159], a[188:191], v[32:35], 0
    v_mfma_f32_16x16x32_bf16 a[232:235], a[248:251], v[32:35], 0
    v_max3_f32 v1, v16, v17, v18
    v_max3_f32 v4, v19, v20, v21
    v_max3_f32 v1, v1, v22, v23
    v_max_f32 v1, v1, v4
    v_mov_b32 v4, v1
    s_nop 1
    v_permlane16_swap_b32 v1, v4
    v_max_f32 v1, v1, v4
    v_mov_b32 v4, v1
    s_nop 1
    v_permlane32_swap_b32 v1, v4
    v_max_f32 v1, v1, v4
    v_mul_f32 v43, s58, v1
    s_mov_b64 exec, 0
    s_branch Lpad8
Lret8:
    s_mov_b64 exec, -1
    v_mfma_f32_16x16x32_bf16 v[24:27], a[128:131], a[48:51], 0
    v_fma_f32 v16, v16, s43, v43
    v_fma_f32 v17, v17, s43, v43
    v_exp_f32 v16, v16
    v_exp_f32 v17, v17
    v_mfma_f32_16x16x32_bf16 v[24:27], a[132:135], a[52:55], v[24:27]
    v_mfma_f32_16x16x32_bf16 v[24:27], a[136:139], a[56:59], v[24:27]
    buffer_load_dwordx4 v57, s[12:15], s40 offen offset:1024 nt lds
    v_mfma_f32_16x16x32_bf16 v[24:27], a[140:143], a[60:63], v[24:27]
    v_fma_f32 v18, v18, s43, v43
    v_fma_f32 v19, v19, s43, v43
    v_exp_f32 v18, v18
    v_mfma_f32_16x16x32_bf16 v[28:31], a[144:147], a[48:51], 0
    v_mfma_f32_16x16x32_bf16 v[28:31], a[148:151], a[52:55], v[28:31]
    buffer_load_dwordx4 v58, s[12:15], s40 offen offset:3104 nt lds
    v_mfma_f32_16x16x32_bf16 v[28:31], a[152:155], a[56:59], v[28:31]
    v_exp_f32 v19, v19
    v_fma_f32 v20, v20, s43, v43
    v_fma_f32 v21, v21, s43, v43
    v_mfma_f32_16x16x32_bf16 v[28:31], a[156:159], a[60:63], v[28:31]
    v_mfma_f32_16x16x32_bf16 v[128:131], a[192:195], v[36:39], v[128:131]
    v_exp_f32 v20, v20
    v_exp_f32 v21, v21
    v_mfma_f32_16x16x32_bf16 v[132:135], a[196:199], v[36:39], v[132:135]
    v_add_u32 v52, 66560, v52
    v_add_u32 v53, 66560, v53
    v_add_u32 v54, 66560, v54
    v_add_u32 v55, 66560, v55
    v_mfma_f32_16x16x32_bf16 v[136:139], a[200:203], v[36:39], v[136:139]
    s_mov_b64 exec, 0
    s_branch Lpad9
Lret9:
    s_mov_b64 exec, -1
    s_waitcnt vmcnt(8)
    v_fma_f32 v22, v22, s43, v43
    v_fma_f32 v23, v23, s43, v43
    v_mfma_f32_16x16x32_bf16 v[140:143], a[204:207], v[36:39], v[140:143]
    ds_read_b128 a[64:67], v52
    ds_read_b128 a[68:71], v53
    v_mfma_f32_16x16x32_bf16 v[144:147], a[208:211], v[36:39], v[144:147]
    ds_read_b128 a[72:75], v54
    v_exp_f32 v22, v22
    v_exp_f32 v23, v23
    v_mfma_f32_16x16x32_bf16 v[148:151], a[212:215], v[36:39], v[148:151]
    ds_read_b128 a[76:79], v55
    v_mfma_f32_16x16x32_bf16 v[152:155], a[216:219], v[36:39], v[152:155]
    v_cvt_pk_bf16_f32 v32, v16, v17
    v_cvt_pk_bf16_f32 v33, v18, v19
    v_cvt_pk_bf16_f32 v34, v20, v21
    v_cvt_pk_bf16_f32 v35, v22, v23
    v_mfma_f32_16x16x32_bf16 v[156:159], a[220:223], v[36:39], v[156:159]
    v_mfma_f32_16x16x32_bf16 a[232:235], a[248:251], v[36:39], a[232:235]
    s_waitcnt lgkmcnt(0)
    v_mfma_f32_16x16x32_bf16 v[16:19], a[96:99], a[64:67], 0
    v_fma_f32 v24, v24, s43, v43
    v_fma_f32 v25, v25, s43, v43
    v_exp_f32 v24, v24
    v_exp_f32 v25, v25
    v_mfma_f32_16x16x32_bf16 v[16:19], a[100:103], a[68:71], v[16:19]
    v_mfma_f32_16x16x32_bf16 v[16:19], a[104:107], a[72:75], v[16:19]
    v_mfma_f32_16x16x32_bf16 v[16:19], a[108:111], a[76:79], v[16:19]
    v_fma_f32 v26, v26, s43, v43
    v_fma_f32 v27, v27, s43, v43
    v_exp_f32 v26, v26
    v_mfma_f32_16x16x32_bf16 v[20:23], a[112:115], a[64:67], 0
    v_mfma_f32_16x16x32_bf16 v[20:23], a[116:119], a[68:71], v[20:23]
    s_mov_b32 m0, s45
    s_add_u32 s40, s40, 8192
    buffer_load_dwordx4 v57, s[8:11], s40 offen nt lds
    v_mfma_f32_16x16x32_bf16 v[20:23], a[120:123], a[72:75], v[20:23]
    v_exp_f32 v27, v27
    v_fma_f32 v28, v28, s43, v43
    v_fma_f32 v29, v29, s43, v43
    v_mfma_f32_16x16x32_bf16 v[20:23], a[124:127], a[76:79], v[20:23]
    v_mfma_f32_16x16x32_bf16 v[160:163], a[160:163], v[32:35], 0
    v_exp_f32 v28, v28
    v_exp_f32 v29, v29
    v_mfma_f32_16x16x32_bf16 v[164:167], a[164:167], v[32:35], 0
    v_mfma_f32_16x16x32_bf16 v[168:171], a[168:171], v[32:35], 0
    buffer_load_dwordx4 v58, s[8:11], s40 offen offset:2080 nt lds
    v_fma_f32 v30, v30, s43, v43
    v_fma_f32 v31, v31, s43, v43
    v_mfma_f32_16x16x32_bf16 v[172:175], a[172:175], v[32:35], 0
    v_mfma_f32_16x16x32_bf16 v[176:179], a[176:179], v[32:35], 0
    v_exp_f32 v30, v30
    v_exp_f32 v31, v31
    v_mfma_f32_16x16x32_bf16 v[180:183], a[180:183], v[32:35], 0
    v_mfma_f32_16x16x32_bf16 v[184:187], a[184:187], v[32:35], 0
    v_cvt_pk_bf16_f32 v36, v24, v25
    v_cvt_pk_bf16_f32 v37, v26, v27
    v_cvt_pk_bf16_f32 v38, v28, v29
    v_cvt_pk_bf16_f32 v39, v30, v31
    v_mfma_f32_16x16x32_bf16 v[188:191], a[188:191], v[32:35], 0
    v_mfma_f32_16x16x32_bf16 a[236:239], a[248:251], v[32:35], 0
    v_max3_f32 v1, v16, v17, v18
    v_max3_f32 v4, v19, v20, v21
    v_max3_f32 v1, v1, v22, v23
    v_max_f32 v1, v1, v4
    v_mov_b32 v4, v1
    s_nop 1
    v_permlane16_swap_b32 v1, v4
    v_max_f32 v1, v1, v4
    v_mov_b32 v4, v1
    s_nop 1
    v_permlane32_swap_b32 v1, v4
    v_max_f32 v1, v1, v4
    v_mul_f32 v44, s58, v1
    s_mov_b64 exec, 0
    s_branch Lpad10
Lret10:
    s_mov_b64 exec, -1
    v_mfma_f32_16x16x32_bf16 v[24:27], a[128:131], a[64:67], 0
    v_fma_f32 v16, v16, s43, v44
    v_fma_f32 v17, v17, s43, v44
    v_exp_f32 v16, v16
    v_exp_f32 v17, v17
    v_mfma_f32_16x16x32_bf16 v[24:27], a[132:135], a[68:71], v[24:27]
    v_mfma_f32_16x16x32_bf16 v[24:27], a[136:139], a[72:75], v[24:27]
    buffer_load_dwordx4 v57, s[12:15], s40 offen offset:1024 nt lds
    v_mfma_f32_16x16x32_bf16 v[24:27], a[140:143], a[76:79], v[24:27]
    v_fma_f32 v18, v18, s43, v44
    v_fma_f32 v19, v19, s43, v44
    v_exp_f32 v18, v18
    v_mfma_f32_16x16x32_bf16 v[28:31], a[144:147], a[64:67], 0
Lpad1:
    s_cbranch_execz Lret1
    v_mfma_f32_16x16x32_bf16 v[28:31], a[148:151], a[68:71], v[28:31]
    buffer_load_dwordx4 v58, s[12:15], s40 offen offset:3104 nt lds
    v_mfma_f32_16x16x32_bf16 v[28:31], a[152:155], a[72:75], v[28:31]
    v_exp_f32 v19, v19
    v_fma_f32 v20, v20, s43, v44
    v_fma_f32 v21, v21, s43, v44
    v_mfma_f32_16x16x32_bf16 v[28:31], a[156:159], a[76:79], v[28:31]
    v_mfma_f32_16x16x32_bf16 v[160:163], a[192:195], v[36:39], v[160:163]
    v_exp_f32 v20, v20
    v_exp_f32 v21, v21
    v_mfma_f32_16x16x32_bf16 v[164:167], a[196:199], v[36:39], v[164:167]
    v_mfma_f32_16x16x32_bf16 v[168:171], a[200:203], v[36:39], v[168:171]
    s_mov_b64 exec, 0
    s_branch Lpad11
Lret11:
    s_mov_b64 exec, -1
    s_waitcnt vmcnt(8)
    v_fma_f32 v22, v22, s43, v44
    v_fma_f32 v23, v23, s43, v44
    v_mfma_f32_16x16x32_bf16 v[172:175], a[204:207], v[36:39], v[172:175]
    ds_read_b128 a[80:83], v52 offset:16640
    ds_read_b128 a[84:87], v53 offset:16640
    v_mfma_f32_16x16x32_bf16 v[176:179], a[208:211], v[36:39], v[176:179]
    ds_read_b128 a[88:91], v54 offset:16640
    v_exp_f32 v22, v22
    v_exp_f32 v23, v23
    v_mfma_f32_16x16x32_bf16 v[180:183], a[212:215], v[36:39], v[180:183]
    ds_read_b128 a[92:95], v55 offset:16640
    v_mfma_f32_16x16x32_bf16 v[184:187], a[216:219], v[36:39], v[184:187]
    v_cvt_pk_bf16_f32 v32, v16, v17
    v_cvt_pk_bf16_f32 v33, v18, v19
    v_cvt_pk_bf16_f32 v34, v20, v21
    v_cvt_pk_bf16_f32 v35, v22, v23
    v_mfma_f32_16x16x32_bf16 v[188:191], a[220:223], v[36:39], v[188:191]
    v_mfma_f32_16x16x32_bf16 a[236:239], a[248:251], v[36:39], a[236:239]
    v_subrev_u32 v52, 66560, v52
    v_subrev_u32 v53, 66560, v53
    v_subrev_u32 v54, 66560, v54
    v_subrev_u32 v55, 66560, v55
    s_waitcnt lgkmcnt(0)
    v_mfma_f32_16x16x32_bf16 v[16:19], a[96:99], a[80:83], 0
    v_fma_f32 v24, v24, s43, v44
    v_fma_f32 v25, v25, s43, v44
    v_exp_f32 v24, v24
    v_exp_f32 v25, v25
    v_mfma_f32_16x16x32_bf16 v[16:19], a[100:103], a[84:87], v[16:19]
    v_mfma_f32_16x16x32_bf16 v[16:19], a[104:107], a[88:91], v[16:19]
    v_mfma_f32_16x16x32_bf16 v[16:19], a[108:111], a[92:95], v[16:19]
    v_fma_f32 v26, v26, s43, v44
    v_fma_f32 v27, v27, s43, v44
    v_exp_f32 v26, v26
    v_mfma_f32_16x16x32_bf16 v[20:23], a[112:115], a[80:83], 0
    v_mfma_f32_16x16x32_bf16 v[20:23], a[116:119], a[84:87], v[20:23]
    s_add_u32 m0, s45, 16640
    s_add_u32 s40, s40, 8192
    buffer_load_dwordx4 v57, s[8:11], s40 offen nt lds
    v_mfma_f32_16x16x32_bf16 v[20:23], a[120:123], a[88:91], v[20:23]
    v_exp_f32 v27, v27
    v_fma_f32 v28, v28, s43, v44
    v_fma_f32 v29, v29, s43, v44
    v_mfma_f32_16x16x32_bf16 v[20:23], a[124:127], a[92:95], v[20:23]
    v_mfma_f32_16x16x32_bf16 v[192:195], a[160:163], v[32:35], 0
    v_exp_f32 v28, v28
    v_exp_f32 v29, v29
    v_mfma_f32_16x16x32_bf16 v[196:199], a[164:167], v[32:35], 0
    v_mfma_f32_16x16x32_bf16 v[200:203], a[168:171], v[32:35], 0
    buffer_load_dwordx4 v58, s[8:11], s40 offen offset:2080 nt lds
    v_fma_f32 v30, v30, s43, v44
    v_fma_f32 v31, v31, s43, v44
    v_mfma_f32_16x16x32_bf16 v[204:207], a[172:175], v[32:35], 0
    v_mfma_f32_16x16x32_bf16 v[208:211], a[176:179], v[32:35], 0
    v_exp_f32 v30, v30
    v_exp_f32 v31, v31
    v_mfma_f32_16x16x32_bf16 v[212:215], a[180:183], v[32:35], 0
    v_mfma_f32_16x16x32_bf16 v[216:219], a[184:187], v[32:35], 0
    v_cvt_pk_bf16_f32 v36, v24, v25
    v_cvt_pk_bf16_f32 v37, v26, v27
    v_cvt_pk_bf16_f32 v38, v28, v29
    v_cvt_pk_bf16_f32 v39, v30, v31
    v_mfma_f32_16x16x32_bf16 v[220:223], a[188:191], v[32:35], 0
    v_mfma_f32_16x16x32_bf16 a[240:243], a[248:251], v[32:35], 0
    v_max3_f32 v1, v16, v17, v18
    v_max3_f32 v4, v19, v20, v21
    v_max3_f32 v1, v1, v22, v23
    v_max_f32 v1, v1, v4
    v_mov_b32 v4, v1
    s_nop 1
    v_permlane16_swap_b32 v1, v4
    v_max_f32 v1, v1, v4
    v_mov_b32 v4, v1
    s_nop 1
    v_permlane32_swap_b32 v1, v4
    v_max_f32 v1, v1, v4
    v_mul_f32 v45, s58, v1
    v_mfma_f32_16x16x32_bf16 v[24:27], a[128:131], a[80:83], 0
    s_waitcnt vmcnt(8) lgkmcnt(0)
    v_fma_f32 v16, v16, s43, v45
    v_fma_f32 v17, v17, s43, v45
    v_exp_f32 v16, v16
    v_exp_f32 v17, v17
    v_mfma_f32_16x16x32_bf16 v[24:27], a[132:135], a[84:87], v[24:27]
    s_barrier
    v_mfma_f32_16x16x32_bf16 v[24:27], a[136:139], a[88:91], v[24:27]
    s_add_u32 s42, s45, 133120
    v_mfma_f32_16x16x32_bf16 v[24:27], a[140:143], a[92:95], v[24:27]
    v_fma_f32 v18, v18, s43, v45
    v_fma_f32 v19, v19, s43, v45
    v_exp_f32 v18, v18
    v_add_u32 v46, s42, v48
    v_add_u32 v47, s42, v49
    ds_read_b128 a[96:99], v46
    v_mfma_f32_16x16x32_bf16 v[28:31], a[144:147], a[80:83], 0
    v_mfma_f32_16x16x32_bf16 v[28:31], a[148:151], a[84:87], v[28:31]
    v_mfma_f32_16x16x32_bf16 v[28:31], a[152:155], a[88:91], v[28:31]
    v_exp_f32 v19, v19
    v_fma_f32 v20, v20, s43, v45
    v_fma_f32 v21, v21, s43, v45
    ds_read_b128 a[100:103], v46 offset:64
    ds_read_b128 a[104:107], v46 offset:128
    v_mfma_f32_16x16x32_bf16 v[28:31], a[156:159], a[92:95], v[28:31]
    v_mfma_f32_16x16x32_bf16 v[192:195], a[192:195], v[36:39], v[192:195]
    v_exp_f32 v20, v20
    v_exp_f32 v21, v21
    ds_read_b128 a[108:111], v46 offset:192
    ds_read_b128 a[112:115], v46 offset:512
    v_mfma_f32_16x16x32_bf16 v[196:199], a[196:199], v[36:39], v[196:199]
    v_mfma_f32_16x16x32_bf16 v[200:203], a[200:203], v[36:39], v[200:203]
    v_fma_f32 v22, v22, s43, v45
    v_fma_f32 v23, v23, s43, v45
    ds_read_b128 a[116:119], v46 offset:576
    v_mfma_f32_16x16x32_bf16 v[204:207], a[204:207], v[36:39], v[204:207]
    v_mfma_f32_16x16x32_bf16 v[208:211], a[208:211], v[36:39], v[208:211]
    v_exp_f32 v22, v22
    v_exp_f32 v23, v23
    ds_read_b128 a[120:123], v46 offset:640
    ds_read_b128 a[124:127], v46 offset:704
    v_mfma_f32_16x16x32_bf16 v[212:215], a[212:215], v[36:39], v[212:215]
    v_mfma_f32_16x16x32_bf16 v[216:219], a[216:219], v[36:39], v[216:219]
    buffer_load_dwordx4 v57, s[12:15], s40 offen offset:1024 nt lds
    v_cvt_pk_bf16_f32 v32, v16, v17
    v_cvt_pk_bf16_f32 v33, v18, v19
    v_cvt_pk_bf16_f32 v34, v20, v21
    v_cvt_pk_bf16_f32 v35, v22, v23
    v_mfma_f32_16x16x32_bf16 v[220:223], a[220:223], v[36:39], v[220:223]
    v_mfma_f32_16x16x32_bf16 a[240:243], a[248:251], v[36:39], a[240:243]
    buffer_load_dwordx4 v58, s[12:15], s40 offen offset:3104 nt lds
    s_waitcnt lgkmcnt(0)
    v_mfma_f32_16x16x32_bf16 v[16:19], a[96:99], a[0:3], 0
    v_fma_f32 v24, v24, s43, v45
    v_fma_f32 v25, v25, s43, v45
    v_exp_f32 v24, v24
    v_exp_f32 v25, v25
    v_mfma_f32_16x16x32_bf16 v[16:19], a[100:103], a[4:7], v[16:19]
    v_mfma_f32_16x16x32_bf16 v[16:19], a[104:107], a[8:11], v[16:19]
    v_mfma_f32_16x16x32_bf16 v[16:19], a[108:111], a[12:15], v[16:19]
    v_fma_f32 v26, v26, s43, v45
    v_fma_f32 v27, v27, s43, v45
    v_exp_f32 v26, v26
    v_mfma_f32_16x16x32_bf16 v[20:23], a[112:115], a[0:3], 0
    v_mfma_f32_16x16x32_bf16 v[20:23], a[116:119], a[4:7], v[20:23]
    s_add_u32 m0, s45, 33280
    s_add_u32 s40, s40, 8192
    buffer_load_dwordx4 v57, s[8:11], s40 offen nt lds
    v_mfma_f32_16x16x32_bf16 v[20:23], a[120:123], a[8:11], v[20:23]
    v_exp_f32 v27, v27
    v_fma_f32 v28, v28, s43, v45
    v_fma_f32 v29, v29, s43, v45
    v_mfma_f32_16x16x32_bf16 v[20:23], a[124:127], a[12:15], v[20:23]
    v_mfma_f32_16x16x32_bf16 v[224:227], a[160:163], v[32:35], 0
    v_exp_f32 v28, v28
    v_exp_f32 v29, v29
    v_mfma_f32_16x16x32_bf16 v[228:231], a[164:167], v[32:35], 0
    v_mfma_f32_16x16x32_bf16 v[232:235], a[168:171], v[32:35], 0
    buffer_load_dwordx4 v58, s[8:11], s40 offen offset:2080 nt lds
    v_fma_f32 v30, v30, s43, v45
    v_fma_f32 v31, v31, s43, v45
    v_mfma_f32_16x16x32_bf16 v[236:239], a[172:175], v[32:35], 0
    v_mfma_f32_16x16x32_bf16 v[240:243], a[176:179], v[32:35], 0
    v_exp_f32 v30, v30
    v_exp_f32 v31, v31
    v_mfma_f32_16x16x32_bf16 v[244:247], a[180:183], v[32:35], 0
    v_mfma_f32_16x16x32_bf16 v[248:251], a[184:187], v[32:35], 0
    v_cvt_pk_bf16_f32 v36, v24, v25
    v_cvt_pk_bf16_f32 v37, v26, v27
    v_cvt_pk_bf16_f32 v38, v28, v29
    v_cvt_pk_bf16_f32 v39, v30, v31
    v_mfma_f32_16x16x32_bf16 v[252:255], a[188:191], v[32:35], 0
    s_waitcnt vmcnt(10)
    v_mfma_f32_16x16x32_bf16 a[244:247], a[248:251], v[32:35], 0
    s_barrier
    v_mfma_f32_16x16x32_bf16 v[24:27], a[96:99], a[16:19], 0
    v_fma_f32 v16, v16, s43, v40
    v_fma_f32 v17, v17, s43, v40
    v_exp_f32 v16, v16
    v_exp_f32 v17, v17
    ds_read_b64_tr_b16 a[160:161], v47
    ds_read_b64_tr_b16 a[162:163], v47 offset:512
    ds_read_b64_tr_b16 a[164:165], v47 offset:32
    v_mfma_f32_16x16x32_bf16 v[24:27], a[100:103], a[20:23], v[24:27]
    v_mfma_f32_16x16x32_bf16 v[24:27], a[104:107], a[24:27], v[24:27]
    v_mfma_f32_16x16x32_bf16 v[24:27], a[108:111], a[28:31], v[24:27]
    v_fma_f32 v18, v18, s43, v40
    v_fma_f32 v19, v19, s43, v40
    v_exp_f32 v18, v18
    ds_read_b64_tr_b16 a[166:167], v47 offset:544
    ds_read_b64_tr_b16 a[168:169], v47 offset:64
    ds_read_b64_tr_b16 a[170:171], v47 offset:576
    v_mfma_f32_16x16x32_bf16 v[28:31], a[112:115], a[16:19], 0
    v_mfma_f32_16x16x32_bf16 v[28:31], a[116:119], a[20:23], v[28:31]
    v_mfma_f32_16x16x32_bf16 v[28:31], a[120:123], a[24:27], v[28:31]
    v_exp_f32 v19, v19
    v_fma_f32 v20, v20, s43, v40
    v_fma_f32 v21, v21, s43, v40
    ds_read_b64_tr_b16 a[172:173], v47 offset:96
    ds_read_b64_tr_b16 a[174:175], v47 offset:608
    ds_read_b64_tr_b16 a[176:177], v47 offset:128
    v_mfma_f32_16x16x32_bf16 v[28:31], a[124:127], a[28:31], v[28:31]
    v_mfma_f32_16x16x32_bf16 v[224:227], a[192:195], v[36:39], v[224:227]
    v_exp_f32 v20, v20
    v_exp_f32 v21, v21
    ds_read_b64_tr_b16 a[178:179], v47 offset:640
    ds_read_b64_tr_b16 a[180:181], v47 offset:160
    v_mfma_f32_16x16x32_bf16 v[228:231], a[196:199], v[36:39], v[228:231]
    v_mfma_f32_16x16x32_bf16 v[232:235], a[200:203], v[36:39], v[232:235]
    v_fma_f32 v22, v22, s43, v40
    v_fma_f32 v23, v23, s43, v40
    ds_read_b64_tr_b16 a[182:183], v47 offset:672
    ds_read_b64_tr_b16 a[184:185], v47 offset:192
    v_mfma_f32_16x16x32_bf16 v[236:239], a[204:207], v[36:39], v[236:239]
    v_mfma_f32_16x16x32_bf16 v[240:243], a[208:211], v[36:39], v[240:243]
    v_exp_f32 v22, v22
    v_exp_f32 v23, v23
    ds_read_b64_tr_b16 a[186:187], v47 offset:704
    ds_read_b64_tr_b16 a[188:189], v47 offset:224
    v_mfma_f32_16x16x32_bf16 v[244:247], a[212:215], v[36:39], v[244:247]
    v_mfma_f32_16x16x32_bf16 v[248:251], a[216:219], v[36:39], v[248:251]
    buffer_load_dwordx4 v57, s[12:15], s40 offen offset:1024 nt lds
    v_cvt_pk_bf16_f32 v32, v16, v17
    v_cvt_pk_bf16_f32 v33, v18, v19
    v_cvt_pk_bf16_f32 v34, v20, v21
    v_cvt_pk_bf16_f32 v35, v22, v23
    ds_read_b64_tr_b16 a[190:191], v47 offset:736
    v_mfma_f32_16x16x32_bf16 v[252:255], a[220:223], v[36:39], v[252:255]
    s_mov_b32 s42, s45
    v_mfma_f32_16x16x32_bf16 a[244:247], a[248:251], v[36:39], a[244:247]
    buffer_load_dwordx4 v58, s[12:15], s40 offen offset:3104 nt lds
    v_mfma_f32_16x16x32_bf16 v[16:19], a[96:99], a[32:35], 0
    s_waitcnt vmcnt(8) lgkmcnt(0)
    v_fma_f32 v24, v24, s43, v41
    v_fma_f32 v25, v25, s43, v41
    v_exp_f32 v24, v24
    v_exp_f32 v25, v25
    v_mfma_f32_16x16x32_bf16 v[16:19], a[100:103], a[36:39], v[16:19]
    s_barrier
    v_mfma_f32_16x16x32_bf16 v[16:19], a[104:107], a[40:43], v[16:19]
    s_add_u32 s42, s45, 0
    v_mfma_f32_16x16x32_bf16 v[16:19], a[108:111], a[44:47], v[16:19]
    v_fma_f32 v26, v26, s43, v41
    v_fma_f32 v27, v27, s43, v41
    v_exp_f32 v26, v26
    v_mfma_f32_16x16x32_bf16 v[20:23], a[112:115], a[32:35], 0
    v_add_u32 v46, s42, v48
    v_add_u32 v47, s42, v49
    v_mfma_f32_16x16x32_bf16 v[20:23], a[116:119], a[36:39], v[20:23]
    v_mfma_f32_16x16x32_bf16 v[20:23], a[120:123], a[40:43], v[20:23]
    v_exp_f32 v27, v27
    v_fma_f32 v28, v28, s43, v41
    v_fma_f32 v29, v29, s43, v41
    ds_read_b128 a[128:131], v46
    v_mfma_f32_16x16x32_bf16 v[20:23], a[124:127], a[44:47], v[20:23]
    v_mfma_f32_16x16x32_bf16 v[64:67], a[160:163], v[32:35], v[64:67]
    v_exp_f32 v28, v28
    v_exp_f32 v29, v29
    ds_read_b128 a[132:135], v46 offset:64
    v_mfma_f32_16x16x32_bf16 v[68:71], a[164:167], v[32:35], v[68:71]
    s_add_u32 m0, s45, 49920
    v_mfma_f32_16x16x32_bf16 v[72:75], a[168:171], v[32:35], v[72:75]
    s_add_u32 s40, s40, 8192
    v_fma_f32 v30, v30, s43, v41
    v_fma_f32 v31, v31, s43, v41
    v_mfma_f32_16x16x32_bf16 v[76:79], a[172:175], v[32:35], v[76:79]
    buffer_load_dwordx4 v57, s[8:11], s40 offen nt lds
    v_mfma_f32_16x16x32_bf16 v[80:83], a[176:179], v[32:35], v[80:83]
    v_exp_f32 v30, v30
    v_exp_f32 v31, v31
    ds_read_b128 a[136:139], v46 offset:128
    v_mfma_f32_16x16x32_bf16 v[84:87], a[180:183], v[32:35], v[84:87]
    ds_read_b128 a[140:143], v46 offset:192
    v_mfma_f32_16x16x32_bf16 v[88:91], a[184:187], v[32:35], v[88:91]
    v_cvt_pk_bf16_f32 v36, v24, v25
    v_cvt_pk_bf16_f32 v37, v26, v27
    v_cvt_pk_bf16_f32 v38, v28, v29
    v_cvt_pk_bf16_f32 v39, v30, v31
    v_mfma_f32_16x16x32_bf16 v[92:95], a[188:191], v[32:35], v[92:95]
    v_mfma_f32_16x16x32_bf16 a[224:227], a[248:251], v[32:35], a[224:227]
    v_mfma_f32_16x16x32_bf16 v[24:27], a[96:99], a[48:51], 0
    v_fma_f32 v16, v16, s43, v42
    v_fma_f32 v17, v17, s43, v42
    v_exp_f32 v16, v16
    v_exp_f32 v17, v17
    v_mfma_f32_16x16x32_bf16 v[24:27], a[100:103], a[52:55], v[24:27]
    v_mfma_f32_16x16x32_bf16 v[24:27], a[104:107], a[56:59], v[24:27]
    v_mfma_f32_16x16x32_bf16 v[24:27], a[108:111], a[60:63], v[24:27]
    v_fma_f32 v18, v18, s43, v42
    v_fma_f32 v19, v19, s43, v42
    v_exp_f32 v18, v18
    v_mfma_f32_16x16x32_bf16 v[28:31], a[112:115], a[48:51], 0
    v_mfma_f32_16x16x32_bf16 v[28:31], a[116:119], a[52:55], v[28:31]
    v_mfma_f32_16x16x32_bf16 v[28:31], a[120:123], a[56:59], v[28:31]
    v_exp_f32 v19, v19
    v_fma_f32 v20, v20, s43, v42
    v_fma_f32 v21, v21, s43, v42
    ds_read_b128 a[144:147], v46 offset:512
    v_mfma_f32_16x16x32_bf16 v[28:31], a[124:127], a[60:63], v[28:31]
    v_mfma_f32_16x16x32_bf16 v[96:99], a[160:163], v[36:39], v[96:99]
    v_exp_f32 v20, v20
    v_exp_f32 v21, v21
    ds_read_b128 a[148:151], v46 offset:576
    v_mfma_f32_16x16x32_bf16 v[100:103], a[164:167], v[36:39], v[100:103]
    v_mfma_f32_16x16x32_bf16 v[104:107], a[168:171], v[36:39], v[104:107]
    v_fma_f32 v22, v22, s43, v42
    v_fma_f32 v23, v23, s43, v42
    v_mfma_f32_16x16x32_bf16 v[108:111], a[172:175], v[36:39], v[108:111]
    buffer_load_dwordx4 v57, s[12:15], s40 offen offset:1024 nt lds
    v_mfma_f32_16x16x32_bf16 v[112:115], a[176:179], v[36:39], v[112:115]
    v_exp_f32 v22, v22
    v_exp_f32 v23, v23
    ds_read_b128 a[152:155], v46 offset:640
    v_mfma_f32_16x16x32_bf16 v[116:119], a[180:183], v[36:39], v[116:119]
    ds_read_b128 a[156:159], v46 offset:704
    v_mfma_f32_16x16x32_bf16 v[120:123], a[184:187], v[36:39], v[120:123]
    v_cvt_pk_bf16_f32 v32, v16, v17
    v_cvt_pk_bf16_f32 v33, v18, v19
    v_cvt_pk_bf16_f32 v34, v20, v21
    v_cvt_pk_bf16_f32 v35, v22, v23
    v_mfma_f32_16x16x32_bf16 v[124:127], a[188:191], v[36:39], v[124:127]
    v_mfma_f32_16x16x32_bf16 a[228:231], a[248:251], v[36:39], a[228:231]
    v_mfma_f32_16x16x32_bf16 v[16:19], a[96:99], a[64:67], 0
    v_fma_f32 v24, v24, s43, v43
    v_fma_f32 v25, v25, s43, v43
    v_exp_f32 v24, v24
    v_exp_f32 v25, v25
    v_mfma_f32_16x16x32_bf16 v[16:19], a[100:103], a[68:71], v[16:19]
    v_mfma_f32_16x16x32_bf16 v[16:19], a[104:107], a[72:75], v[16:19]
    v_mfma_f32_16x16x32_bf16 v[16:19], a[108:111], a[76:79], v[16:19]
    v_fma_f32 v26, v26, s43, v43
    v_fma_f32 v27, v27, s43, v43
    v_exp_f32 v26, v26
    v_mfma_f32_16x16x32_bf16 v[20:23], a[112:115], a[64:67], 0
    v_mfma_f32_16x16x32_bf16 v[20:23], a[116:119], a[68:71], v[20:23]
    v_mfma_f32_16x16x32_bf16 v[20:23], a[120:123], a[72:75], v[20:23]
    v_exp_f32 v27, v27
    v_fma_f32 v28, v28, s43, v43
    v_fma_f32 v29, v29, s43, v43
    ds_read_b64_tr_b16 a[192:193], v47
    v_mfma_f32_16x16x32_bf16 v[20:23], a[124:127], a[76:79], v[20:23]
    v_mfma_f32_16x16x32_bf16 v[128:131], a[160:163], v[32:35], v[128:131]
    v_exp_f32 v28, v28
    v_exp_f32 v29, v29
    ds_read_b64_tr_b16 a[194:195], v47 offset:512
    v_mfma_f32_16x16x32_bf16 v[132:135], a[164:167], v[32:35], v[132:135]
    v_mfma_f32_16x16x32_bf16 v[136:139], a[168:171], v[32:35], v[136:139]
    v_fma_f32 v30, v30, s43, v43
    v_fma_f32 v31, v31, s43, v43
    v_mfma_f32_16x16x32_bf16 v[140:143], a[172:175], v[32:35], v[140:143]
    buffer_load_dwordx4 v58, s[8:11], s40 offen offset:2080 nt lds
    v_mfma_f32_16x16x32_bf16 v[144:147], a[176:179], v[32:35], v[144:147]
    v_exp_f32 v30, v30
    v_exp_f32 v31, v31
    ds_read_b64_tr_b16 a[196:197], v47 offset:32
    v_mfma_f32_16x16x32_bf16 v[148:151], a[180:183], v[32:35], v[148:151]
    ds_read_b64_tr_b16 a[198:199], v47 offset:544
    v_mfma_f32_16x16x32_bf16 v[152:155], a[184:187], v[32:35], v[152:155]
    v_cvt_pk_bf16_f32 v36, v24, v25
    v_cvt_pk_bf16_f32 v37, v26, v27
    v_cvt_pk_bf16_f32 v38, v28, v29
    v_cvt_pk_bf16_f32 v39, v30, v31
    v_mfma_f32_16x16x32_bf16 v[156:159], a[188:191], v[32:35], v[156:159]
    v_mfma_f32_16x16x32_bf16 a[232:235], a[248:251], v[32:35], a[232:235]
    v_mfma_f32_16x16x32_bf16 v[24:27], a[96:99], a[80:83], 0
    v_fma_f32 v16, v16, s43, v44
    v_fma_f32 v17, v17, s43, v44
    v_exp_f32 v16, v16
    v_exp_f32 v17, v17
    v_mfma_f32_16x16x32_bf16 v[24:27], a[100:103], a[84:87], v[24:27]
    v_mfma_f32_16x16x32_bf16 v[24:27], a[104:107], a[88:91], v[24:27]
    v_mfma_f32_16x16x32_bf16 v[24:27], a[108:111], a[92:95], v[24:27]
    v_fma_f32 v18, v18, s43, v44
    v_fma_f32 v19, v19, s43, v44
    v_exp_f32 v18, v18
    v_mfma_f32_16x16x32_bf16 v[28:31], a[112:115], a[80:83], 0
    v_mfma_f32_16x16x32_bf16 v[28:31], a[116:119], a[84:87], v[28:31]
    v_mfma_f32_16x16x32_bf16 v[28:31], a[120:123], a[88:91], v[28:31]
    v_exp_f32 v19, v19
    v_fma_f32 v20, v20, s43, v44
    v_fma_f32 v21, v21, s43, v44
    ds_read_b64_tr_b16 a[200:201], v47 offset:64
    v_mfma_f32_16x16x32_bf16 v[28:31], a[124:127], a[92:95], v[28:31]
    v_mfma_f32_16x16x32_bf16 v[160:163], a[160:163], v[36:39], v[160:163]
    v_exp_f32 v20, v20
    v_exp_f32 v21, v21
    ds_read_b64_tr_b16 a[202:203], v47 offset:576
    v_mfma_f32_16x16x32_bf16 v[164:167], a[164:167], v[36:39], v[164:167]
    v_mfma_f32_16x16x32_bf16 v[168:171], a[168:171], v[36:39], v[168:171]
    v_fma_f32 v22, v22, s43, v44
    v_fma_f32 v23, v23, s43, v44
    v_mfma_f32_16x16x32_bf16 v[172:175], a[172:175], v[36:39], v[172:175]
    buffer_load_dwordx4 v58, s[12:15], s40 offen offset:3104 nt lds
    v_mfma_f32_16x16x32_bf16 v[176:179], a[176:179], v[36:39], v[176:179]
    v_exp_f32 v22, v22
    v_exp_f32 v23, v23
    ds_read_b64_tr_b16 a[204:205], v47 offset:96
    v_mfma_f32_16x16x32_bf16 v[180:183], a[180:183], v[36:39], v[180:183]
    ds_read_b64_tr_b16 a[206:207], v47 offset:608
    v_mfma_f32_16x16x32_bf16 v[184:187], a[184:187], v[36:39], v[184:187]
    v_cvt_pk_bf16_f32 v32, v16, v17
    v_cvt_pk_bf16_f32 v33, v18, v19
    v_cvt_pk_bf16_f32 v34, v20, v21
    v_cvt_pk_bf16_f32 v35, v22, v23
    v_mfma_f32_16x16x32_bf16 v[188:191], a[188:191], v[36:39], v[188:191]
    s_waitcnt lgkmcnt(8)
    v_mfma_f32_16x16x32_bf16 a[236:239], a[248:251], v[36:39], a[236:239]
    v_mfma_f32_16x16x32_bf16 v[16:19], a[128:131], a[0:3], 0
    v_fma_f32 v24, v24, s43, v45
    v_fma_f32 v25, v25, s43, v45
    v_exp_f32 v24, v24
    v_exp_f32 v25, v25
    v_mfma_f32_16x16x32_bf16 v[16:19], a[132:135], a[4:7], v[16:19]
    v_mfma_f32_16x16x32_bf16 v[16:19], a[136:139], a[8:11], v[16:19]
    v_mfma_f32_16x16x32_bf16 v[16:19], a[140:143], a[12:15], v[16:19]
    v_fma_f32 v26, v26, s43, v45
    v_fma_f32 v27, v27, s43, v45
    v_exp_f32 v26, v26
    v_mfma_f32_16x16x32_bf16 v[20:23], a[144:147], a[0:3], 0
    v_mfma_f32_16x16x32_bf16 v[20:23], a[148:151], a[4:7], v[20:23]
    v_mfma_f32_16x16x32_bf16 v[20:23], a[152:155], a[8:11], v[20:23]
    v_exp_f32 v27, v27
    v_fma_f32 v28, v28, s43, v45
    v_fma_f32 v29, v29, s43, v45
    ds_read_b64_tr_b16 a[208:209], v47 offset:128
    v_mfma_f32_16x16x32_bf16 v[20:23], a[156:159], a[12:15], v[20:23]
    v_mfma_f32_16x16x32_bf16 v[192:195], a[160:163], v[32:35], v[192:195]
    v_exp_f32 v28, v28
    v_exp_f32 v29, v29
    ds_read_b64_tr_b16 a[210:211], v47 offset:640
    v_mfma_f32_16x16x32_bf16 v[196:199], a[164:167], v[32:35], v[196:199]
    s_add_u32 m0, s45, 66560
    v_mfma_f32_16x16x32_bf16 v[200:203], a[168:171], v[32:35], v[200:203]
    s_add_u32 s40, s40, 8192
    v_fma_f32 v30, v30, s43, v45
    v_fma_f32 v31, v31, s43, v45
    v_mfma_f32_16x16x32_bf16 v[204:207], a[172:175], v[32:35], v[204:207]
    buffer_load_dwordx4 v57, s[8:11], s40 offen nt lds
    v_mfma_f32_16x16x32_bf16 v[208:211], a[176:179], v[32:35], v[208:211]
    v_exp_f32 v30, v30
    v_exp_f32 v31, v31
    ds_read_b64_tr_b16 a[212:213], v47 offset:160
    v_mfma_f32_16x16x32_bf16 v[212:215], a[180:183], v[32:35], v[212:215]
    ds_read_b64_tr_b16 a[214:215], v47 offset:672
    v_mfma_f32_16x16x32_bf16 v[216:219], a[184:187], v[32:35], v[216:219]
    v_cvt_pk_bf16_f32 v36, v24, v25
    v_cvt_pk_bf16_f32 v37, v26, v27
    v_cvt_pk_bf16_f32 v38, v28, v29
    v_cvt_pk_bf16_f32 v39, v30, v31
    v_mfma_f32_16x16x32_bf16 v[220:223], a[188:191], v[32:35], v[220:223]
    v_mfma_f32_16x16x32_bf16 a[240:243], a[248:251], v[32:35], a[240:243]
    v_mfma_f32_16x16x32_bf16 v[24:27], a[128:131], a[16:19], 0
    v_fma_f32 v16, v16, s43, v40
    v_fma_f32 v17, v17, s43, v40
    v_exp_f32 v16, v16
    v_exp_f32 v17, v17
    v_mfma_f32_16x16x32_bf16 v[24:27], a[132:135], a[20:23], v[24:27]
    v_mfma_f32_16x16x32_bf16 v[24:27], a[136:139], a[24:27], v[24:27]
    ds_read_b64_tr_b16 a[216:217], v47 offset:192
    v_mfma_f32_16x16x32_bf16 v[24:27], a[140:143], a[28:31], v[24:27]
    v_fma_f32 v18, v18, s43, v40
    v_fma_f32 v19, v19, s43, v40
    v_exp_f32 v18, v18
    v_mfma_f32_16x16x32_bf16 v[28:31], a[144:147], a[16:19], 0
    v_mfma_f32_16x16x32_bf16 v[28:31], a[148:151], a[20:23], v[28:31]
    v_mfma_f32_16x16x32_bf16 v[28:31], a[152:155], a[24:27], v[28:31]
    v_exp_f32 v19, v19
    v_fma_f32 v20, v20, s43, v40
    v_fma_f32 v21, v21, s43, v40
    ds_read_b64_tr_b16 a[218:219], v47 offset:704
    v_mfma_f32_16x16x32_bf16 v[28:31], a[156:159], a[28:31], v[28:31]
    v_mfma_f32_16x16x32_bf16 v[224:227], a[160:163], v[36:39], v[224:227]
    v_exp_f32 v20, v20
    v_exp_f32 v21, v21
    ds_read_b64_tr_b16 a[220:221], v47 offset:224
    v_mfma_f32_16x16x32_bf16 v[228:231], a[164:167], v[36:39], v[228:231]
    ds_read_b64_tr_b16 a[222:223], v47 offset:736
    v_mfma_f32_16x16x32_bf16 v[232:235], a[168:171], v[36:39], v[232:235]
    v_fma_f32 v22, v22, s43, v40
    v_fma_f32 v23, v23, s43, v40
    v_mfma_f32_16x16x32_bf16 v[236:239], a[172:175], v[36:39], v[236:239]
    v_mfma_f32_16x16x32_bf16 v[240:243], a[176:179], v[36:39], v[240:243]
    v_exp_f32 v22, v22
    v_exp_f32 v23, v23
    v_mfma_f32_16x16x32_bf16 v[244:247], a[180:183], v[36:39], v[244:247]
    v_mfma_f32_16x16x32_bf16 v[248:251], a[184:187], v[36:39], v[248:251]
    buffer_load_dwordx4 v57, s[12:15], s40 offen offset:1024 nt lds
    v_cvt_pk_bf16_f32 v32, v16, v17
    v_cvt_pk_bf16_f32 v33, v18, v19
    v_cvt_pk_bf16_f32 v34, v20, v21
    v_cvt_pk_bf16_f32 v35, v22, v23
    v_mfma_f32_16x16x32_bf16 v[252:255], a[188:191], v[36:39], v[252:255]
    v_mfma_f32_16x16x32_bf16 a[244:247], a[248:251], v[36:39], a[244:247]
    v_mfma_f32_16x16x32_bf16 v[16:19], a[128:131], a[32:35], 0
    s_waitcnt vmcnt(10) lgkmcnt(0)
    v_fma_f32 v24, v24, s43, v41
    v_fma_f32 v25, v25, s43, v41
    v_exp_f32 v24, v24
    v_exp_f32 v25, v25
    v_mfma_f32_16x16x32_bf16 v[16:19], a[132:135], a[36:39], v[16:19]
    s_barrier
    v_mfma_f32_16x16x32_bf16 v[16:19], a[136:139], a[40:43], v[16:19]
    v_mfma_f32_16x16x32_bf16 v[16:19], a[140:143], a[44:47], v[16:19]
    v_fma_f32 v26, v26, s43, v41
    v_fma_f32 v27, v27, s43, v41
    v_exp_f32 v26, v26
    v_mfma_f32_16x16x32_bf16 v[20:23], a[144:147], a[32:35], 0
    v_mfma_f32_16x16x32_bf16 v[20:23], a[148:151], a[36:39], v[20:23]
    v_mfma_f32_16x16x32_bf16 v[20:23], a[152:155], a[40:43], v[20:23]
    v_exp_f32 v27, v27
    v_fma_f32 v28, v28, s43, v41
    v_fma_f32 v29, v29, s43, v41
    ds_read_b128 a[96:99], v46 offset:16640
    v_mfma_f32_16x16x32_bf16 v[20:23], a[156:159], a[44:47], v[20:23]
    v_mfma_f32_16x16x32_bf16 v[64:67], a[192:195], v[32:35], v[64:67]
    v_exp_f32 v28, v28
    v_exp_f32 v29, v29
    ds_read_b128 a[100:103], v46 offset:16704
    v_mfma_f32_16x16x32_bf16 v[68:71], a[196:199], v[32:35], v[68:71]
    v_mfma_f32_16x16x32_bf16 v[72:75], a[200:203], v[32:35], v[72:75]
    v_fma_f32 v30, v30, s43, v41
    v_fma_f32 v31, v31, s43, v41
    v_mfma_f32_16x16x32_bf16 v[76:79], a[204:207], v[32:35], v[76:79]
    buffer_load_dwordx4 v58, s[8:11], s40 offen offset:2080 nt lds
    v_mfma_f32_16x16x32_bf16 v[80:83], a[208:211], v[32:35], v[80:83]
    v_exp_f32 v30, v30
    v_exp_f32 v31, v31
    ds_read_b128 a[104:107], v46 offset:16768
    v_mfma_f32_16x16x32_bf16 v[84:87], a[212:215], v[32:35], v[84:87]
    ds_read_b128 a[108:111], v46 offset:16832
    v_mfma_f32_16x16x32_bf16 v[88:91], a[216:219], v[32:35], v[88:91]
    v_cvt_pk_bf16_f32 v36, v24, v25
    v_cvt_pk_bf16_f32 v37, v26, v27
    v_cvt_pk_bf16_f32 v38, v28, v29
    v_cvt_pk_bf16_f32 v39, v30, v31
    v_mfma_f32_16x16x32_bf16 v[92:95], a[220:223], v[32:35], v[92:95]
    v_mfma_f32_16x16x32_bf16 a[224:227], a[248:251], v[32:35], a[224:227]
    v_mfma_f32_16x16x32_bf16 v[24:27], a[128:131], a[48:51], 0
    v_fma_f32 v16, v16, s43, v42
    v_fma_f32 v17, v17, s43, v42
    v_exp_f32 v16, v16
    v_exp_f32 v17, v17
    v_mfma_f32_16x16x32_bf16 v[24:27], a[132:135], a[52:55], v[24:27]
    v_mfma_f32_16x16x32_bf16 v[24:27], a[136:139], a[56:59], v[24:27]
    v_mfma_f32_16x16x32_bf16 v[24:27], a[140:143], a[60:63], v[24:27]
    v_fma_f32 v18, v18, s43, v42
    v_fma_f32 v19, v19, s43, v42
    v_exp_f32 v18, v18
    v_mfma_f32_16x16x32_bf16 v[28:31], a[144:147], a[48:51], 0
    v_mfma_f32_16x16x32_bf16 v[28:31], a[148:151], a[52:55], v[28:31]
    v_mfma_f32_16x16x32_bf16 v[28:31], a[152:155], a[56:59], v[28:31]
    v_exp_f32 v19, v19
    v_fma_f32 v20, v20, s43, v42
    v_fma_f32 v21, v21, s43, v42
    ds_read_b128 a[112:115], v46 offset:17152
    v_mfma_f32_16x16x32_bf16 v[28:31], a[156:159], a[60:63], v[28:31]
    v_mfma_f32_16x16x32_bf16 v[96:99], a[192:195], v[36:39], v[96:99]
    v_exp_f32 v20, v20
    v_exp_f32 v21, v21
    ds_read_b128 a[116:119], v46 offset:17216
    v_mfma_f32_16x16x32_bf16 v[100:103], a[196:199], v[36:39], v[100:103]
Lpad2:
    s_cbranch_execz Lret2
    v_mfma_f32_16x16x32_bf16 v[104:107], a[200:203], v[36:39], v[104:107]
    v_fma_f32 v22, v22, s43, v42
    v_fma_f32 v23, v23, s43, v42
    v_mfma_f32_16x16x32_bf16 v[108:111], a[204:207], v[36:39], v[108:111]
    buffer_load_dwordx4 v58, s[12:15], s40 offen offset:3104 nt lds
    v_mfma_f32_16x16x32_bf16 v[112:115], a[208:211], v[36:39], v[112:115]
    v_exp_f32 v22, v22
    v_exp_f32 v23, v23
    ds_read_b128 a[120:123], v46 offset:17280
    v_mfma_f32_16x16x32_bf16 v[116:119], a[212:215], v[36:39], v[116:119]
    ds_read_b128 a[124:127], v46 offset:17344
    v_mfma_f32_16x16x32_bf16 v[120:123], a[216:219], v[36:39], v[120:123]
    v_cvt_pk_bf16_f32 v32, v16, v17
    v_cvt_pk_bf16_f32 v33, v18, v19
    v_cvt_pk_bf16_f32 v34, v20, v21
    v_cvt_pk_bf16_f32 v35, v22, v23
    v_mfma_f32_16x16x32_bf16 v[124:127], a[220:223], v[36:39], v[124:127]
    v_mfma_f32_16x16x32_bf16 a[228:231], a[248:251], v[36:39], a[228:231]
    v_mfma_f32_16x16x32_bf16 v[16:19], a[128:131], a[64:67], 0
    v_fma_f32 v24, v24, s43, v43
    v_fma_f32 v25, v25, s43, v43
    v_exp_f32 v24, v24
    v_exp_f32 v25, v25
    v_mfma_f32_16x16x32_bf16 v[16:19], a[132:135], a[68:71], v[16:19]
    v_mfma_f32_16x16x32_bf16 v[16:19], a[136:139], a[72:75], v[16:19]
    v_mfma_f32_16x16x32_bf16 v[16:19], a[140:143], a[76:79], v[16:19]
    v_fma_f32 v26, v26, s43, v43
    v_fma_f32 v27, v27, s43, v43
    v_exp_f32 v26, v26
    v_mfma_f32_16x16x32_bf16 v[20:23], a[144:147], a[64:67], 0
    v_mfma_f32_16x16x32_bf16 v[20:23], a[148:151], a[68:71], v[20:23]
    v_mfma_f32_16x16x32_bf16 v[20:23], a[152:155], a[72:75], v[20:23]
    v_exp_f32 v27, v27
    v_fma_f32 v28, v28, s43, v43
    v_fma_f32 v29, v29, s43, v43
    ds_read_b64_tr_b16 a[160:161], v47 offset:16640
    v_mfma_f32_16x16x32_bf16 v[20:23], a[156:159], a[76:79], v[20:23]
    v_mfma_f32_16x16x32_bf16 v[128:131], a[192:195], v[32:35], v[128:131]
    v_exp_f32 v28, v28
    v_exp_f32 v29, v29
    ds_read_b64_tr_b16 a[162:163], v47 offset:17152
    v_mfma_f32_16x16x32_bf16 v[132:135], a[196:199], v[32:35], v[132:135]
    s_add_u32 m0, s45, 83200
    v_mfma_f32_16x16x32_bf16 v[136:139], a[200:203], v[32:35], v[136:139]
    s_add_u32 s40, s40, 8192
    v_fma_f32 v30, v30, s43, v43
    v_fma_f32 v31, v31, s43, v43
    v_mfma_f32_16x16x32_bf16 v[140:143], a[204:207], v[32:35], v[140:143]
    buffer_load_dwordx4 v57, s[8:11], s40 offen nt lds
    v_mfma_f32_16x16x32_bf16 v[144:147], a[208:211], v[32:35], v[144:147]
    v_exp_f32 v30, v30
    v_exp_f32 v31, v31
    ds_read_b64_tr_b16 a[164:165], v47 offset:16672
    v_mfma_f32_16x16x32_bf16 v[148:151], a[212:215], v[32:35], v[148:151]
    ds_read_b64_tr_b16 a[166:167], v47 offset:17184
    v_mfma_f32_16x16x32_bf16 v[152:155], a[216:219], v[32:35], v[152:155]
    v_cvt_pk_bf16_f32 v36, v24, v25
    v_cvt_pk_bf16_f32 v37, v26, v27
    v_cvt_pk_bf16_f32 v38, v28, v29
    v_cvt_pk_bf16_f32 v39, v30, v31
    v_mfma_f32_16x16x32_bf16 v[156:159], a[220:223], v[32:35], v[156:159]
    v_mfma_f32_16x16x32_bf16 a[232:235], a[248:251], v[32:35], a[232:235]
    v_mfma_f32_16x16x32_bf16 v[24:27], a[128:131], a[80:83], 0
    v_fma_f32 v16, v16, s43, v44
    v_fma_f32 v17, v17, s43, v44
    v_exp_f32 v16, v16
    v_exp_f32 v17, v17
    v_mfma_f32_16x16x32_bf16 v[24:27], a[132:135], a[84:87], v[24:27]
    v_mfma_f32_16x16x32_bf16 v[24:27], a[136:139], a[88:91], v[24:27]
    v_mfma_f32_16x16x32_bf16 v[24:27], a[140:143], a[92:95], v[24:27]
    v_fma_f32 v18, v18, s43, v44
    v_fma_f32 v19, v19, s43, v44
    v_exp_f32 v18, v18
    v_mfma_f32_16x16x32_bf16 v[28:31], a[144:147], a[80:83], 0
    v_mfma_f32_16x16x32_bf16 v[28:31], a[148:151], a[84:87], v[28:31]
    v_mfma_f32_16x16x32_bf16 v[28:31], a[152:155], a[88:91], v[28:31]
    v_exp_f32 v19, v19
    v_fma_f32 v20, v20, s43, v44
    v_fma_f32 v21, v21, s43, v44
    ds_read_b64_tr_b16 a[168:169], v47 offset:16704
    v_mfma_f32_16x16x32_bf16 v[28:31], a[156:159], a[92:95], v[28:31]
    v_mfma_f32_16x16x32_bf16 v[160:163], a[192:195], v[36:39], v[160:163]
    v_exp_f32 v20, v20
    v_exp_f32 v21, v21
    ds_read_b64_tr_b16 a[170:171], v47 offset:17216
    v_mfma_f32_16x16x32_bf16 v[164:167], a[196:199], v[36:39], v[164:167]
    v_mfma_f32_16x16x32_bf16 v[168:171], a[200:203], v[36:39], v[168:171]
    v_fma_f32 v22, v22, s43, v44
    v_fma_f32 v23, v23, s43, v44
    v_mfma_f32_16x16x32_bf16 v[172:175], a[204:207], v[36:39], v[172:175]
    buffer_load_dwordx4 v57, s[12:15], s40 offen offset:1024 nt lds
    v_mfma_f32_16x16x32_bf16 v[176:179], a[208:211], v[36:39], v[176:179]
    v_exp_f32 v22, v22
    v_exp_f32 v23, v23
    ds_read_b64_tr_b16 a[172:173], v47 offset:16736
    v_mfma_f32_16x16x32_bf16 v[180:183], a[212:215], v[36:39], v[180:183]
    ds_read_b64_tr_b16 a[174:175], v47 offset:17248
    v_mfma_f32_16x16x32_bf16 v[184:187], a[216:219], v[36:39], v[184:187]
    v_cvt_pk_bf16_f32 v32, v16, v17
    v_cvt_pk_bf16_f32 v33, v18, v19
    v_cvt_pk_bf16_f32 v34, v20, v21
    v_cvt_pk_bf16_f32 v35, v22, v23
    v_mfma_f32_16x16x32_bf16 v[188:191], a[220:223], v[36:39], v[188:191]
    s_waitcnt lgkmcnt(8)
    v_mfma_f32_16x16x32_bf16 a[236:239], a[248:251], v[36:39], a[236:239]
    v_mfma_f32_16x16x32_bf16 v[16:19], a[96:99], a[0:3], 0
    v_fma_f32 v24, v24, s43, v45
    v_fma_f32 v25, v25, s43, v45
    v_exp_f32 v24, v24
    v_exp_f32 v25, v25
    v_mfma_f32_16x16x32_bf16 v[16:19], a[100:103], a[4:7], v[16:19]
    v_mfma_f32_16x16x32_bf16 v[16:19], a[104:107], a[8:11], v[16:19]
    v_mfma_f32_16x16x32_bf16 v[16:19], a[108:111], a[12:15], v[16:19]
    v_fma_f32 v26, v26, s43, v45
    v_fma_f32 v27, v27, s43, v45
    v_exp_f32 v26, v26
    v_mfma_f32_16x16x32_bf16 v[20:23], a[112:115], a[0:3], 0
    v_mfma_f32_16x16x32_bf16 v[20:23], a[116:119], a[4:7], v[20:23]
    v_mfma_f32_16x16x32_bf16 v[20:23], a[120:123], a[8:11], v[20:23]
    v_exp_f32 v27, v27
    v_fma_f32 v28, v28, s43, v45
    v_fma_f32 v29, v29, s43, v45
    ds_read_b64_tr_b16 a[176:177], v47 offset:16768
    v_mfma_f32_16x16x32_bf16 v[20:23], a[124:127], a[12:15], v[20:23]
    v_mfma_f32_16x16x32_bf16 v[192:195], a[192:195], v[32:35], v[192:195]
    v_exp_f32 v28, v28
    v_exp_f32 v29, v29
    ds_read_b64_tr_b16 a[178:179], v47 offset:17280
    v_mfma_f32_16x16x32_bf16 v[196:199], a[196:199], v[32:35], v[196:199]
    v_mfma_f32_16x16x32_bf16 v[200:203], a[200:203], v[32:35], v[200:203]
    v_fma_f32 v30, v30, s43, v45
    v_fma_f32 v31, v31, s43, v45
    v_mfma_f32_16x16x32_bf16 v[204:207], a[204:207], v[32:35], v[204:207]
    buffer_load_dwordx4 v58, s[8:11], s40 offen offset:2080 nt lds
    v_mfma_f32_16x16x32_bf16 v[208:211], a[208:211], v[32:35], v[208:211]
    v_exp_f32 v30, v30
    v_exp_f32 v31, v31
    ds_read_b64_tr_b16 a[180:181], v47 offset:16800
    v_mfma_f32_16x16x32_bf16 v[212:215], a[212:215], v[32:35], v[212:215]
    ds_read_b64_tr_b16 a[182:183], v47 offset:17312
    v_mfma_f32_16x16x32_bf16 v[216:219], a[216:219], v[32:35], v[216:219]
    v_cvt_pk_bf16_f32 v36, v24, v25
    v_cvt_pk_bf16_f32 v37, v26, v27
    v_cvt_pk_bf16_f32 v38, v28, v29
    v_cvt_pk_bf16_f32 v39, v30, v31
    v_mfma_f32_16x16x32_bf16 v[220:223], a[220:223], v[32:35], v[220:223]
    v_mfma_f32_16x16x32_bf16 a[240:243], a[248:251], v[32:35], a[240:243]
    v_mfma_f32_16x16x32_bf16 v[24:27], a[96:99], a[16:19], 0
    v_fma_f32 v16, v16, s43, v40
    v_fma_f32 v17, v17, s43, v40
    v_exp_f32 v16, v16
    v_exp_f32 v17, v17
    v_mfma_f32_16x16x32_bf16 v[24:27], a[100:103], a[20:23], v[24:27]
    v_mfma_f32_16x16x32_bf16 v[24:27], a[104:107], a[24:27], v[24:27]
    ds_read_b64_tr_b16 a[184:185], v47 offset:16832
    v_mfma_f32_16x16x32_bf16 v[24:27], a[108:111], a[28:31], v[24:27]
    v_fma_f32 v18, v18, s43, v40
    v_fma_f32 v19, v19, s43, v40
    v_exp_f32 v18, v18
    v_mfma_f32_16x16x32_bf16 v[28:31], a[112:115], a[16:19], 0
    v_mfma_f32_16x16x32_bf16 v[28:31], a[116:119], a[20:23], v[28:31]
    v_mfma_f32_16x16x32_bf16 v[28:31], a[120:123], a[24:27], v[28:31]
    v_exp_f32 v19, v19
    v_fma_f32 v20, v20, s43, v40
    v_fma_f32 v21, v21, s43, v40
    ds_read_b64_tr_b16 a[186:187], v47 offset:17344
    v_mfma_f32_16x16x32_bf16 v[28:31], a[124:127], a[28:31], v[28:31]
    v_mfma_f32_16x16x32_bf16 v[224:227], a[192:195], v[36:39], v[224:227]
    v_exp_f32 v20, v20
    v_exp_f32 v21, v21
    ds_read_b64_tr_b16 a[188:189], v47 offset:16864
    v_mfma_f32_16x16x32_bf16 v[228:231], a[196:199], v[36:39], v[228:231]
    ds_read_b64_tr_b16 a[190:191], v47 offset:17376
    v_mfma_f32_16x16x32_bf16 v[232:235], a[200:203], v[36:39], v[232:235]
    v_fma_f32 v22, v22, s43, v40
    v_fma_f32 v23, v23, s43, v40
    v_mfma_f32_16x16x32_bf16 v[236:239], a[204:207], v[36:39], v[236:239]
    v_mfma_f32_16x16x32_bf16 v[240:243], a[208:211], v[36:39], v[240:243]
    v_exp_f32 v22, v22
    v_exp_f32 v23, v23
    v_mfma_f32_16x16x32_bf16 v[244:247], a[212:215], v[36:39], v[244:247]
    v_mfma_f32_16x16x32_bf16 v[248:251], a[216:219], v[36:39], v[248:251]
    buffer_load_dwordx4 v58, s[12:15], s40 offen offset:3104 nt lds
    v_cvt_pk_bf16_f32 v32, v16, v17
    v_cvt_pk_bf16_f32 v33, v18, v19
    v_cvt_pk_bf16_f32 v34, v20, v21
    v_cvt_pk_bf16_f32 v35, v22, v23
    v_mfma_f32_16x16x32_bf16 v[252:255], a[220:223], v[36:39], v[252:255]
    v_mfma_f32_16x16x32_bf16 a[244:247], a[248:251], v[36:39], a[244:247]
    v_mfma_f32_16x16x32_bf16 v[16:19], a[96:99], a[32:35], 0
    s_waitcnt vmcnt(12) lgkmcnt(0)
    v_fma_f32 v24, v24, s43, v41
    v_fma_f32 v25, v25, s43, v41
    v_mfma_f32_16x16x32_bf16 v[16:19], a[100:103], a[36:39], v[16:19]
    s_barrier
    v_exp_f32 v24, v24
    v_exp_f32 v25, v25
    v_mfma_f32_16x16x32_bf16 v[16:19], a[104:107], a[40:43], v[16:19]
    v_mfma_f32_16x16x32_bf16 v[16:19], a[108:111], a[44:47], v[16:19]
    v_fma_f32 v26, v26, s43, v41
    v_fma_f32 v27, v27, s43, v41
    v_mfma_f32_16x16x32_bf16 v[20:23], a[112:115], a[32:35], 0
    v_exp_f32 v26, v26
    v_mfma_f32_16x16x32_bf16 v[20:23], a[116:119], a[36:39], v[20:23]
    v_mfma_f32_16x16x32_bf16 v[20:23], a[120:123], a[40:43], v[20:23]
    v_exp_f32 v27, v27
    ds_read_b128 a[128:131], v46 offset:33280
    v_mfma_f32_16x16x32_bf16 v[20:23], a[124:127], a[44:47], v[20:23]
    v_fma_f32 v28, v28, s43, v41
    v_fma_f32 v29, v29, s43, v41
    v_mfma_f32_16x16x32_bf16 v[64:67], a[160:163], v[32:35], v[64:67]
    v_exp_f32 v28, v28
    v_exp_f32 v29, v29
    ds_read_b128 a[132:135], v46 offset:33344
    v_mfma_f32_16x16x32_bf16 v[68:71], a[164:167], v[32:35], v[68:71]
    s_add_u32 m0, s45, 99840
    v_mfma_f32_16x16x32_bf16 v[72:75], a[168:171], v[32:35], v[72:75]
    s_add_u32 s40, s40, 8192
    v_fma_f32 v30, v30, s43, v41
    v_fma_f32 v31, v31, s43, v41
    v_mfma_f32_16x16x32_bf16 v[76:79], a[172:175], v[32:35], v[76:79]
    buffer_load_dwordx4 v57, s[8:11], s40 offen nt lds
    v_mfma_f32_16x16x32_bf16 v[80:83], a[176:179], v[32:35], v[80:83]
    v_exp_f32 v30, v30
    v_exp_f32 v31, v31
    ds_read_b128 a[136:139], v46 offset:33408
    v_mfma_f32_16x16x32_bf16 v[84:87], a[180:183], v[32:35], v[84:87]
    ds_read_b128 a[140:143], v46 offset:33472
    v_mfma_f32_16x16x32_bf16 v[88:91], a[184:187], v[32:35], v[88:91]
    v_cvt_pk_bf16_f32 v36, v24, v25
    v_cvt_pk_bf16_f32 v37, v26, v27
    v_cvt_pk_bf16_f32 v38, v28, v29
    v_cvt_pk_bf16_f32 v39, v30, v31
    v_mfma_f32_16x16x32_bf16 v[92:95], a[188:191], v[32:35], v[92:95]
    v_mfma_f32_16x16x32_bf16 a[224:227], a[248:251], v[32:35], a[224:227]
    v_mfma_f32_16x16x32_bf16 v[24:27], a[96:99], a[48:51], 0
    v_fma_f32 v16, v16, s43, v42
    v_fma_f32 v17, v17, s43, v42
    v_mfma_f32_16x16x32_bf16 v[24:27], a[100:103], a[52:55], v[24:27]
    v_exp_f32 v16, v16
    v_exp_f32 v17, v17
    v_mfma_f32_16x16x32_bf16 v[24:27], a[104:107], a[56:59], v[24:27]
    v_mfma_f32_16x16x32_bf16 v[24:27], a[108:111], a[60:63], v[24:27]
    v_fma_f32 v18, v18, s43, v42
    v_fma_f32 v19, v19, s43, v42
    v_mfma_f32_16x16x32_bf16 v[28:31], a[112:115], a[48:51], 0
    v_exp_f32 v18, v18
    v_mfma_f32_16x16x32_bf16 v[28:31], a[116:119], a[52:55], v[28:31]
    v_mfma_f32_16x16x32_bf16 v[28:31], a[120:123], a[56:59], v[28:31]
    v_exp_f32 v19, v19
    ds_read_b128 a[144:147], v46 offset:33792
    v_mfma_f32_16x16x32_bf16 v[28:31], a[124:127], a[60:63], v[28:31]
    v_fma_f32 v20, v20, s43, v42
    v_fma_f32 v21, v21, s43, v42
    v_mfma_f32_16x16x32_bf16 v[96:99], a[160:163], v[36:39], v[96:99]
    v_exp_f32 v20, v20
    v_exp_f32 v21, v21
    ds_read_b128 a[148:151], v46 offset:33856
    v_mfma_f32_16x16x32_bf16 v[100:103], a[164:167], v[36:39], v[100:103]
    v_mfma_f32_16x16x32_bf16 v[104:107], a[168:171], v[36:39], v[104:107]
    v_fma_f32 v22, v22, s43, v42
    v_fma_f32 v23, v23, s43, v42
    v_mfma_f32_16x16x32_bf16 v[108:111], a[172:175], v[36:39], v[108:111]
    buffer_load_dwordx4 v57, s[12:15], s40 offen offset:1024 nt lds
    v_mfma_f32_16x16x32_bf16 v[112:115], a[176:179], v[36:39], v[112:115]
    v_exp_f32 v22, v22
    v_exp_f32 v23, v23
    ds_read_b128 a[152:155], v46 offset:33920
    v_mfma_f32_16x16x32_bf16 v[116:119], a[180:183], v[36:39], v[116:119]
    ds_read_b128 a[156:159], v46 offset:33984
    v_mfma_f32_16x16x32_bf16 v[120:123], a[184:187], v[36:39], v[120:123]
    v_cvt_pk_bf16_f32 v32, v16, v17
    v_cvt_pk_bf16_f32 v33, v18, v19
    v_cvt_pk_bf16_f32 v34, v20, v21
    v_cvt_pk_bf16_f32 v35, v22, v23
    v_mfma_f32_16x16x32_bf16 v[124:127], a[188:191], v[36:39], v[124:127]
    v_mfma_f32_16x16x32_bf16 a[228:231], a[248:251], v[36:39], a[228:231]
    v_mfma_f32_16x16x32_bf16 v[16:19], a[96:99], a[64:67], 0
    v_fma_f32 v24, v24, s43, v43
    v_fma_f32 v25, v25, s43, v43
    v_mfma_f32_16x16x32_bf16 v[16:19], a[100:103], a[68:71], v[16:19]
    v_exp_f32 v24, v24
    v_exp_f32 v25, v25
    v_mfma_f32_16x16x32_bf16 v[16:19], a[104:107], a[72:75], v[16:19]
    v_mfma_f32_16x16x32_bf16 v[16:19], a[108:111], a[76:79], v[16:19]
    v_fma_f32 v26, v26, s43, v43
    v_fma_f32 v27, v27, s43, v43
    v_mfma_f32_16x16x32_bf16 v[20:23], a[112:115], a[64:67], 0
    v_exp_f32 v26, v26
    v_mfma_f32_16x16x32_bf16 v[20:23], a[116:119], a[68:71], v[20:23]
    v_mfma_f32_16x16x32_bf16 v[20:23], a[120:123], a[72:75], v[20:23]
    v_exp_f32 v27, v27
    ds_read_b64_tr_b16 a[192:193], v47 offset:33280
    v_mfma_f32_16x16x32_bf16 v[20:23], a[124:127], a[76:79], v[20:23]
    v_fma_f32 v28, v28, s43, v43
    v_fma_f32 v29, v29, s43, v43
    v_mfma_f32_16x16x32_bf16 v[128:131], a[160:163], v[32:35], v[128:131]
    v_exp_f32 v28, v28
    v_exp_f32 v29, v29
    ds_read_b64_tr_b16 a[194:195], v47 offset:33792
    v_mfma_f32_16x16x32_bf16 v[132:135], a[164:167], v[32:35], v[132:135]
    v_mfma_f32_16x16x32_bf16 v[136:139], a[168:171], v[32:35], v[136:139]
    v_fma_f32 v30, v30, s43, v43
    v_fma_f32 v31, v31, s43, v43
    v_mfma_f32_16x16x32_bf16 v[140:143], a[172:175], v[32:35], v[140:143]
    buffer_load_dwordx4 v58, s[8:11], s40 offen offset:2080 nt lds
    v_mfma_f32_16x16x32_bf16 v[144:147], a[176:179], v[32:35], v[144:147]
    v_exp_f32 v30, v30
    v_exp_f32 v31, v31
    ds_read_b64_tr_b16 a[196:197], v47 offset:33312
    v_mfma_f32_16x16x32_bf16 v[148:151], a[180:183], v[32:35], v[148:151]
    ds_read_b64_tr_b16 a[198:199], v47 offset:33824
    v_mfma_f32_16x16x32_bf16 v[152:155], a[184:187], v[32:35], v[152:155]
    v_cvt_pk_bf16_f32 v36, v24, v25
    v_cvt_pk_bf16_f32 v37, v26, v27
    v_cvt_pk_bf16_f32 v38, v28, v29
    v_cvt_pk_bf16_f32 v39, v30, v31
    v_mfma_f32_16x16x32_bf16 v[156:159], a[188:191], v[32:35], v[156:159]
    v_mfma_f32_16x16x32_bf16 a[232:235], a[248:251], v[32:35], a[232:235]
    v_mfma_f32_16x16x32_bf16 v[24:27], a[96:99], a[80:83], 0
    v_fma_f32 v16, v16, s43, v44
    v_fma_f32 v17, v17, s43, v44
    v_mfma_f32_16x16x32_bf16 v[24:27], a[100:103], a[84:87], v[24:27]
    v_exp_f32 v16, v16
    v_exp_f32 v17, v17
    v_mfma_f32_16x16x32_bf16 v[24:27], a[104:107], a[88:91], v[24:27]
    v_mfma_f32_16x16x32_bf16 v[24:27], a[108:111], a[92:95], v[24:27]
    v_fma_f32 v18, v18, s43, v44
    v_fma_f32 v19, v19, s43, v44
    v_mfma_f32_16x16x32_bf16 v[28:31], a[112:115], a[80:83], 0
    v_exp_f32 v18, v18
    v_mfma_f32_16x16x32_bf16 v[28:31], a[116:119], a[84:87], v[28:31]
    v_mfma_f32_16x16x32_bf16 v[28:31], a[120:123], a[88:91], v[28:31]
    v_exp_f32 v19, v19
    ds_read_b64_tr_b16 a[200:201], v47 offset:33344
    v_mfma_f32_16x16x32_bf16 v[28:31], a[124:127], a[92:95], v[28:31]
    v_fma_f32 v20, v20, s43, v44
    v_fma_f32 v21, v21, s43, v44
    v_mfma_f32_16x16x32_bf16 v[160:163], a[160:163], v[36:39], v[160:163]
    v_exp_f32 v20, v20
    v_exp_f32 v21, v21
    ds_read_b64_tr_b16 a[202:203], v47 offset:33856
    v_mfma_f32_16x16x32_bf16 v[164:167], a[164:167], v[36:39], v[164:167]
    v_mfma_f32_16x16x32_bf16 v[168:171], a[168:171], v[36:39], v[168:171]
    v_fma_f32 v22, v22, s43, v44
    v_fma_f32 v23, v23, s43, v44
    v_mfma_f32_16x16x32_bf16 v[172:175], a[172:175], v[36:39], v[172:175]
    buffer_load_dwordx4 v58, s[12:15], s40 offen offset:3104 nt lds
    v_mfma_f32_16x16x32_bf16 v[176:179], a[176:179], v[36:39], v[176:179]
    v_exp_f32 v22, v22
    v_exp_f32 v23, v23
    ds_read_b64_tr_b16 a[204:205], v47 offset:33376
    v_mfma_f32_16x16x32_bf16 v[180:183], a[180:183], v[36:39], v[180:183]
    ds_read_b64_tr_b16 a[206:207], v47 offset:33888
    v_mfma_f32_16x16x32_bf16 v[184:187], a[184:187], v[36:39], v[184:187]
    v_cvt_pk_bf16_f32 v32, v16, v17
    v_cvt_pk_bf16_f32 v33, v18, v19
    v_cvt_pk_bf16_f32 v34, v20, v21
    v_cvt_pk_bf16_f32 v35, v22, v23
    v_mfma_f32_16x16x32_bf16 v[188:191], a[188:191], v[36:39], v[188:191]
    s_waitcnt lgkmcnt(8)
    v_mfma_f32_16x16x32_bf16 a[236:239], a[248:251], v[36:39], a[236:239]
    v_mfma_f32_16x16x32_bf16 v[16:19], a[128:131], a[0:3], 0
    v_fma_f32 v24, v24, s43, v45
    v_fma_f32 v25, v25, s43, v45
    v_mfma_f32_16x16x32_bf16 v[16:19], a[132:135], a[4:7], v[16:19]
    v_exp_f32 v24, v24
    v_exp_f32 v25, v25
    v_mfma_f32_16x16x32_bf16 v[16:19], a[136:139], a[8:11], v[16:19]
    v_mfma_f32_16x16x32_bf16 v[16:19], a[140:143], a[12:15], v[16:19]
    v_fma_f32 v26, v26, s43, v45
    v_fma_f32 v27, v27, s43, v45
    v_mfma_f32_16x16x32_bf16 v[20:23], a[144:147], a[0:3], 0
    v_exp_f32 v26, v26
    v_mfma_f32_16x16x32_bf16 v[20:23], a[148:151], a[4:7], v[20:23]
    v_mfma_f32_16x16x32_bf16 v[20:23], a[152:155], a[8:11], v[20:23]
    v_exp_f32 v27, v27
    ds_read_b64_tr_b16 a[208:209], v47 offset:33408
    v_mfma_f32_16x16x32_bf16 v[20:23], a[156:159], a[12:15], v[20:23]
    v_fma_f32 v28, v28, s43, v45
    v_fma_f32 v29, v29, s43, v45
    v_mfma_f32_16x16x32_bf16 v[192:195], a[160:163], v[32:35], v[192:195]
    v_exp_f32 v28, v28
    v_exp_f32 v29, v29
    ds_read_b64_tr_b16 a[210:211], v47 offset:33920
    v_mfma_f32_16x16x32_bf16 v[196:199], a[164:167], v[32:35], v[196:199]
    s_add_u32 m0, s45, 116480
    v_mfma_f32_16x16x32_bf16 v[200:203], a[168:171], v[32:35], v[200:203]
    s_add_u32 s40, s40, 8192
    v_fma_f32 v30, v30, s43, v45
    v_fma_f32 v31, v31, s43, v45
    v_mfma_f32_16x16x32_bf16 v[204:207], a[172:175], v[32:35], v[204:207]
    buffer_load_dwordx4 v57, s[8:11], s40 offen nt lds
    v_mfma_f32_16x16x32_bf16 v[208:211], a[176:179], v[32:35], v[208:211]
    v_exp_f32 v30, v30
    v_exp_f32 v31, v31
    ds_read_b64_tr_b16 a[212:213], v47 offset:33440
    v_mfma_f32_16x16x32_bf16 v[212:215], a[180:183], v[32:35], v[212:215]
    ds_read_b64_tr_b16 a[214:215], v47 offset:33952
    v_mfma_f32_16x16x32_bf16 v[216:219], a[184:187], v[32:35], v[216:219]
    v_cvt_pk_bf16_f32 v36, v24, v25
    v_cvt_pk_bf16_f32 v37, v26, v27
    v_cvt_pk_bf16_f32 v38, v28, v29
    v_cvt_pk_bf16_f32 v39, v30, v31
    v_mfma_f32_16x16x32_bf16 v[220:223], a[188:191], v[32:35], v[220:223]
    v_mfma_f32_16x16x32_bf16 a[240:243], a[248:251], v[32:35], a[240:243]
    v_mfma_f32_16x16x32_bf16 v[24:27], a[128:131], a[16:19], 0
    v_fma_f32 v16, v16, s43, v40
    v_fma_f32 v17, v17, s43, v40
    v_mfma_f32_16x16x32_bf16 v[24:27], a[132:135], a[20:23], v[24:27]
    v_exp_f32 v16, v16
    v_exp_f32 v17, v17
    v_mfma_f32_16x16x32_bf16 v[24:27], a[136:139], a[24:27], v[24:27]
    ds_read_b64_tr_b16 a[216:217], v47 offset:33472
    v_mfma_f32_16x16x32_bf16 v[24:27], a[140:143], a[28:31], v[24:27]
    v_fma_f32 v18, v18, s43, v40
    v_fma_f32 v19, v19, s43, v40
    v_mfma_f32_16x16x32_bf16 v[28:31], a[144:147], a[16:19], 0
    v_exp_f32 v18, v18
    v_mfma_f32_16x16x32_bf16 v[28:31], a[148:151], a[20:23], v[28:31]
    v_mfma_f32_16x16x32_bf16 v[28:31], a[152:155], a[24:27], v[28:31]
    v_exp_f32 v19, v19
    ds_read_b64_tr_b16 a[218:219], v47 offset:33984
    v_mfma_f32_16x16x32_bf16 v[28:31], a[156:159], a[28:31], v[28:31]
    v_fma_f32 v20, v20, s43, v40
    v_fma_f32 v21, v21, s43, v40
    v_mfma_f32_16x16x32_bf16 v[224:227], a[160:163], v[36:39], v[224:227]
    v_exp_f32 v20, v20
    v_exp_f32 v21, v21
    ds_read_b64_tr_b16 a[220:221], v47 offset:33504
    v_mfma_f32_16x16x32_bf16 v[228:231], a[164:167], v[36:39], v[228:231]
    ds_read_b64_tr_b16 a[222:223], v47 offset:34016
    v_mfma_f32_16x16x32_bf16 v[232:235], a[168:171], v[36:39], v[232:235]
    v_fma_f32 v22, v22, s43, v40
    v_fma_f32 v23, v23, s43, v40
    v_mfma_f32_16x16x32_bf16 v[236:239], a[172:175], v[36:39], v[236:239]
    v_mfma_f32_16x16x32_bf16 v[240:243], a[176:179], v[36:39], v[240:243]
    v_exp_f32 v22, v22
    v_exp_f32 v23, v23
    v_mfma_f32_16x16x32_bf16 v[244:247], a[180:183], v[36:39], v[244:247]
    v_mfma_f32_16x16x32_bf16 v[248:251], a[184:187], v[36:39], v[248:251]
    buffer_load_dwordx4 v57, s[12:15], s40 offen offset:1024 nt lds
    v_cvt_pk_bf16_f32 v32, v16, v17
    v_cvt_pk_bf16_f32 v33, v18, v19
    v_cvt_pk_bf16_f32 v34, v20, v21
    v_cvt_pk_bf16_f32 v35, v22, v23
    v_mfma_f32_16x16x32_bf16 v[252:255], a[188:191], v[36:39], v[252:255]
    v_mfma_f32_16x16x32_bf16 a[244:247], a[248:251], v[36:39], a[244:247]
    v_mfma_f32_16x16x32_bf16 v[16:19], a[128:131], a[32:35], 0
    s_waitcnt vmcnt(14) lgkmcnt(0)
    v_fma_f32 v24, v24, s43, v41
    v_fma_f32 v25, v25, s43, v41
    v_mfma_f32_16x16x32_bf16 v[16:19], a[132:135], a[36:39], v[16:19]
    s_barrier
    v_exp_f32 v24, v24
    v_mfma_f32_16x16x32_bf16 v[16:19], a[136:139], a[40:43], v[16:19]
    v_exp_f32 v25, v25
    v_mfma_f32_16x16x32_bf16 v[16:19], a[140:143], a[44:47], v[16:19]
    v_fma_f32 v26, v26, s43, v41
    v_fma_f32 v27, v27, s43, v41
    v_mfma_f32_16x16x32_bf16 v[20:23], a[144:147], a[32:35], 0
    v_exp_f32 v26, v26
    v_mfma_f32_16x16x32_bf16 v[20:23], a[148:151], a[36:39], v[20:23]
    v_mfma_f32_16x16x32_bf16 v[20:23], a[152:155], a[40:43], v[20:23]
    v_exp_f32 v27, v27
    ds_read_b128 a[96:99], v46 offset:49920
    v_mfma_f32_16x16x32_bf16 v[20:23], a[156:159], a[44:47], v[20:23]
    v_fma_f32 v28, v28, s43, v41
    v_fma_f32 v29, v29, s43, v41
    v_mfma_f32_16x16x32_bf16 v[64:67], a[192:195], v[32:35], v[64:67]
    v_exp_f32 v28, v28
    ds_read_b128 a[100:103], v46 offset:49984
    v_mfma_f32_16x16x32_bf16 v[68:71], a[196:199], v[32:35], v[68:71]
    v_exp_f32 v29, v29
    v_mfma_f32_16x16x32_bf16 v[72:75], a[200:203], v[32:35], v[72:75]
    v_fma_f32 v30, v30, s43, v41
    v_fma_f32 v31, v31, s43, v41
    v_mfma_f32_16x16x32_bf16 v[76:79], a[204:207], v[32:35], v[76:79]
    buffer_load_dwordx4 v58, s[8:11], s40 offen offset:2080 nt lds
    v_mfma_f32_16x16x32_bf16 v[80:83], a[208:211], v[32:35], v[80:83]
    v_exp_f32 v30, v30
    ds_read_b128 a[104:107], v46 offset:50048
    v_mfma_f32_16x16x32_bf16 v[84:87], a[212:215], v[32:35], v[84:87]
    v_exp_f32 v31, v31
    ds_read_b128 a[108:111], v46 offset:50112
    v_mfma_f32_16x16x32_bf16 v[88:91], a[216:219], v[32:35], v[88:91]
    v_cvt_pk_bf16_f32 v36, v24, v25
    v_cvt_pk_bf16_f32 v37, v26, v27
    v_mfma_f32_16x16x32_bf16 v[92:95], a[220:223], v[32:35], v[92:95]
    v_cvt_pk_bf16_f32 v38, v28, v29
    v_cvt_pk_bf16_f32 v39, v30, v31
    v_mfma_f32_16x16x32_bf16 a[224:227], a[248:251], v[32:35], a[224:227]
    v_mfma_f32_16x16x32_bf16 v[24:27], a[128:131], a[48:51], 0
    v_fma_f32 v16, v16, s43, v42
    v_fma_f32 v17, v17, s43, v42
    v_mfma_f32_16x16x32_bf16 v[24:27], a[132:135], a[52:55], v[24:27]
    v_exp_f32 v16, v16
    v_mfma_f32_16x16x32_bf16 v[24:27], a[136:139], a[56:59], v[24:27]
    v_exp_f32 v17, v17
    v_mfma_f32_16x16x32_bf16 v[24:27], a[140:143], a[60:63], v[24:27]
    v_fma_f32 v18, v18, s43, v42
    v_fma_f32 v19, v19, s43, v42
    v_mfma_f32_16x16x32_bf16 v[28:31], a[144:147], a[48:51], 0
    v_exp_f32 v18, v18
    v_mfma_f32_16x16x32_bf16 v[28:31], a[148:151], a[52:55], v[28:31]
    v_mfma_f32_16x16x32_bf16 v[28:31], a[152:155], a[56:59], v[28:31]
    v_exp_f32 v19, v19
    ds_read_b128 a[112:115], v46 offset:50432
    v_mfma_f32_16x16x32_bf16 v[28:31], a[156:159], a[60:63], v[28:31]
    v_fma_f32 v20, v20, s43, v42
    v_fma_f32 v21, v21, s43, v42
    v_mfma_f32_16x16x32_bf16 v[96:99], a[192:195], v[36:39], v[96:99]
    v_exp_f32 v20, v20
    ds_read_b128 a[116:119], v46 offset:50496
    v_mfma_f32_16x16x32_bf16 v[100:103], a[196:199], v[36:39], v[100:103]
    v_exp_f32 v21, v21
    v_mfma_f32_16x16x32_bf16 v[104:107], a[200:203], v[36:39], v[104:107]
    v_fma_f32 v22, v22, s43, v42
    v_fma_f32 v23, v23, s43, v42
    v_mfma_f32_16x16x32_bf16 v[108:111], a[204:207], v[36:39], v[108:111]
    buffer_load_dwordx4 v58, s[12:15], s40 offen offset:3104 nt lds
    v_mfma_f32_16x16x32_bf16 v[112:115], a[208:211], v[36:39], v[112:115]
    v_exp_f32 v22, v22
    ds_read_b128 a[120:123], v46 offset:50560
    v_mfma_f32_16x16x32_bf16 v[116:119], a[212:215], v[36:39], v[116:119]
    v_exp_f32 v23, v23
    ds_read_b128 a[124:127], v46 offset:50624
    v_mfma_f32_16x16x32_bf16 v[120:123], a[216:219], v[36:39], v[120:123]
    v_cvt_pk_bf16_f32 v32, v16, v17
    v_cvt_pk_bf16_f32 v33, v18, v19
    v_mfma_f32_16x16x32_bf16 v[124:127], a[220:223], v[36:39], v[124:127]
    v_cvt_pk_bf16_f32 v34, v20, v21
    v_cvt_pk_bf16_f32 v35, v22, v23
    v_mfma_f32_16x16x32_bf16 a[228:231], a[248:251], v[36:39], a[228:231]
    v_mfma_f32_16x16x32_bf16 v[16:19], a[128:131], a[64:67], 0
    v_fma_f32 v24, v24, s43, v43
    v_fma_f32 v25, v25, s43, v43
    v_mfma_f32_16x16x32_bf16 v[16:19], a[132:135], a[68:71], v[16:19]
    v_exp_f32 v24, v24
    v_mfma_f32_16x16x32_bf16 v[16:19], a[136:139], a[72:75], v[16:19]
    v_exp_f32 v25, v25
    v_mfma_f32_16x16x32_bf16 v[16:19], a[140:143], a[76:79], v[16:19]
    v_fma_f32 v26, v26, s43, v43
    v_fma_f32 v27, v27, s43, v43
    v_mfma_f32_16x16x32_bf16 v[20:23], a[144:147], a[64:67], 0
    v_exp_f32 v26, v26
    v_mfma_f32_16x16x32_bf16 v[20:23], a[148:151], a[68:71], v[20:23]
    v_mfma_f32_16x16x32_bf16 v[20:23], a[152:155], a[72:75], v[20:23]
    v_exp_f32 v27, v27
    ds_read_b64_tr_b16 a[160:161], v47 offset:49920
    v_mfma_f32_16x16x32_bf16 v[20:23], a[156:159], a[76:79], v[20:23]
    v_fma_f32 v28, v28, s43, v43
    v_fma_f32 v29, v29, s43, v43
    v_mfma_f32_16x16x32_bf16 v[128:131], a[192:195], v[32:35], v[128:131]
    v_exp_f32 v28, v28
    ds_read_b64_tr_b16 a[162:163], v47 offset:50432
    v_mfma_f32_16x16x32_bf16 v[132:135], a[196:199], v[32:35], v[132:135]
    s_add_u32 m0, s45, 133120
    v_exp_f32 v29, v29
    v_mfma_f32_16x16x32_bf16 v[136:139], a[200:203], v[32:35], v[136:139]
    s_add_u32 s40, s40, 8192
    v_fma_f32 v30, v30, s43, v43
    v_fma_f32 v31, v31, s43, v43
    v_mfma_f32_16x16x32_bf16 v[140:143], a[204:207], v[32:35], v[140:143]
    buffer_load_dwordx4 v57, s[8:11], s40 offen nt lds
    v_mfma_f32_16x16x32_bf16 v[144:147], a[208:211], v[32:35], v[144:147]
    v_exp_f32 v30, v30
    ds_read_b64_tr_b16 a[164:165], v47 offset:49952
    v_mfma_f32_16x16x32_bf16 v[148:151], a[212:215], v[32:35], v[148:151]
Lpad3:
    s_cbranch_execz Lret3
    v_exp_f32 v31, v31
    ds_read_b64_tr_b16 a[166:167], v47 offset:50464
    v_mfma_f32_16x16x32_bf16 v[152:155], a[216:219], v[32:35], v[152:155]
    v_cvt_pk_bf16_f32 v36, v24, v25
    v_cvt_pk_bf16_f32 v37, v26, v27
    v_mfma_f32_16x16x32_bf16 v[156:159], a[220:223], v[32:35], v[156:159]
    v_cvt_pk_bf16_f32 v38, v28, v29
    v_cvt_pk_bf16_f32 v39, v30, v31
    v_mfma_f32_16x16x32_bf16 a[232:235], a[248:251], v[32:35], a[232:235]
    v_mfma_f32_16x16x32_bf16 v[24:27], a[128:131], a[80:83], 0
    v_fma_f32 v16, v16, s43, v44
    v_fma_f32 v17, v17, s43, v44
    v_mfma_f32_16x16x32_bf16 v[24:27], a[132:135], a[84:87], v[24:27]
    v_exp_f32 v16, v16
    v_mfma_f32_16x16x32_bf16 v[24:27], a[136:139], a[88:91], v[24:27]
    v_exp_f32 v17, v17
    v_mfma_f32_16x16x32_bf16 v[24:27], a[140:143], a[92:95], v[24:27]
    v_fma_f32 v18, v18, s43, v44
    v_fma_f32 v19, v19, s43, v44
    v_mfma_f32_16x16x32_bf16 v[28:31], a[144:147], a[80:83], 0
    v_exp_f32 v18, v18
    v_mfma_f32_16x16x32_bf16 v[28:31], a[148:151], a[84:87], v[28:31]
    v_mfma_f32_16x16x32_bf16 v[28:31], a[152:155], a[88:91], v[28:31]
    v_exp_f32 v19, v19
    ds_read_b64_tr_b16 a[168:169], v47 offset:49984
    v_mfma_f32_16x16x32_bf16 v[28:31], a[156:159], a[92:95], v[28:31]
    v_fma_f32 v20, v20, s43, v44
    v_fma_f32 v21, v21, s43, v44
    v_mfma_f32_16x16x32_bf16 v[160:163], a[192:195], v[36:39], v[160:163]
    v_exp_f32 v20, v20
    ds_read_b64_tr_b16 a[170:171], v47 offset:50496
    v_mfma_f32_16x16x32_bf16 v[164:167], a[196:199], v[36:39], v[164:167]
    v_exp_f32 v21, v21
    v_mfma_f32_16x16x32_bf16 v[168:171], a[200:203], v[36:39], v[168:171]
    v_fma_f32 v22, v22, s43, v44
    v_fma_f32 v23, v23, s43, v44
    v_mfma_f32_16x16x32_bf16 v[172:175], a[204:207], v[36:39], v[172:175]
    buffer_load_dwordx4 v57, s[12:15], s40 offen offset:1024 nt lds
    v_mfma_f32_16x16x32_bf16 v[176:179], a[208:211], v[36:39], v[176:179]
    v_exp_f32 v22, v22
    ds_read_b64_tr_b16 a[172:173], v47 offset:50016
    v_mfma_f32_16x16x32_bf16 v[180:183], a[212:215], v[36:39], v[180:183]
    v_exp_f32 v23, v23
    ds_read_b64_tr_b16 a[174:175], v47 offset:50528
    v_mfma_f32_16x16x32_bf16 v[184:187], a[216:219], v[36:39], v[184:187]
    v_cvt_pk_bf16_f32 v32, v16, v17
    v_cvt_pk_bf16_f32 v33, v18, v19
    v_mfma_f32_16x16x32_bf16 v[188:191], a[220:223], v[36:39], v[188:191]
    s_waitcnt lgkmcnt(8)
    v_cvt_pk_bf16_f32 v34, v20, v21
    v_cvt_pk_bf16_f32 v35, v22, v23
    v_mfma_f32_16x16x32_bf16 a[236:239], a[248:251], v[36:39], a[236:239]
    v_mfma_f32_16x16x32_bf16 v[16:19], a[96:99], a[0:3], 0
    v_fma_f32 v24, v24, s43, v45
    v_fma_f32 v25, v25, s43, v45
    v_mfma_f32_16x16x32_bf16 v[16:19], a[100:103], a[4:7], v[16:19]
    v_exp_f32 v24, v24
    v_mfma_f32_16x16x32_bf16 v[16:19], a[104:107], a[8:11], v[16:19]
    v_exp_f32 v25, v25
    v_mfma_f32_16x16x32_bf16 v[16:19], a[108:111], a[12:15], v[16:19]
    v_fma_f32 v26, v26, s43, v45
    v_fma_f32 v27, v27, s43, v45
    v_mfma_f32_16x16x32_bf16 v[20:23], a[112:115], a[0:3], 0
    v_exp_f32 v26, v26
    v_mfma_f32_16x16x32_bf16 v[20:23], a[116:119], a[4:7], v[20:23]
    v_mfma_f32_16x16x32_bf16 v[20:23], a[120:123], a[8:11], v[20:23]
    v_exp_f32 v27, v27
    ds_read_b64_tr_b16 a[176:177], v47 offset:50048
    v_mfma_f32_16x16x32_bf16 v[20:23], a[124:127], a[12:15], v[20:23]
    v_fma_f32 v28, v28, s43, v45
    v_fma_f32 v29, v29, s43, v45
    v_mfma_f32_16x16x32_bf16 v[192:195], a[192:195], v[32:35], v[192:195]
    v_exp_f32 v28, v28
    ds_read_b64_tr_b16 a[178:179], v47 offset:50560
    v_mfma_f32_16x16x32_bf16 v[196:199], a[196:199], v[32:35], v[196:199]
    v_exp_f32 v29, v29
    v_mfma_f32_16x16x32_bf16 v[200:203], a[200:203], v[32:35], v[200:203]
    v_fma_f32 v30, v30, s43, v45
    v_fma_f32 v31, v31, s43, v45
    v_mfma_f32_16x16x32_bf16 v[204:207], a[204:207], v[32:35], v[204:207]
    buffer_load_dwordx4 v58, s[8:11], s40 offen offset:2080 nt lds
    v_mfma_f32_16x16x32_bf16 v[208:211], a[208:211], v[32:35], v[208:211]
    v_exp_f32 v30, v30
    ds_read_b64_tr_b16 a[180:181], v47 offset:50080
    v_mfma_f32_16x16x32_bf16 v[212:215], a[212:215], v[32:35], v[212:215]
    v_exp_f32 v31, v31
    ds_read_b64_tr_b16 a[182:183], v47 offset:50592
    v_mfma_f32_16x16x32_bf16 v[216:219], a[216:219], v[32:35], v[216:219]
    v_cvt_pk_bf16_f32 v36, v24, v25
    v_cvt_pk_bf16_f32 v37, v26, v27
    v_mfma_f32_16x16x32_bf16 v[220:223], a[220:223], v[32:35], v[220:223]
    v_cvt_pk_bf16_f32 v38, v28, v29
    v_cvt_pk_bf16_f32 v39, v30, v31
    v_mfma_f32_16x16x32_bf16 a[240:243], a[248:251], v[32:35], a[240:243]
    v_mfma_f32_16x16x32_bf16 v[24:27], a[96:99], a[16:19], 0
    v_fma_f32 v16, v16, s43, v40
    v_fma_f32 v17, v17, s43, v40
    v_mfma_f32_16x16x32_bf16 v[24:27], a[100:103], a[20:23], v[24:27]
    v_exp_f32 v16, v16
    v_mfma_f32_16x16x32_bf16 v[24:27], a[104:107], a[24:27], v[24:27]
    v_exp_f32 v17, v17
    ds_read_b64_tr_b16 a[184:185], v47 offset:50112
    v_mfma_f32_16x16x32_bf16 v[24:27], a[108:111], a[28:31], v[24:27]
    v_fma_f32 v18, v18, s43, v40
    v_fma_f32 v19, v19, s43, v40
    v_mfma_f32_16x16x32_bf16 v[28:31], a[112:115], a[16:19], 0
    v_exp_f32 v18, v18
    v_mfma_f32_16x16x32_bf16 v[28:31], a[116:119], a[20:23], v[28:31]
    v_mfma_f32_16x16x32_bf16 v[28:31], a[120:123], a[24:27], v[28:31]
    v_exp_f32 v19, v19
    ds_read_b64_tr_b16 a[186:187], v47 offset:50624
    v_mfma_f32_16x16x32_bf16 v[28:31], a[124:127], a[28:31], v[28:31]
    v_fma_f32 v20, v20, s43, v40
    v_fma_f32 v21, v21, s43, v40
    v_mfma_f32_16x16x32_bf16 v[224:227], a[192:195], v[36:39], v[224:227]
    v_exp_f32 v20, v20
    ds_read_b64_tr_b16 a[188:189], v47 offset:50144
    v_mfma_f32_16x16x32_bf16 v[228:231], a[196:199], v[36:39], v[228:231]
    v_exp_f32 v21, v21
    ds_read_b64_tr_b16 a[190:191], v47 offset:50656
    v_mfma_f32_16x16x32_bf16 v[232:235], a[200:203], v[36:39], v[232:235]
    v_fma_f32 v22, v22, s43, v40
    v_fma_f32 v23, v23, s43, v40
    v_mfma_f32_16x16x32_bf16 v[236:239], a[204:207], v[36:39], v[236:239]
    v_mfma_f32_16x16x32_bf16 v[240:243], a[208:211], v[36:39], v[240:243]
    v_exp_f32 v22, v22
    v_mfma_f32_16x16x32_bf16 v[244:247], a[212:215], v[36:39], v[244:247]
    v_exp_f32 v23, v23
    v_mfma_f32_16x16x32_bf16 v[248:251], a[216:219], v[36:39], v[248:251]
    buffer_load_dwordx4 v58, s[12:15], s40 offen offset:3104 nt lds
    v_cvt_pk_bf16_f32 v32, v16, v17
    v_cvt_pk_bf16_f32 v33, v18, v19
    v_mfma_f32_16x16x32_bf16 v[252:255], a[220:223], v[36:39], v[252:255]
    v_cvt_pk_bf16_f32 v34, v20, v21
    v_cvt_pk_bf16_f32 v35, v22, v23
    v_mfma_f32_16x16x32_bf16 a[244:247], a[248:251], v[36:39], a[244:247]
    v_mfma_f32_16x16x32_bf16 v[16:19], a[96:99], a[32:35], 0
    s_waitcnt vmcnt(16) lgkmcnt(0)
    v_fma_f32 v24, v24, s43, v41
    v_fma_f32 v25, v25, s43, v41
    v_mfma_f32_16x16x32_bf16 v[16:19], a[100:103], a[36:39], v[16:19]
    s_barrier
    v_exp_f32 v24, v24
    v_mfma_f32_16x16x32_bf16 v[16:19], a[104:107], a[40:43], v[16:19]
    s_add_u32 s42, s45, 66560
    v_exp_f32 v25, v25
    v_mfma_f32_16x16x32_bf16 v[16:19], a[108:111], a[44:47], v[16:19]
    v_fma_f32 v26, v26, s43, v41
    v_fma_f32 v27, v27, s43, v41
    v_mfma_f32_16x16x32_bf16 v[20:23], a[112:115], a[32:35], 0
    v_exp_f32 v26, v26
    v_add_u32 v46, s42, v48
    v_add_u32 v47, s42, v49
    v_mfma_f32_16x16x32_bf16 v[20:23], a[116:119], a[36:39], v[20:23]
    ds_read_b128 a[128:131], v46
    ds_read_b128 a[132:135], v46 offset:64
    v_mfma_f32_16x16x32_bf16 v[20:23], a[120:123], a[40:43], v[20:23]
    v_exp_f32 v27, v27
    v_mfma_f32_16x16x32_bf16 v[20:23], a[124:127], a[44:47], v[20:23]
    v_fma_f32 v28, v28, s43, v41
    v_fma_f32 v29, v29, s43, v41
    v_mfma_f32_16x16x32_bf16 v[64:67], a[160:163], v[32:35], v[64:67]
    v_exp_f32 v28, v28
    v_mfma_f32_16x16x32_bf16 v[68:71], a[164:167], v[32:35], v[68:71]
    s_mov_b32 m0, s45
    v_exp_f32 v29, v29
    v_mfma_f32_16x16x32_bf16 v[72:75], a[168:171], v[32:35], v[72:75]
    s_add_u32 s40, s59, s49
    v_fma_f32 v30, v30, s43, v41
    v_fma_f32 v31, v31, s43, v41
    v_mfma_f32_16x16x32_bf16 v[76:79], a[172:175], v[32:35], v[76:79]
    buffer_load_dwordx4 v57, s[8:11], s40 offen nt lds
    v_mfma_f32_16x16x32_bf16 v[80:83], a[176:179], v[32:35], v[80:83]
    v_exp_f32 v30, v30
    v_mfma_f32_16x16x32_bf16 v[84:87], a[180:183], v[32:35], v[84:87]
    v_exp_f32 v31, v31
    v_mfma_f32_16x16x32_bf16 v[88:91], a[184:187], v[32:35], v[88:91]
    v_cvt_pk_bf16_f32 v36, v24, v25
    v_cvt_pk_bf16_f32 v37, v26, v27
    v_mfma_f32_16x16x32_bf16 v[92:95], a[188:191], v[32:35], v[92:95]
    v_cvt_pk_bf16_f32 v38, v28, v29
    v_cvt_pk_bf16_f32 v39, v30, v31
    v_mfma_f32_16x16x32_bf16 a[224:227], a[248:251], v[32:35], a[224:227]
    ds_read_b128 a[136:139], v46 offset:128
    ds_read_b128 a[140:143], v46 offset:192
    v_mfma_f32_16x16x32_bf16 v[24:27], a[96:99], a[48:51], 0
    v_fma_f32 v16, v16, s43, v42
    v_fma_f32 v17, v17, s43, v42
    v_mfma_f32_16x16x32_bf16 v[24:27], a[100:103], a[52:55], v[24:27]
    v_exp_f32 v16, v16
    v_mfma_f32_16x16x32_bf16 v[24:27], a[104:107], a[56:59], v[24:27]
    v_exp_f32 v17, v17
    v_mfma_f32_16x16x32_bf16 v[24:27], a[108:111], a[60:63], v[24:27]
    v_fma_f32 v18, v18, s43, v42
    v_fma_f32 v19, v19, s43, v42
    v_mfma_f32_16x16x32_bf16 v[28:31], a[112:115], a[48:51], 0
    v_exp_f32 v18, v18
    v_mfma_f32_16x16x32_bf16 v[28:31], a[116:119], a[52:55], v[28:31]
    ds_read_b128 a[144:147], v46 offset:512
    ds_read_b128 a[148:151], v46 offset:576
    v_mfma_f32_16x16x32_bf16 v[28:31], a[120:123], a[56:59], v[28:31]
    v_exp_f32 v19, v19
    v_mfma_f32_16x16x32_bf16 v[28:31], a[124:127], a[60:63], v[28:31]
    v_fma_f32 v20, v20, s43, v42
    v_fma_f32 v21, v21, s43, v42
    v_mfma_f32_16x16x32_bf16 v[96:99], a[160:163], v[36:39], v[96:99]
    v_exp_f32 v20, v20
    v_mfma_f32_16x16x32_bf16 v[100:103], a[164:167], v[36:39], v[100:103]
    v_exp_f32 v21, v21
    v_mfma_f32_16x16x32_bf16 v[104:107], a[168:171], v[36:39], v[104:107]
    v_fma_f32 v22, v22, s43, v42
    v_fma_f32 v23, v23, s43, v42
    v_mfma_f32_16x16x32_bf16 v[108:111], a[172:175], v[36:39], v[108:111]
    buffer_load_dwordx4 v57, s[12:15], s40 offen offset:1024 nt lds
    v_mfma_f32_16x16x32_bf16 v[112:115], a[176:179], v[36:39], v[112:115]
    v_exp_f32 v22, v22
    v_mfma_f32_16x16x32_bf16 v[116:119], a[180:183], v[36:39], v[116:119]
    v_exp_f32 v23, v23
    v_mfma_f32_16x16x32_bf16 v[120:123], a[184:187], v[36:39], v[120:123]
    v_cvt_pk_bf16_f32 v32, v16, v17
    v_cvt_pk_bf16_f32 v33, v18, v19
    v_mfma_f32_16x16x32_bf16 v[124:127], a[188:191], v[36:39], v[124:127]
    v_cvt_pk_bf16_f32 v34, v20, v21
    v_cvt_pk_bf16_f32 v35, v22, v23
    v_mfma_f32_16x16x32_bf16 a[228:231], a[248:251], v[36:39], a[228:231]
    ds_read_b128 a[152:155], v46 offset:640
    ds_read_b128 a[156:159], v46 offset:704
    v_mfma_f32_16x16x32_bf16 v[16:19], a[96:99], a[64:67], 0
    v_fma_f32 v24, v24, s43, v43
    v_fma_f32 v25, v25, s43, v43
    v_mfma_f32_16x16x32_bf16 v[16:19], a[100:103], a[68:71], v[16:19]
    v_exp_f32 v24, v24
    v_mfma_f32_16x16x32_bf16 v[16:19], a[104:107], a[72:75], v[16:19]
    v_exp_f32 v25, v25
    v_mfma_f32_16x16x32_bf16 v[16:19], a[108:111], a[76:79], v[16:19]
    v_fma_f32 v26, v26, s43, v43
    v_fma_f32 v27, v27, s43, v43
    v_mfma_f32_16x16x32_bf16 v[20:23], a[112:115], a[64:67], 0
    v_exp_f32 v26, v26
    v_mfma_f32_16x16x32_bf16 v[20:23], a[116:119], a[68:71], v[20:23]
    ds_read_b64_tr_b16 a[192:193], v47
    ds_read_b64_tr_b16 a[194:195], v47 offset:512
    v_mfma_f32_16x16x32_bf16 v[20:23], a[120:123], a[72:75], v[20:23]
    v_exp_f32 v27, v27
    v_mfma_f32_16x16x32_bf16 v[20:23], a[124:127], a[76:79], v[20:23]
    v_fma_f32 v28, v28, s43, v43
    v_fma_f32 v29, v29, s43, v43
    v_mfma_f32_16x16x32_bf16 v[128:131], a[160:163], v[32:35], v[128:131]
    v_exp_f32 v28, v28
    v_mfma_f32_16x16x32_bf16 v[132:135], a[164:167], v[32:35], v[132:135]
    v_exp_f32 v29, v29
    v_mfma_f32_16x16x32_bf16 v[136:139], a[168:171], v[32:35], v[136:139]
    v_fma_f32 v30, v30, s43, v43
    v_fma_f32 v31, v31, s43, v43
    v_mfma_f32_16x16x32_bf16 v[140:143], a[172:175], v[32:35], v[140:143]
    buffer_load_dwordx4 v58, s[8:11], s40 offen offset:2080 nt lds
    v_mfma_f32_16x16x32_bf16 v[144:147], a[176:179], v[32:35], v[144:147]
    v_exp_f32 v30, v30
    v_mfma_f32_16x16x32_bf16 v[148:151], a[180:183], v[32:35], v[148:151]
    v_exp_f32 v31, v31
    v_mfma_f32_16x16x32_bf16 v[152:155], a[184:187], v[32:35], v[152:155]
    v_cvt_pk_bf16_f32 v36, v24, v25
    v_cvt_pk_bf16_f32 v37, v26, v27
    v_mfma_f32_16x16x32_bf16 v[156:159], a[188:191], v[32:35], v[156:159]
    v_cvt_pk_bf16_f32 v38, v28, v29
    v_cvt_pk_bf16_f32 v39, v30, v31
    v_mfma_f32_16x16x32_bf16 a[232:235], a[248:251], v[32:35], a[232:235]
    ds_read_b64_tr_b16 a[196:197], v47 offset:32
    ds_read_b64_tr_b16 a[198:199], v47 offset:544
    v_mfma_f32_16x16x32_bf16 v[24:27], a[96:99], a[80:83], 0
    v_fma_f32 v16, v16, s43, v44
    v_fma_f32 v17, v17, s43, v44
    v_mfma_f32_16x16x32_bf16 v[24:27], a[100:103], a[84:87], v[24:27]
    v_exp_f32 v16, v16
    v_mfma_f32_16x16x32_bf16 v[24:27], a[104:107], a[88:91], v[24:27]
    v_exp_f32 v17, v17
    v_mfma_f32_16x16x32_bf16 v[24:27], a[108:111], a[92:95], v[24:27]
    v_fma_f32 v18, v18, s43, v44
    v_fma_f32 v19, v19, s43, v44
    v_mfma_f32_16x16x32_bf16 v[28:31], a[112:115], a[80:83], 0
    v_exp_f32 v18, v18
    v_mfma_f32_16x16x32_bf16 v[28:31], a[116:119], a[84:87], v[28:31]
    ds_read_b64_tr_b16 a[200:201], v47 offset:64
    ds_read_b64_tr_b16 a[202:203], v47 offset:576
    v_mfma_f32_16x16x32_bf16 v[28:31], a[120:123], a[88:91], v[28:31]
    v_exp_f32 v19, v19
    v_mfma_f32_16x16x32_bf16 v[28:31], a[124:127], a[92:95], v[28:31]
    v_fma_f32 v20, v20, s43, v44
    v_fma_f32 v21, v21, s43, v44
    v_mfma_f32_16x16x32_bf16 v[160:163], a[160:163], v[36:39], v[160:163]
    v_exp_f32 v20, v20
    v_mfma_f32_16x16x32_bf16 v[164:167], a[164:167], v[36:39], v[164:167]
    v_exp_f32 v21, v21
    v_mfma_f32_16x16x32_bf16 v[168:171], a[168:171], v[36:39], v[168:171]
    v_fma_f32 v22, v22, s43, v44
    v_fma_f32 v23, v23, s43, v44
    v_mfma_f32_16x16x32_bf16 v[172:175], a[172:175], v[36:39], v[172:175]
    buffer_load_dwordx4 v58, s[12:15], s40 offen offset:3104 nt lds
    v_mfma_f32_16x16x32_bf16 v[176:179], a[176:179], v[36:39], v[176:179]
    v_exp_f32 v22, v22
    v_mfma_f32_16x16x32_bf16 v[180:183], a[180:183], v[36:39], v[180:183]
    v_exp_f32 v23, v23
    v_mfma_f32_16x16x32_bf16 v[184:187], a[184:187], v[36:39], v[184:187]
    v_cvt_pk_bf16_f32 v32, v16, v17
    v_cvt_pk_bf16_f32 v33, v18, v19
    v_mfma_f32_16x16x32_bf16 v[188:191], a[188:191], v[36:39], v[188:191]
    s_waitcnt lgkmcnt(6)
    v_cvt_pk_bf16_f32 v34, v20, v21
    v_cvt_pk_bf16_f32 v35, v22, v23
    v_mfma_f32_16x16x32_bf16 a[236:239], a[248:251], v[36:39], a[236:239]
    ds_read_b64_tr_b16 a[204:205], v47 offset:96
    ds_read_b64_tr_b16 a[206:207], v47 offset:608
    v_mfma_f32_16x16x32_bf16 v[16:19], a[128:131], a[0:3], 0
    v_fma_f32 v24, v24, s43, v45
    v_fma_f32 v25, v25, s43, v45
    v_mfma_f32_16x16x32_bf16 v[16:19], a[132:135], a[4:7], v[16:19]
    v_exp_f32 v24, v24
    v_mfma_f32_16x16x32_bf16 v[16:19], a[136:139], a[8:11], v[16:19]
    v_exp_f32 v25, v25
    v_mfma_f32_16x16x32_bf16 v[16:19], a[140:143], a[12:15], v[16:19]
    v_fma_f32 v26, v26, s43, v45
    v_fma_f32 v27, v27, s43, v45
    v_mfma_f32_16x16x32_bf16 v[20:23], a[144:147], a[0:3], 0
    v_exp_f32 v26, v26
    v_mfma_f32_16x16x32_bf16 v[20:23], a[148:151], a[4:7], v[20:23]
    ds_read_b64_tr_b16 a[208:209], v47 offset:128
    ds_read_b64_tr_b16 a[210:211], v47 offset:640
    v_mfma_f32_16x16x32_bf16 v[20:23], a[152:155], a[8:11], v[20:23]
    v_exp_f32 v27, v27
    v_mfma_f32_16x16x32_bf16 v[20:23], a[156:159], a[12:15], v[20:23]
    v_fma_f32 v28, v28, s43, v45
    v_fma_f32 v29, v29, s43, v45
    v_mfma_f32_16x16x32_bf16 v[192:195], a[160:163], v[32:35], v[192:195]
    v_exp_f32 v28, v28
    v_mfma_f32_16x16x32_bf16 v[196:199], a[164:167], v[32:35], v[196:199]
    s_add_u32 m0, s45, 16640
    v_exp_f32 v29, v29
    v_mfma_f32_16x16x32_bf16 v[200:203], a[168:171], v[32:35], v[200:203]
    s_add_u32 s40, s40, 8192
    v_fma_f32 v30, v30, s43, v45
    v_fma_f32 v31, v31, s43, v45
    v_mfma_f32_16x16x32_bf16 v[204:207], a[172:175], v[32:35], v[204:207]
    buffer_load_dwordx4 v57, s[8:11], s40 offen nt lds
    v_mfma_f32_16x16x32_bf16 v[208:211], a[176:179], v[32:35], v[208:211]
    v_exp_f32 v30, v30
    v_mfma_f32_16x16x32_bf16 v[212:215], a[180:183], v[32:35], v[212:215]
    v_exp_f32 v31, v31
    v_mfma_f32_16x16x32_bf16 v[216:219], a[184:187], v[32:35], v[216:219]
    v_cvt_pk_bf16_f32 v36, v24, v25
    v_cvt_pk_bf16_f32 v37, v26, v27
    v_mfma_f32_16x16x32_bf16 v[220:223], a[188:191], v[32:35], v[220:223]
    v_cvt_pk_bf16_f32 v38, v28, v29
    v_cvt_pk_bf16_f32 v39, v30, v31
    v_mfma_f32_16x16x32_bf16 a[240:243], a[248:251], v[32:35], a[240:243]
    ds_read_b64_tr_b16 a[212:213], v47 offset:160
    ds_read_b64_tr_b16 a[214:215], v47 offset:672
    v_mfma_f32_16x16x32_bf16 v[24:27], a[128:131], a[16:19], 0
    v_fma_f32 v16, v16, s43, v40
    v_fma_f32 v17, v17, s43, v40
    v_mfma_f32_16x16x32_bf16 v[24:27], a[132:135], a[20:23], v[24:27]
    v_exp_f32 v16, v16
    v_mfma_f32_16x16x32_bf16 v[24:27], a[136:139], a[24:27], v[24:27]
    v_exp_f32 v17, v17
    v_mfma_f32_16x16x32_bf16 v[24:27], a[140:143], a[28:31], v[24:27]
    v_fma_f32 v18, v18, s43, v40
    v_fma_f32 v19, v19, s43, v40
    v_mfma_f32_16x16x32_bf16 v[28:31], a[144:147], a[16:19], 0
    v_exp_f32 v18, v18
    v_mfma_f32_16x16x32_bf16 v[28:31], a[148:151], a[20:23], v[28:31]
    ds_read_b64_tr_b16 a[216:217], v47 offset:192
    ds_read_b64_tr_b16 a[218:219], v47 offset:704
    v_mfma_f32_16x16x32_bf16 v[28:31], a[152:155], a[24:27], v[28:31]
    v_exp_f32 v19, v19
    v_mfma_f32_16x16x32_bf16 v[28:31], a[156:159], a[28:31], v[28:31]
    v_fma_f32 v20, v20, s43, v40
    v_fma_f32 v21, v21, s43, v40
    v_mfma_f32_16x16x32_bf16 v[224:227], a[160:163], v[36:39], v[224:227]
    v_exp_f32 v20, v20
    v_mfma_f32_16x16x32_bf16 v[228:231], a[164:167], v[36:39], v[228:231]
    v_exp_f32 v21, v21
    v_mfma_f32_16x16x32_bf16 v[232:235], a[168:171], v[36:39], v[232:235]
    v_fma_f32 v22, v22, s43, v40
    v_fma_f32 v23, v23, s43, v40
    v_mfma_f32_16x16x32_bf16 v[236:239], a[172:175], v[36:39], v[236:239]
    ds_read_b64_tr_b16 a[220:221], v47 offset:224
    ds_read_b64_tr_b16 a[222:223], v47 offset:736
    v_mfma_f32_16x16x32_bf16 v[240:243], a[176:179], v[36:39], v[240:243]
    v_exp_f32 v22, v22
    v_mfma_f32_16x16x32_bf16 v[244:247], a[180:183], v[36:39], v[244:247]
    v_exp_f32 v23, v23
    v_mfma_f32_16x16x32_bf16 v[248:251], a[184:187], v[36:39], v[248:251]
    buffer_load_dwordx4 v57, s[12:15], s40 offen offset:1024 nt lds
    v_cvt_pk_bf16_f32 v32, v16, v17
    v_cvt_pk_bf16_f32 v33, v18, v19
    v_mfma_f32_16x16x32_bf16 v[252:255], a[188:191], v[36:39], v[252:255]
    v_cvt_pk_bf16_f32 v34, v20, v21
    v_cvt_pk_bf16_f32 v35, v22, v23
    v_mfma_f32_16x16x32_bf16 a[244:247], a[248:251], v[36:39], a[244:247]
    v_mfma_f32_16x16x32_bf16 v[16:19], a[128:131], a[32:35], 0
    s_waitcnt vmcnt(18) lgkmcnt(0)
    v_fma_f32 v24, v24, s43, v41
    v_fma_f32 v25, v25, s43, v41
    v_mfma_f32_16x16x32_bf16 v[16:19], a[132:135], a[36:39], v[16:19]
    s_barrier
    v_exp_f32 v24, v24
    v_mfma_f32_16x16x32_bf16 v[16:19], a[136:139], a[40:43], v[16:19]
    v_exp_f32 v25, v25
    v_mfma_f32_16x16x32_bf16 v[16:19], a[140:143], a[44:47], v[16:19]
    v_fma_f32 v26, v26, s43, v41
    v_fma_f32 v27, v27, s43, v41
    v_mfma_f32_16x16x32_bf16 v[20:23], a[144:147], a[32:35], 0
    v_exp_f32 v26, v26
    v_mfma_f32_16x16x32_bf16 v[20:23], a[148:151], a[36:39], v[20:23]
    ds_read_b128 a[96:99], v46 offset:16640
    ds_read_b128 a[100:103], v46 offset:16704
    v_mfma_f32_16x16x32_bf16 v[20:23], a[152:155], a[40:43], v[20:23]
    v_exp_f32 v27, v27
    v_mfma_f32_16x16x32_bf16 v[20:23], a[156:159], a[44:47], v[20:23]
    v_fma_f32 v28, v28, s43, v41
    v_fma_f32 v29, v29, s43, v41
    v_mfma_f32_16x16x32_bf16 v[64:67], a[192:195], v[32:35], v[64:67]
    v_exp_f32 v28, v28
    v_mfma_f32_16x16x32_bf16 v[68:71], a[196:199], v[32:35], v[68:71]
    v_exp_f32 v29, v29
    v_mfma_f32_16x16x32_bf16 v[72:75], a[200:203], v[32:35], v[72:75]
    v_fma_f32 v30, v30, s43, v41
    v_fma_f32 v31, v31, s43, v41
    v_mfma_f32_16x16x32_bf16 v[76:79], a[204:207], v[32:35], v[76:79]
    buffer_load_dwordx4 v58, s[8:11], s40 offen offset:2080 nt lds
    v_mfma_f32_16x16x32_bf16 v[80:83], a[208:211], v[32:35], v[80:83]
    v_exp_f32 v30, v30
    v_mfma_f32_16x16x32_bf16 v[84:87], a[212:215], v[32:35], v[84:87]
    v_exp_f32 v31, v31
    v_mfma_f32_16x16x32_bf16 v[88:91], a[216:219], v[32:35], v[88:91]
    v_cvt_pk_bf16_f32 v36, v24, v25
    v_cvt_pk_bf16_f32 v37, v26, v27
    v_mfma_f32_16x16x32_bf16 v[92:95], a[220:223], v[32:35], v[92:95]
    v_cvt_pk_bf16_f32 v38, v28, v29
    v_cvt_pk_bf16_f32 v39, v30, v31
    v_mfma_f32_16x16x32_bf16 a[224:227], a[248:251], v[32:35], a[224:227]
    ds_read_b128 a[104:107], v46 offset:16768
    ds_read_b128 a[108:111], v46 offset:16832
    v_mfma_f32_16x16x32_bf16 v[24:27], a[128:131], a[48:51], 0
    v_fma_f32 v16, v16, s43, v42
    v_fma_f32 v17, v17, s43, v42
    v_mfma_f32_16x16x32_bf16 v[24:27], a[132:135], a[52:55], v[24:27]
    v_exp_f32 v16, v16
    v_mfma_f32_16x16x32_bf16 v[24:27], a[136:139], a[56:59], v[24:27]
    v_exp_f32 v17, v17
    v_mfma_f32_16x16x32_bf16 v[24:27], a[140:143], a[60:63], v[24:27]
    v_fma_f32 v18, v18, s43, v42
    v_fma_f32 v19, v19, s43, v42
    v_mfma_f32_16x16x32_bf16 v[28:31], a[144:147], a[48:51], 0
    v_exp_f32 v18, v18
    v_mfma_f32_16x16x32_bf16 v[28:31], a[148:151], a[52:55], v[28:31]
    ds_read_b128 a[112:115], v46 offset:17152
    ds_read_b128 a[116:119], v46 offset:17216
    v_mfma_f32_16x16x32_bf16 v[28:31], a[152:155], a[56:59], v[28:31]
    v_exp_f32 v19, v19
    v_mfma_f32_16x16x32_bf16 v[28:31], a[156:159], a[60:63], v[28:31]
    v_fma_f32 v20, v20, s43, v42
    v_fma_f32 v21, v21, s43, v42
    v_mfma_f32_16x16x32_bf16 v[96:99], a[192:195], v[36:39], v[96:99]
    v_exp_f32 v20, v20
    v_mfma_f32_16x16x32_bf16 v[100:103], a[196:199], v[36:39], v[100:103]
    v_exp_f32 v21, v21
    v_mfma_f32_16x16x32_bf16 v[104:107], a[200:203], v[36:39], v[104:107]
    v_fma_f32 v22, v22, s43, v42
    v_fma_f32 v23, v23, s43, v42
    v_mfma_f32_16x16x32_bf16 v[108:111], a[204:207], v[36:39], v[108:111]
    buffer_load_dwordx4 v58, s[12:15], s40 offen offset:3104 nt lds
    v_mfma_f32_16x16x32_bf16 v[112:115], a[208:211], v[36:39], v[112:115]
    v_exp_f32 v22, v22
    v_mfma_f32_16x16x32_bf16 v[116:119], a[212:215], v[36:39], v[116:119]
    v_exp_f32 v23, v23
    v_mfma_f32_16x16x32_bf16 v[120:123], a[216:219], v[36:39], v[120:123]
    v_cvt_pk_bf16_f32 v32, v16, v17
    v_cvt_pk_bf16_f32 v33, v18, v19
    v_mfma_f32_16x16x32_bf16 v[124:127], a[220:223], v[36:39], v[124:127]
    v_cvt_pk_bf16_f32 v34, v20, v21
    v_cvt_pk_bf16_f32 v35, v22, v23
    v_mfma_f32_16x16x32_bf16 a[228:231], a[248:251], v[36:39], a[228:231]
    ds_read_b128 a[120:123], v46 offset:17280
    ds_read_b128 a[124:127], v46 offset:17344
    v_mfma_f32_16x16x32_bf16 v[16:19], a[128:131], a[64:67], 0
    v_fma_f32 v24, v24, s43, v43
    v_fma_f32 v25, v25, s43, v43
    v_mfma_f32_16x16x32_bf16 v[16:19], a[132:135], a[68:71], v[16:19]
    v_exp_f32 v24, v24
    v_mfma_f32_16x16x32_bf16 v[16:19], a[136:139], a[72:75], v[16:19]
    v_exp_f32 v25, v25
    v_mfma_f32_16x16x32_bf16 v[16:19], a[140:143], a[76:79], v[16:19]
    v_fma_f32 v26, v26, s43, v43
    v_fma_f32 v27, v27, s43, v43
    v_mfma_f32_16x16x32_bf16 v[20:23], a[144:147], a[64:67], 0
    v_exp_f32 v26, v26
    v_mfma_f32_16x16x32_bf16 v[20:23], a[148:151], a[68:71], v[20:23]
    ds_read_b64_tr_b16 a[160:161], v47 offset:16640
    ds_read_b64_tr_b16 a[162:163], v47 offset:17152
    v_mfma_f32_16x16x32_bf16 v[20:23], a[152:155], a[72:75], v[20:23]
    v_exp_f32 v27, v27
    v_mfma_f32_16x16x32_bf16 v[20:23], a[156:159], a[76:79], v[20:23]
    v_fma_f32 v28, v28, s43, v43
    v_fma_f32 v29, v29, s43, v43
    v_mfma_f32_16x16x32_bf16 v[128:131], a[192:195], v[32:35], v[128:131]
    v_exp_f32 v28, v28
    v_mfma_f32_16x16x32_bf16 v[132:135], a[196:199], v[32:35], v[132:135]
    s_add_u32 m0, s45, 33280
    v_exp_f32 v29, v29
    v_mfma_f32_16x16x32_bf16 v[136:139], a[200:203], v[32:35], v[136:139]
    s_add_u32 s40, s59, s50
    v_fma_f32 v30, v30, s43, v43
    v_fma_f32 v31, v31, s43, v43
    v_mfma_f32_16x16x32_bf16 v[140:143], a[204:207], v[32:35], v[140:143]
    buffer_load_dwordx4 v59, s[16:19], s40 offen nt lds
    v_mfma_f32_16x16x32_bf16 v[144:147], a[208:211], v[32:35], v[144:147]
    v_exp_f32 v30, v30
    v_mfma_f32_16x16x32_bf16 v[148:151], a[212:215], v[32:35], v[148:151]
    v_exp_f32 v31, v31
    v_mfma_f32_16x16x32_bf16 v[152:155], a[216:219], v[32:35], v[152:155]
    v_cvt_pk_bf16_f32 v36, v24, v25
    v_cvt_pk_bf16_f32 v37, v26, v27
    v_mfma_f32_16x16x32_bf16 v[156:159], a[220:223], v[32:35], v[156:159]
    v_cvt_pk_bf16_f32 v38, v28, v29
    v_cvt_pk_bf16_f32 v39, v30, v31
    v_mfma_f32_16x16x32_bf16 a[232:235], a[248:251], v[32:35], a[232:235]
    ds_read_b64_tr_b16 a[164:165], v47 offset:16672
    ds_read_b64_tr_b16 a[166:167], v47 offset:17184
    v_mfma_f32_16x16x32_bf16 v[24:27], a[128:131], a[80:83], 0
    v_fma_f32 v16, v16, s43, v44
    v_fma_f32 v17, v17, s43, v44
    v_mfma_f32_16x16x32_bf16 v[24:27], a[132:135], a[84:87], v[24:27]
    v_exp_f32 v16, v16
    v_mfma_f32_16x16x32_bf16 v[24:27], a[136:139], a[88:91], v[24:27]
    v_exp_f32 v17, v17
    v_mfma_f32_16x16x32_bf16 v[24:27], a[140:143], a[92:95], v[24:27]
    v_fma_f32 v18, v18, s43, v44
    v_fma_f32 v19, v19, s43, v44
    v_mfma_f32_16x16x32_bf16 v[28:31], a[144:147], a[80:83], 0
    v_exp_f32 v18, v18
    v_mfma_f32_16x16x32_bf16 v[28:31], a[148:151], a[84:87], v[28:31]
    ds_read_b64_tr_b16 a[168:169], v47 offset:16704
    ds_read_b64_tr_b16 a[170:171], v47 offset:17216
    v_mfma_f32_16x16x32_bf16 v[28:31], a[152:155], a[88:91], v[28:31]
    v_exp_f32 v19, v19
    v_mfma_f32_16x16x32_bf16 v[28:31], a[156:159], a[92:95], v[28:31]
    v_fma_f32 v20, v20, s43, v44
    v_fma_f32 v21, v21, s43, v44
    v_mfma_f32_16x16x32_bf16 v[160:163], a[192:195], v[36:39], v[160:163]
    v_exp_f32 v20, v20
    v_mfma_f32_16x16x32_bf16 v[164:167], a[196:199], v[36:39], v[164:167]
    v_exp_f32 v21, v21
    v_mfma_f32_16x16x32_bf16 v[168:171], a[200:203], v[36:39], v[168:171]
    v_fma_f32 v22, v22, s43, v44
    v_fma_f32 v23, v23, s43, v44
    v_mfma_f32_16x16x32_bf16 v[172:175], a[204:207], v[36:39], v[172:175]
    buffer_load_dwordx4 v59, s[20:23], s40 offen offset:1024 nt lds
    v_mfma_f32_16x16x32_bf16 v[176:179], a[208:211], v[36:39], v[176:179]
    v_exp_f32 v22, v22
    v_mfma_f32_16x16x32_bf16 v[180:183], a[212:215], v[36:39], v[180:183]
    v_exp_f32 v23, v23
    v_mfma_f32_16x16x32_bf16 v[184:187], a[216:219], v[36:39], v[184:187]
    v_cvt_pk_bf16_f32 v32, v16, v17
    v_cvt_pk_bf16_f32 v33, v18, v19
    v_mfma_f32_16x16x32_bf16 v[188:191], a[220:223], v[36:39], v[188:191]
    s_waitcnt lgkmcnt(6)
    v_cvt_pk_bf16_f32 v34, v20, v21
    v_cvt_pk_bf16_f32 v35, v22, v23
    v_mfma_f32_16x16x32_bf16 a[236:239], a[248:251], v[36:39], a[236:239]
Lpad4:
    s_cbranch_execz Lret4
    ds_read_b64_tr_b16 a[172:173], v47 offset:16736
    ds_read_b64_tr_b16 a[174:175], v47 offset:17248
    v_mfma_f32_16x16x32_bf16 v[16:19], a[96:99], a[0:3], 0
    v_fma_f32 v24, v24, s43, v45
    v_fma_f32 v25, v25, s43, v45
    v_mfma_f32_16x16x32_bf16 v[16:19], a[100:103], a[4:7], v[16:19]
    v_exp_f32 v24, v24
    v_mfma_f32_16x16x32_bf16 v[16:19], a[104:107], a[8:11], v[16:19]
    v_exp_f32 v25, v25
    v_mfma_f32_16x16x32_bf16 v[16:19], a[108:111], a[12:15], v[16:19]
    v_fma_f32 v26, v26, s43, v45
    v_fma_f32 v27, v27, s43, v45
    v_mfma_f32_16x16x32_bf16 v[20:23], a[112:115], a[0:3], 0
    v_exp_f32 v26, v26
    v_mfma_f32_16x16x32_bf16 v[20:23], a[116:119], a[4:7], v[20:23]
    ds_read_b64_tr_b16 a[176:177], v47 offset:16768
    ds_read_b64_tr_b16 a[178:179], v47 offset:17280
    v_mfma_f32_16x16x32_bf16 v[20:23], a[120:123], a[8:11], v[20:23]
    v_exp_f32 v27, v27
    v_mfma_f32_16x16x32_bf16 v[20:23], a[124:127], a[12:15], v[20:23]
    v_fma_f32 v28, v28, s43, v45
    v_fma_f32 v29, v29, s43, v45
    v_mfma_f32_16x16x32_bf16 v[192:195], a[192:195], v[32:35], v[192:195]
    v_exp_f32 v28, v28
    v_mfma_f32_16x16x32_bf16 v[196:199], a[196:199], v[32:35], v[196:199]
    v_exp_f32 v29, v29
    v_mfma_f32_16x16x32_bf16 v[200:203], a[200:203], v[32:35], v[200:203]
    v_fma_f32 v30, v30, s43, v45
    v_fma_f32 v31, v31, s43, v45
    v_mfma_f32_16x16x32_bf16 v[204:207], a[204:207], v[32:35], v[204:207]
    buffer_load_dwordx4 v60, s[16:19], s40 offen offset:2080 nt lds
    v_mfma_f32_16x16x32_bf16 v[208:211], a[208:211], v[32:35], v[208:211]
    v_exp_f32 v30, v30
    v_mfma_f32_16x16x32_bf16 v[212:215], a[212:215], v[32:35], v[212:215]
    v_exp_f32 v31, v31
    v_mfma_f32_16x16x32_bf16 v[216:219], a[216:219], v[32:35], v[216:219]
    v_cvt_pk_bf16_f32 v36, v24, v25
    v_cvt_pk_bf16_f32 v37, v26, v27
    v_mfma_f32_16x16x32_bf16 v[220:223], a[220:223], v[32:35], v[220:223]
    v_cvt_pk_bf16_f32 v38, v28, v29
    v_cvt_pk_bf16_f32 v39, v30, v31
    v_mfma_f32_16x16x32_bf16 a[240:243], a[248:251], v[32:35], a[240:243]
    ds_read_b64_tr_b16 a[180:181], v47 offset:16800
    ds_read_b64_tr_b16 a[182:183], v47 offset:17312
    v_mfma_f32_16x16x32_bf16 v[24:27], a[96:99], a[16:19], 0
    v_fma_f32 v16, v16, s43, v40
    v_fma_f32 v17, v17, s43, v40
    v_mfma_f32_16x16x32_bf16 v[24:27], a[100:103], a[20:23], v[24:27]
    v_exp_f32 v16, v16
    v_mfma_f32_16x16x32_bf16 v[24:27], a[104:107], a[24:27], v[24:27]
    v_exp_f32 v17, v17
    v_mfma_f32_16x16x32_bf16 v[24:27], a[108:111], a[28:31], v[24:27]
    v_fma_f32 v18, v18, s43, v40
    v_fma_f32 v19, v19, s43, v40
    v_mfma_f32_16x16x32_bf16 v[28:31], a[112:115], a[16:19], 0
    v_exp_f32 v18, v18
    v_mfma_f32_16x16x32_bf16 v[28:31], a[116:119], a[20:23], v[28:31]
    ds_read_b64_tr_b16 a[184:185], v47 offset:16832
    ds_read_b64_tr_b16 a[186:187], v47 offset:17344
    v_mfma_f32_16x16x32_bf16 v[28:31], a[120:123], a[24:27], v[28:31]
    v_exp_f32 v19, v19
    v_mfma_f32_16x16x32_bf16 v[28:31], a[124:127], a[28:31], v[28:31]
    v_fma_f32 v20, v20, s43, v40
    v_fma_f32 v21, v21, s43, v40
    v_mfma_f32_16x16x32_bf16 v[224:227], a[192:195], v[36:39], v[224:227]
    v_exp_f32 v20, v20
    v_mfma_f32_16x16x32_bf16 v[228:231], a[196:199], v[36:39], v[228:231]
    v_exp_f32 v21, v21
    v_mfma_f32_16x16x32_bf16 v[232:235], a[200:203], v[36:39], v[232:235]
    v_fma_f32 v22, v22, s43, v40
    v_fma_f32 v23, v23, s43, v40
    v_mfma_f32_16x16x32_bf16 v[236:239], a[204:207], v[36:39], v[236:239]
    ds_read_b64_tr_b16 a[188:189], v47 offset:16864
    ds_read_b64_tr_b16 a[190:191], v47 offset:17376
    v_mfma_f32_16x16x32_bf16 v[240:243], a[208:211], v[36:39], v[240:243]
    v_exp_f32 v22, v22
    v_mfma_f32_16x16x32_bf16 v[244:247], a[212:215], v[36:39], v[244:247]
    v_exp_f32 v23, v23
    v_mfma_f32_16x16x32_bf16 v[248:251], a[216:219], v[36:39], v[248:251]
    buffer_load_dwordx4 v60, s[20:23], s40 offen offset:3104 nt lds
    v_cvt_pk_bf16_f32 v32, v16, v17
    v_cvt_pk_bf16_f32 v33, v18, v19
    v_mfma_f32_16x16x32_bf16 v[252:255], a[220:223], v[36:39], v[252:255]
    v_cvt_pk_bf16_f32 v34, v20, v21
    v_cvt_pk_bf16_f32 v35, v22, v23
    v_mfma_f32_16x16x32_bf16 a[244:247], a[248:251], v[36:39], a[244:247]
    v_mfma_f32_16x16x32_bf16 v[16:19], a[96:99], a[32:35], 0
    s_waitcnt vmcnt(20) lgkmcnt(0)
    v_fma_f32 v24, v24, s43, v41
    v_fma_f32 v25, v25, s43, v41
    v_mfma_f32_16x16x32_bf16 v[16:19], a[100:103], a[36:39], v[16:19]
    s_barrier
    v_exp_f32 v24, v24
    v_mfma_f32_16x16x32_bf16 v[16:19], a[104:107], a[40:43], v[16:19]
    v_exp_f32 v25, v25
    v_mfma_f32_16x16x32_bf16 v[16:19], a[108:111], a[44:47], v[16:19]
    v_fma_f32 v26, v26, s43, v41
    v_fma_f32 v27, v27, s43, v41
    v_mfma_f32_16x16x32_bf16 v[20:23], a[112:115], a[32:35], 0
    v_exp_f32 v26, v26
    v_mfma_f32_16x16x32_bf16 v[20:23], a[116:119], a[36:39], v[20:23]
    ds_read_b128 a[128:131], v46 offset:33280
    ds_read_b128 a[132:135], v46 offset:33344
    v_mfma_f32_16x16x32_bf16 v[20:23], a[120:123], a[40:43], v[20:23]
    v_exp_f32 v27, v27
    v_mfma_f32_16x16x32_bf16 v[20:23], a[124:127], a[44:47], v[20:23]
    v_fma_f32 v28, v28, s43, v41
    v_fma_f32 v29, v29, s43, v41
    v_mfma_f32_16x16x32_bf16 v[64:67], a[160:163], v[32:35], v[64:67]
    v_exp_f32 v28, v28
    v_mfma_f32_16x16x32_bf16 v[68:71], a[164:167], v[32:35], v[68:71]
    s_add_u32 m0, s45, 49920
    v_exp_f32 v29, v29
    v_mfma_f32_16x16x32_bf16 v[72:75], a[168:171], v[32:35], v[72:75]
    s_add_u32 s40, s40, 4096
    v_fma_f32 v30, v30, s43, v41
    v_fma_f32 v31, v31, s43, v41
    v_mfma_f32_16x16x32_bf16 v[76:79], a[172:175], v[32:35], v[76:79]
    buffer_load_dwordx4 v59, s[16:19], s40 offen nt lds
    v_mfma_f32_16x16x32_bf16 v[80:83], a[176:179], v[32:35], v[80:83]
    v_exp_f32 v30, v30
    v_mfma_f32_16x16x32_bf16 v[84:87], a[180:183], v[32:35], v[84:87]
    v_exp_f32 v31, v31
    v_mfma_f32_16x16x32_bf16 v[88:91], a[184:187], v[32:35], v[88:91]
    v_cvt_pk_bf16_f32 v36, v24, v25
    v_cvt_pk_bf16_f32 v37, v26, v27
    v_mfma_f32_16x16x32_bf16 v[92:95], a[188:191], v[32:35], v[92:95]
    v_cvt_pk_bf16_f32 v38, v28, v29
    v_cvt_pk_bf16_f32 v39, v30, v31
    v_mfma_f32_16x16x32_bf16 a[224:227], a[248:251], v[32:35], a[224:227]
    ds_read_b128 a[136:139], v46 offset:33408
    ds_read_b128 a[140:143], v46 offset:33472
    v_mfma_f32_16x16x32_bf16 v[24:27], a[96:99], a[48:51], 0
    v_fma_f32 v16, v16, s43, v42
    v_fma_f32 v17, v17, s43, v42
    v_mfma_f32_16x16x32_bf16 v[24:27], a[100:103], a[52:55], v[24:27]
    v_exp_f32 v16, v16
    v_mfma_f32_16x16x32_bf16 v[24:27], a[104:107], a[56:59], v[24:27]
    v_exp_f32 v17, v17
    v_mfma_f32_16x16x32_bf16 v[24:27], a[108:111], a[60:63], v[24:27]
    v_fma_f32 v18, v18, s43, v42
    v_fma_f32 v19, v19, s43, v42
    v_mfma_f32_16x16x32_bf16 v[28:31], a[112:115], a[48:51], 0
    v_exp_f32 v18, v18
    v_mfma_f32_16x16x32_bf16 v[28:31], a[116:119], a[52:55], v[28:31]
    ds_read_b128 a[144:147], v46 offset:33792
    ds_read_b128 a[148:151], v46 offset:33856
    v_mfma_f32_16x16x32_bf16 v[28:31], a[120:123], a[56:59], v[28:31]
    v_exp_f32 v19, v19
    v_mfma_f32_16x16x32_bf16 v[28:31], a[124:127], a[60:63], v[28:31]
    v_fma_f32 v20, v20, s43, v42
    v_fma_f32 v21, v21, s43, v42
    v_mfma_f32_16x16x32_bf16 v[96:99], a[160:163], v[36:39], v[96:99]
    v_exp_f32 v20, v20
    v_mfma_f32_16x16x32_bf16 v[100:103], a[164:167], v[36:39], v[100:103]
    v_exp_f32 v21, v21
    v_mfma_f32_16x16x32_bf16 v[104:107], a[168:171], v[36:39], v[104:107]
    v_fma_f32 v22, v22, s43, v42
    v_fma_f32 v23, v23, s43, v42
    v_mfma_f32_16x16x32_bf16 v[108:111], a[172:175], v[36:39], v[108:111]
    buffer_load_dwordx4 v59, s[20:23], s40 offen offset:1024 nt lds
    v_mfma_f32_16x16x32_bf16 v[112:115], a[176:179], v[36:39], v[112:115]
    v_exp_f32 v22, v22
    v_mfma_f32_16x16x32_bf16 v[116:119], a[180:183], v[36:39], v[116:119]
    v_exp_f32 v23, v23
    v_mfma_f32_16x16x32_bf16 v[120:123], a[184:187], v[36:39], v[120:123]
    v_cvt_pk_bf16_f32 v32, v16, v17
    v_cvt_pk_bf16_f32 v33, v18, v19
    v_mfma_f32_16x16x32_bf16 v[124:127], a[188:191], v[36:39], v[124:127]
    v_cvt_pk_bf16_f32 v34, v20, v21
    v_cvt_pk_bf16_f32 v35, v22, v23
    v_mfma_f32_16x16x32_bf16 a[228:231], a[248:251], v[36:39], a[228:231]
    ds_read_b128 a[152:155], v46 offset:33920
    ds_read_b128 a[156:159], v46 offset:33984
    v_mfma_f32_16x16x32_bf16 v[16:19], a[96:99], a[64:67], 0
    v_fma_f32 v24, v24, s43, v43
    v_fma_f32 v25, v25, s43, v43
    v_mfma_f32_16x16x32_bf16 v[16:19], a[100:103], a[68:71], v[16:19]
    v_exp_f32 v24, v24
    v_mfma_f32_16x16x32_bf16 v[16:19], a[104:107], a[72:75], v[16:19]
    v_exp_f32 v25, v25
    v_mfma_f32_16x16x32_bf16 v[16:19], a[108:111], a[76:79], v[16:19]
    v_fma_f32 v26, v26, s43, v43
    v_fma_f32 v27, v27, s43, v43
    v_mfma_f32_16x16x32_bf16 v[20:23], a[112:115], a[64:67], 0
    v_exp_f32 v26, v26
    v_mfma_f32_16x16x32_bf16 v[20:23], a[116:119], a[68:71], v[20:23]
    ds_read_b64_tr_b16 a[192:193], v47 offset:33280
    ds_read_b64_tr_b16 a[194:195], v47 offset:33792
    v_mfma_f32_16x16x32_bf16 v[20:23], a[120:123], a[72:75], v[20:23]
    v_exp_f32 v27, v27
    v_mfma_f32_16x16x32_bf16 v[20:23], a[124:127], a[76:79], v[20:23]
    v_fma_f32 v28, v28, s43, v43
    v_fma_f32 v29, v29, s43, v43
    v_mfma_f32_16x16x32_bf16 v[128:131], a[160:163], v[32:35], v[128:131]
    v_exp_f32 v28, v28
    v_mfma_f32_16x16x32_bf16 v[132:135], a[164:167], v[32:35], v[132:135]
    v_exp_f32 v29, v29
    v_mfma_f32_16x16x32_bf16 v[136:139], a[168:171], v[32:35], v[136:139]
    v_fma_f32 v30, v30, s43, v43
    v_fma_f32 v31, v31, s43, v43
    v_mfma_f32_16x16x32_bf16 v[140:143], a[172:175], v[32:35], v[140:143]
    buffer_load_dwordx4 v60, s[16:19], s40 offen offset:2080 nt lds
    v_mfma_f32_16x16x32_bf16 v[144:147], a[176:179], v[32:35], v[144:147]
    v_exp_f32 v30, v30
    v_mfma_f32_16x16x32_bf16 v[148:151], a[180:183], v[32:35], v[148:151]
    v_exp_f32 v31, v31
    v_mfma_f32_16x16x32_bf16 v[152:155], a[184:187], v[32:35], v[152:155]
    v_cvt_pk_bf16_f32 v36, v24, v25
    v_cvt_pk_bf16_f32 v37, v26, v27
    v_mfma_f32_16x16x32_bf16 v[156:159], a[188:191], v[32:35], v[156:159]
    v_cvt_pk_bf16_f32 v38, v28, v29
    v_cvt_pk_bf16_f32 v39, v30, v31
    v_mfma_f32_16x16x32_bf16 a[232:235], a[248:251], v[32:35], a[232:235]
    ds_read_b64_tr_b16 a[196:197], v47 offset:33312
    ds_read_b64_tr_b16 a[198:199], v47 offset:33824
    v_mfma_f32_16x16x32_bf16 v[24:27], a[96:99], a[80:83], 0
    v_fma_f32 v16, v16, s43, v44
    v_fma_f32 v17, v17, s43, v44
    v_mfma_f32_16x16x32_bf16 v[24:27], a[100:103], a[84:87], v[24:27]
    v_exp_f32 v16, v16
    v_mfma_f32_16x16x32_bf16 v[24:27], a[104:107], a[88:91], v[24:27]
    v_exp_f32 v17, v17
    v_mfma_f32_16x16x32_bf16 v[24:27], a[108:111], a[92:95], v[24:27]
    v_fma_f32 v18, v18, s43, v44
    v_fma_f32 v19, v19, s43, v44
    v_mfma_f32_16x16x32_bf16 v[28:31], a[112:115], a[80:83], 0
    v_exp_f32 v18, v18
    v_mfma_f32_16x16x32_bf16 v[28:31], a[116:119], a[84:87], v[28:31]
    ds_read_b64_tr_b16 a[200:201], v47 offset:33344
    ds_read_b64_tr_b16 a[202:203], v47 offset:33856
    v_mfma_f32_16x16x32_bf16 v[28:31], a[120:123], a[88:91], v[28:31]
    v_exp_f32 v19, v19
    v_mfma_f32_16x16x32_bf16 v[28:31], a[124:127], a[92:95], v[28:31]
    v_fma_f32 v20, v20, s43, v44
    v_fma_f32 v21, v21, s43, v44
    v_mfma_f32_16x16x32_bf16 v[160:163], a[160:163], v[36:39], v[160:163]
    v_exp_f32 v20, v20
    v_mfma_f32_16x16x32_bf16 v[164:167], a[164:167], v[36:39], v[164:167]
    v_exp_f32 v21, v21
    v_mfma_f32_16x16x32_bf16 v[168:171], a[168:171], v[36:39], v[168:171]
    v_fma_f32 v22, v22, s43, v44
    v_fma_f32 v23, v23, s43, v44
    v_mfma_f32_16x16x32_bf16 v[172:175], a[172:175], v[36:39], v[172:175]
    buffer_load_dwordx4 v60, s[20:23], s40 offen offset:3104 nt lds
    v_mfma_f32_16x16x32_bf16 v[176:179], a[176:179], v[36:39], v[176:179]
    v_exp_f32 v22, v22
    v_mfma_f32_16x16x32_bf16 v[180:183], a[180:183], v[36:39], v[180:183]
    v_exp_f32 v23, v23
    v_mfma_f32_16x16x32_bf16 v[184:187], a[184:187], v[36:39], v[184:187]
    v_cvt_pk_bf16_f32 v32, v16, v17
    v_cvt_pk_bf16_f32 v33, v18, v19
    v_mfma_f32_16x16x32_bf16 v[188:191], a[188:191], v[36:39], v[188:191]
    s_waitcnt lgkmcnt(6)
    v_cvt_pk_bf16_f32 v34, v20, v21
    v_cvt_pk_bf16_f32 v35, v22, v23
    v_mfma_f32_16x16x32_bf16 a[236:239], a[248:251], v[36:39], a[236:239]
    ds_read_b64_tr_b16 a[204:205], v47 offset:33376
    ds_read_b64_tr_b16 a[206:207], v47 offset:33888
    v_mfma_f32_16x16x32_bf16 v[16:19], a[128:131], a[0:3], 0
    v_fma_f32 v24, v24, s43, v45
    v_fma_f32 v25, v25, s43, v45
    v_mfma_f32_16x16x32_bf16 v[16:19], a[132:135], a[4:7], v[16:19]
    v_exp_f32 v24, v24
    v_mfma_f32_16x16x32_bf16 v[16:19], a[136:139], a[8:11], v[16:19]
    v_exp_f32 v25, v25
    v_mfma_f32_16x16x32_bf16 v[16:19], a[140:143], a[12:15], v[16:19]
    v_fma_f32 v26, v26, s43, v45
    v_fma_f32 v27, v27, s43, v45
    v_mfma_f32_16x16x32_bf16 v[20:23], a[144:147], a[0:3], 0
    v_exp_f32 v26, v26
    v_mfma_f32_16x16x32_bf16 v[20:23], a[148:151], a[4:7], v[20:23]
    ds_read_b64_tr_b16 a[208:209], v47 offset:33408
    ds_read_b64_tr_b16 a[210:211], v47 offset:33920
    v_mfma_f32_16x16x32_bf16 v[20:23], a[152:155], a[8:11], v[20:23]
    v_exp_f32 v27, v27
    v_mfma_f32_16x16x32_bf16 v[20:23], a[156:159], a[12:15], v[20:23]
    v_fma_f32 v28, v28, s43, v45
    v_fma_f32 v29, v29, s43, v45
    v_mfma_f32_16x16x32_bf16 v[192:195], a[160:163], v[32:35], v[192:195]
    v_exp_f32 v28, v28
    v_mfma_f32_16x16x32_bf16 v[196:199], a[164:167], v[32:35], v[196:199]
    s_add_u32 m0, s45, 66560
    v_exp_f32 v29, v29
    v_mfma_f32_16x16x32_bf16 v[200:203], a[168:171], v[32:35], v[200:203]
    s_add_u32 s40, s40, 4096
    v_fma_f32 v30, v30, s43, v45
    v_fma_f32 v31, v31, s43, v45
    v_mfma_f32_16x16x32_bf16 v[204:207], a[172:175], v[32:35], v[204:207]
    buffer_load_dwordx4 v59, s[16:19], s40 offen nt lds
    v_mfma_f32_16x16x32_bf16 v[208:211], a[176:179], v[32:35], v[208:211]
    v_exp_f32 v30, v30
    v_mfma_f32_16x16x32_bf16 v[212:215], a[180:183], v[32:35], v[212:215]
    v_exp_f32 v31, v31
    v_mfma_f32_16x16x32_bf16 v[216:219], a[184:187], v[32:35], v[216:219]
    v_cvt_pk_bf16_f32 v36, v24, v25
    v_cvt_pk_bf16_f32 v37, v26, v27
    v_mfma_f32_16x16x32_bf16 v[220:223], a[188:191], v[32:35], v[220:223]
    v_cvt_pk_bf16_f32 v38, v28, v29
    v_cvt_pk_bf16_f32 v39, v30, v31
    v_mfma_f32_16x16x32_bf16 a[240:243], a[248:251], v[32:35], a[240:243]
    ds_read_b64_tr_b16 a[212:213], v47 offset:33440
    ds_read_b64_tr_b16 a[214:215], v47 offset:33952
    v_mfma_f32_16x16x32_bf16 v[24:27], a[128:131], a[16:19], 0
    v_fma_f32 v16, v16, s43, v40
    v_fma_f32 v17, v17, s43, v40
    v_mfma_f32_16x16x32_bf16 v[24:27], a[132:135], a[20:23], v[24:27]
    v_exp_f32 v16, v16
    v_mfma_f32_16x16x32_bf16 v[24:27], a[136:139], a[24:27], v[24:27]
    v_exp_f32 v17, v17
    v_mfma_f32_16x16x32_bf16 v[24:27], a[140:143], a[28:31], v[24:27]
    v_fma_f32 v18, v18, s43, v40
    v_fma_f32 v19, v19, s43, v40
    v_mfma_f32_16x16x32_bf16 v[28:31], a[144:147], a[16:19], 0
    v_exp_f32 v18, v18
    v_mfma_f32_16x16x32_bf16 v[28:31], a[148:151], a[20:23], v[28:31]
    ds_read_b64_tr_b16 a[216:217], v47 offset:33472
    ds_read_b64_tr_b16 a[218:219], v47 offset:33984
    v_mfma_f32_16x16x32_bf16 v[28:31], a[152:155], a[24:27], v[28:31]
    v_exp_f32 v19, v19
    v_mfma_f32_16x16x32_bf16 v[28:31], a[156:159], a[28:31], v[28:31]
    v_fma_f32 v20, v20, s43, v40
    v_fma_f32 v21, v21, s43, v40
    v_mfma_f32_16x16x32_bf16 v[224:227], a[160:163], v[36:39], v[224:227]
    v_exp_f32 v20, v20
    v_mfma_f32_16x16x32_bf16 v[228:231], a[164:167], v[36:39], v[228:231]
    v_exp_f32 v21, v21
    v_mfma_f32_16x16x32_bf16 v[232:235], a[168:171], v[36:39], v[232:235]
    v_fma_f32 v22, v22, s43, v40
    v_fma_f32 v23, v23, s43, v40
    v_mfma_f32_16x16x32_bf16 v[236:239], a[172:175], v[36:39], v[236:239]
    ds_read_b64_tr_b16 a[220:221], v47 offset:33504
    ds_read_b64_tr_b16 a[222:223], v47 offset:34016
    v_mfma_f32_16x16x32_bf16 v[240:243], a[176:179], v[36:39], v[240:243]
    v_exp_f32 v22, v22
    v_mfma_f32_16x16x32_bf16 v[244:247], a[180:183], v[36:39], v[244:247]
    v_exp_f32 v23, v23
    v_mfma_f32_16x16x32_bf16 v[248:251], a[184:187], v[36:39], v[248:251]
    buffer_load_dwordx4 v59, s[20:23], s40 offen offset:1024 nt lds
    v_cvt_pk_bf16_f32 v32, v16, v17
    v_cvt_pk_bf16_f32 v33, v18, v19
    v_mfma_f32_16x16x32_bf16 v[252:255], a[188:191], v[36:39], v[252:255]
    v_cvt_pk_bf16_f32 v34, v20, v21
    v_cvt_pk_bf16_f32 v35, v22, v23
    v_mfma_f32_16x16x32_bf16 a[244:247], a[248:251], v[36:39], a[244:247]
    v_mfma_f32_16x16x32_bf16 v[16:19], a[128:131], a[32:35], 0
    s_waitcnt vmcnt(22) lgkmcnt(0)
    v_fma_f32 v24, v24, s43, v41
    v_fma_f32 v25, v25, s43, v41
    v_mfma_f32_16x16x32_bf16 v[16:19], a[132:135], a[36:39], v[16:19]
    s_barrier
    v_exp_f32 v24, v24
    v_mfma_f32_16x16x32_bf16 v[16:19], a[136:139], a[40:43], v[16:19]
    v_exp_f32 v25, v25
    v_mfma_f32_16x16x32_bf16 v[16:19], a[140:143], a[44:47], v[16:19]
    v_fma_f32 v26, v26, s43, v41
    v_fma_f32 v27, v27, s43, v41
    v_mfma_f32_16x16x32_bf16 v[20:23], a[144:147], a[32:35], 0
    v_exp_f32 v26, v26
    v_mfma_f32_16x16x32_bf16 v[20:23], a[148:151], a[36:39], v[20:23]
    ds_read_b128 a[96:99], v46 offset:49920
    ds_read_b128 a[100:103], v46 offset:49984
    v_mfma_f32_16x16x32_bf16 v[20:23], a[152:155], a[40:43], v[20:23]
    v_exp_f32 v27, v27
    v_mfma_f32_16x16x32_bf16 v[20:23], a[156:159], a[44:47], v[20:23]
    v_fma_f32 v28, v28, s43, v41
    v_fma_f32 v29, v29, s43, v41
    v_mfma_f32_16x16x32_bf16 v[64:67], a[192:195], v[32:35], v[64:67]
    v_exp_f32 v28, v28
    v_mfma_f32_16x16x32_bf16 v[68:71], a[196:199], v[32:35], v[68:71]
    v_exp_f32 v29, v29
    v_mfma_f32_16x16x32_bf16 v[72:75], a[200:203], v[32:35], v[72:75]
    v_fma_f32 v30, v30, s43, v41
    v_fma_f32 v31, v31, s43, v41
    v_mfma_f32_16x16x32_bf16 v[76:79], a[204:207], v[32:35], v[76:79]
    buffer_load_dwordx4 v60, s[16:19], s40 offen offset:2080 nt lds
    v_mfma_f32_16x16x32_bf16 v[80:83], a[208:211], v[32:35], v[80:83]
    v_exp_f32 v30, v30
    v_mfma_f32_16x16x32_bf16 v[84:87], a[212:215], v[32:35], v[84:87]
    v_exp_f32 v31, v31
    v_mfma_f32_16x16x32_bf16 v[88:91], a[216:219], v[32:35], v[88:91]
    v_cvt_pk_bf16_f32 v36, v24, v25
    v_cvt_pk_bf16_f32 v37, v26, v27
    v_mfma_f32_16x16x32_bf16 v[92:95], a[220:223], v[32:35], v[92:95]
    v_cvt_pk_bf16_f32 v38, v28, v29
    v_cvt_pk_bf16_f32 v39, v30, v31
    v_mfma_f32_16x16x32_bf16 a[224:227], a[248:251], v[32:35], a[224:227]
    ds_read_b128 a[104:107], v46 offset:50048
    ds_read_b128 a[108:111], v46 offset:50112
    v_mfma_f32_16x16x32_bf16 v[24:27], a[128:131], a[48:51], 0
    v_fma_f32 v16, v16, s43, v42
    v_fma_f32 v17, v17, s43, v42
    v_mfma_f32_16x16x32_bf16 v[24:27], a[132:135], a[52:55], v[24:27]
    v_exp_f32 v16, v16
    v_mfma_f32_16x16x32_bf16 v[24:27], a[136:139], a[56:59], v[24:27]
    v_exp_f32 v17, v17
    v_mfma_f32_16x16x32_bf16 v[24:27], a[140:143], a[60:63], v[24:27]
    v_fma_f32 v18, v18, s43, v42
    v_fma_f32 v19, v19, s43, v42
    v_mfma_f32_16x16x32_bf16 v[28:31], a[144:147], a[48:51], 0
    v_exp_f32 v18, v18
    v_mfma_f32_16x16x32_bf16 v[28:31], a[148:151], a[52:55], v[28:31]
    ds_read_b128 a[112:115], v46 offset:50432
    ds_read_b128 a[116:119], v46 offset:50496
    v_mfma_f32_16x16x32_bf16 v[28:31], a[152:155], a[56:59], v[28:31]
    v_exp_f32 v19, v19
    v_mfma_f32_16x16x32_bf16 v[28:31], a[156:159], a[60:63], v[28:31]
    v_fma_f32 v20, v20, s43, v42
    v_fma_f32 v21, v21, s43, v42
    v_mfma_f32_16x16x32_bf16 v[96:99], a[192:195], v[36:39], v[96:99]
    v_exp_f32 v20, v20
    v_mfma_f32_16x16x32_bf16 v[100:103], a[196:199], v[36:39], v[100:103]
    v_exp_f32 v21, v21
    v_mfma_f32_16x16x32_bf16 v[104:107], a[200:203], v[36:39], v[104:107]
    v_fma_f32 v22, v22, s43, v42
    v_fma_f32 v23, v23, s43, v42
    v_mfma_f32_16x16x32_bf16 v[108:111], a[204:207], v[36:39], v[108:111]
    buffer_load_dwordx4 v60, s[20:23], s40 offen offset:3104 nt lds
    v_mfma_f32_16x16x32_bf16 v[112:115], a[208:211], v[36:39], v[112:115]
    v_exp_f32 v22, v22
    v_mfma_f32_16x16x32_bf16 v[116:119], a[212:215], v[36:39], v[116:119]
    v_exp_f32 v23, v23
    v_mfma_f32_16x16x32_bf16 v[120:123], a[216:219], v[36:39], v[120:123]
    v_cvt_pk_bf16_f32 v32, v16, v17
    v_cvt_pk_bf16_f32 v33, v18, v19
    v_mfma_f32_16x16x32_bf16 v[124:127], a[220:223], v[36:39], v[124:127]
    v_cvt_pk_bf16_f32 v34, v20, v21
    v_cvt_pk_bf16_f32 v35, v22, v23
    v_mfma_f32_16x16x32_bf16 a[228:231], a[248:251], v[36:39], a[228:231]
    ds_read_b128 a[120:123], v46 offset:50560
    ds_read_b128 a[124:127], v46 offset:50624
    v_mfma_f32_16x16x32_bf16 v[16:19], a[128:131], a[64:67], 0
    v_fma_f32 v24, v24, s43, v43
    v_fma_f32 v25, v25, s43, v43
    v_mfma_f32_16x16x32_bf16 v[16:19], a[132:135], a[68:71], v[16:19]
    v_exp_f32 v24, v24
    v_mfma_f32_16x16x32_bf16 v[16:19], a[136:139], a[72:75], v[16:19]
    v_exp_f32 v25, v25
    v_mfma_f32_16x16x32_bf16 v[16:19], a[140:143], a[76:79], v[16:19]
    v_fma_f32 v26, v26, s43, v43
    v_fma_f32 v27, v27, s43, v43
    v_mfma_f32_16x16x32_bf16 v[20:23], a[144:147], a[64:67], 0
    v_exp_f32 v26, v26
    v_mfma_f32_16x16x32_bf16 v[20:23], a[148:151], a[68:71], v[20:23]
    ds_read_b64_tr_b16 a[160:161], v47 offset:49920
    ds_read_b64_tr_b16 a[162:163], v47 offset:50432
    v_mfma_f32_16x16x32_bf16 v[20:23], a[152:155], a[72:75], v[20:23]
    v_exp_f32 v27, v27
    v_mfma_f32_16x16x32_bf16 v[20:23], a[156:159], a[76:79], v[20:23]
    v_fma_f32 v28, v28, s43, v43
    v_fma_f32 v29, v29, s43, v43
    v_mfma_f32_16x16x32_bf16 v[128:131], a[192:195], v[32:35], v[128:131]
    v_exp_f32 v28, v28
    v_mfma_f32_16x16x32_bf16 v[132:135], a[196:199], v[32:35], v[132:135]
    s_add_u32 m0, s45, 83200
    v_exp_f32 v29, v29
    v_mfma_f32_16x16x32_bf16 v[136:139], a[200:203], v[32:35], v[136:139]
    s_add_u32 s40, s40, 4096
    v_fma_f32 v30, v30, s43, v43
    v_fma_f32 v31, v31, s43, v43
    v_mfma_f32_16x16x32_bf16 v[140:143], a[204:207], v[32:35], v[140:143]
    buffer_load_dwordx4 v59, s[16:19], s40 offen nt lds
    v_mfma_f32_16x16x32_bf16 v[144:147], a[208:211], v[32:35], v[144:147]
    v_exp_f32 v30, v30
    v_mfma_f32_16x16x32_bf16 v[148:151], a[212:215], v[32:35], v[148:151]
    v_exp_f32 v31, v31
    v_mfma_f32_16x16x32_bf16 v[152:155], a[216:219], v[32:35], v[152:155]
    v_cvt_pk_bf16_f32 v36, v24, v25
    v_cvt_pk_bf16_f32 v37, v26, v27
    v_mfma_f32_16x16x32_bf16 v[156:159], a[220:223], v[32:35], v[156:159]
    v_cvt_pk_bf16_f32 v38, v28, v29
    v_cvt_pk_bf16_f32 v39, v30, v31
    v_mfma_f32_16x16x32_bf16 a[232:235], a[248:251], v[32:35], a[232:235]
    ds_read_b64_tr_b16 a[164:165], v47 offset:49952
    ds_read_b64_tr_b16 a[166:167], v47 offset:50464
    v_mfma_f32_16x16x32_bf16 v[24:27], a[128:131], a[80:83], 0
    v_fma_f32 v16, v16, s43, v44
    v_fma_f32 v17, v17, s43, v44
    v_mfma_f32_16x16x32_bf16 v[24:27], a[132:135], a[84:87], v[24:27]
    v_exp_f32 v16, v16
    v_mfma_f32_16x16x32_bf16 v[24:27], a[136:139], a[88:91], v[24:27]
    v_exp_f32 v17, v17
    v_mfma_f32_16x16x32_bf16 v[24:27], a[140:143], a[92:95], v[24:27]
    v_fma_f32 v18, v18, s43, v44
    v_fma_f32 v19, v19, s43, v44
    v_mfma_f32_16x16x32_bf16 v[28:31], a[144:147], a[80:83], 0
    v_exp_f32 v18, v18
    v_mfma_f32_16x16x32_bf16 v[28:31], a[148:151], a[84:87], v[28:31]
    ds_read_b64_tr_b16 a[168:169], v47 offset:49984
    ds_read_b64_tr_b16 a[170:171], v47 offset:50496
    v_mfma_f32_16x16x32_bf16 v[28:31], a[152:155], a[88:91], v[28:31]
    v_exp_f32 v19, v19
    v_mfma_f32_16x16x32_bf16 v[28:31], a[156:159], a[92:95], v[28:31]
    v_fma_f32 v20, v20, s43, v44
    v_fma_f32 v21, v21, s43, v44
    v_mfma_f32_16x16x32_bf16 v[160:163], a[192:195], v[36:39], v[160:163]
    v_exp_f32 v20, v20
    v_mfma_f32_16x16x32_bf16 v[164:167], a[196:199], v[36:39], v[164:167]
    v_exp_f32 v21, v21
    v_mfma_f32_16x16x32_bf16 v[168:171], a[200:203], v[36:39], v[168:171]
    v_fma_f32 v22, v22, s43, v44
    v_fma_f32 v23, v23, s43, v44
    v_mfma_f32_16x16x32_bf16 v[172:175], a[204:207], v[36:39], v[172:175]
    buffer_load_dwordx4 v59, s[20:23], s40 offen offset:1024 nt lds
    v_mfma_f32_16x16x32_bf16 v[176:179], a[208:211], v[36:39], v[176:179]
    v_exp_f32 v22, v22
    v_mfma_f32_16x16x32_bf16 v[180:183], a[212:215], v[36:39], v[180:183]
    v_exp_f32 v23, v23
    v_mfma_f32_16x16x32_bf16 v[184:187], a[216:219], v[36:39], v[184:187]
    v_cvt_pk_bf16_f32 v32, v16, v17
    v_cvt_pk_bf16_f32 v33, v18, v19
    v_mfma_f32_16x16x32_bf16 v[188:191], a[220:223], v[36:39], v[188:191]
    s_waitcnt lgkmcnt(6)
    v_cvt_pk_bf16_f32 v34, v20, v21
    v_cvt_pk_bf16_f32 v35, v22, v23
    v_mfma_f32_16x16x32_bf16 a[236:239], a[248:251], v[36:39], a[236:239]
    ds_read_b64_tr_b16 a[172:173], v47 offset:50016
    ds_read_b64_tr_b16 a[174:175], v47 offset:50528
    v_mfma_f32_16x16x32_bf16 v[16:19], a[96:99], a[0:3], 0
    v_fma_f32 v24, v24, s43, v45
    v_fma_f32 v25, v25, s43, v45
    v_mfma_f32_16x16x32_bf16 v[16:19], a[100:103], a[4:7], v[16:19]
    v_exp_f32 v24, v24
    v_mfma_f32_16x16x32_bf16 v[16:19], a[104:107], a[8:11], v[16:19]
    v_exp_f32 v25, v25
    v_mfma_f32_16x16x32_bf16 v[16:19], a[108:111], a[12:15], v[16:19]
    v_fma_f32 v26, v26, s43, v45
    v_fma_f32 v27, v27, s43, v45
    v_mfma_f32_16x16x32_bf16 v[20:23], a[112:115], a[0:3], 0
    v_exp_f32 v26, v26
    v_mfma_f32_16x16x32_bf16 v[20:23], a[116:119], a[4:7], v[20:23]
    ds_read_b64_tr_b16 a[176:177], v47 offset:50048
    ds_read_b64_tr_b16 a[178:179], v47 offset:50560
    v_mfma_f32_16x16x32_bf16 v[20:23], a[120:123], a[8:11], v[20:23]
    v_exp_f32 v27, v27
    v_mfma_f32_16x16x32_bf16 v[20:23], a[124:127], a[12:15], v[20:23]
    v_fma_f32 v28, v28, s43, v45
    v_fma_f32 v29, v29, s43, v45
    v_mfma_f32_16x16x32_bf16 v[192:195], a[192:195], v[32:35], v[192:195]
    v_exp_f32 v28, v28
    v_mfma_f32_16x16x32_bf16 v[196:199], a[196:199], v[32:35], v[196:199]
    v_exp_f32 v29, v29
    v_mfma_f32_16x16x32_bf16 v[200:203], a[200:203], v[32:35], v[200:203]
    v_fma_f32 v30, v30, s43, v45
    v_fma_f32 v31, v31, s43, v45
    v_mfma_f32_16x16x32_bf16 v[204:207], a[204:207], v[32:35], v[204:207]
    buffer_load_dwordx4 v60, s[16:19], s40 offen offset:2080 nt lds
    v_mfma_f32_16x16x32_bf16 v[208:211], a[208:211], v[32:35], v[208:211]
    v_exp_f32 v30, v30
    v_mfma_f32_16x16x32_bf16 v[212:215], a[212:215], v[32:35], v[212:215]
    v_exp_f32 v31, v31
    v_mfma_f32_16x16x32_bf16 v[216:219], a[216:219], v[32:35], v[216:219]
    v_cvt_pk_bf16_f32 v36, v24, v25
    v_cvt_pk_bf16_f32 v37, v26, v27
    v_mfma_f32_16x16x32_bf16 v[220:223], a[220:223], v[32:35], v[220:223]
    v_cvt_pk_bf16_f32 v38, v28, v29
    v_cvt_pk_bf16_f32 v39, v30, v31
    v_mfma_f32_16x16x32_bf16 a[240:243], a[248:251], v[32:35], a[240:243]
    ds_read_b64_tr_b16 a[180:181], v47 offset:50080
    ds_read_b64_tr_b16 a[182:183], v47 offset:50592
    v_mfma_f32_16x16x32_bf16 v[24:27], a[96:99], a[16:19], 0
    v_fma_f32 v16, v16, s43, v40
    v_fma_f32 v17, v17, s43, v40
    v_mfma_f32_16x16x32_bf16 v[24:27], a[100:103], a[20:23], v[24:27]
    v_exp_f32 v16, v16
    v_mfma_f32_16x16x32_bf16 v[24:27], a[104:107], a[24:27], v[24:27]
Lpad5:
    s_cbranch_execz Lret5
    v_exp_f32 v17, v17
    v_mfma_f32_16x16x32_bf16 v[24:27], a[108:111], a[28:31], v[24:27]
    v_fma_f32 v18, v18, s43, v40
    v_fma_f32 v19, v19, s43, v40
    v_mfma_f32_16x16x32_bf16 v[28:31], a[112:115], a[16:19], 0
    v_exp_f32 v18, v18
    v_mfma_f32_16x16x32_bf16 v[28:31], a[116:119], a[20:23], v[28:31]
    ds_read_b64_tr_b16 a[184:185], v47 offset:50112
    ds_read_b64_tr_b16 a[186:187], v47 offset:50624
    v_mfma_f32_16x16x32_bf16 v[28:31], a[120:123], a[24:27], v[28:31]
    v_exp_f32 v19, v19
    v_mfma_f32_16x16x32_bf16 v[28:31], a[124:127], a[28:31], v[28:31]
    v_fma_f32 v20, v20, s43, v40
    v_fma_f32 v21, v21, s43, v40
    v_mfma_f32_16x16x32_bf16 v[224:227], a[192:195], v[36:39], v[224:227]
    v_exp_f32 v20, v20
    v_mfma_f32_16x16x32_bf16 v[228:231], a[196:199], v[36:39], v[228:231]
    v_exp_f32 v21, v21
    v_mfma_f32_16x16x32_bf16 v[232:235], a[200:203], v[36:39], v[232:235]
    v_fma_f32 v22, v22, s43, v40
    v_fma_f32 v23, v23, s43, v40
    v_mfma_f32_16x16x32_bf16 v[236:239], a[204:207], v[36:39], v[236:239]
    ds_read_b64_tr_b16 a[188:189], v47 offset:50144
    ds_read_b64_tr_b16 a[190:191], v47 offset:50656
    v_mfma_f32_16x16x32_bf16 v[240:243], a[208:211], v[36:39], v[240:243]
    s_add_u32 s42, s45, 133120
    v_exp_f32 v22, v22
    v_mfma_f32_16x16x32_bf16 v[244:247], a[212:215], v[36:39], v[244:247]
    v_exp_f32 v23, v23
    v_mfma_f32_16x16x32_bf16 v[248:251], a[216:219], v[36:39], v[248:251]
    buffer_load_dwordx4 v60, s[20:23], s40 offen offset:3104 nt lds
    v_cvt_pk_bf16_f32 v32, v16, v17
    v_cvt_pk_bf16_f32 v33, v18, v19
    v_mfma_f32_16x16x32_bf16 v[252:255], a[220:223], v[36:39], v[252:255]
    v_cvt_pk_bf16_f32 v34, v20, v21
    v_cvt_pk_bf16_f32 v35, v22, v23
    v_mfma_f32_16x16x32_bf16 a[244:247], a[248:251], v[36:39], a[244:247]
    v_mfma_f32_16x16x32_bf16 v[16:19], a[96:99], a[32:35], 0
    s_waitcnt vmcnt(24) lgkmcnt(0)
    v_fma_f32 v24, v24, s43, v41
    v_fma_f32 v25, v25, s43, v41
    v_mfma_f32_16x16x32_bf16 v[16:19], a[100:103], a[36:39], v[16:19]
    s_barrier
    v_exp_f32 v24, v24
    v_mfma_f32_16x16x32_bf16 v[16:19], a[104:107], a[40:43], v[16:19]
    s_add_u32 s41, s44, s50
    v_exp_f32 v25, v25
    v_add_u32 v46, s42, v48
    v_add_u32 v47, s42, v49
    v_mfma_f32_16x16x32_bf16 v[16:19], a[108:111], a[44:47], v[16:19]
    v_fma_f32 v26, v26, s43, v41
    v_fma_f32 v27, v27, s43, v41
    v_mfma_f32_16x16x32_bf16 v[20:23], a[112:115], a[32:35], 0
    ds_read_b128 a[128:131], v46
    v_exp_f32 v26, v26
    v_mfma_f32_16x16x32_bf16 v[20:23], a[116:119], a[36:39], v[20:23]
    ds_read_b128 a[132:135], v46 offset:64
    ds_read_b128 a[136:139], v46 offset:128
    v_mfma_f32_16x16x32_bf16 v[20:23], a[120:123], a[40:43], v[20:23]
    v_exp_f32 v27, v27
    v_mfma_f32_16x16x32_bf16 v[20:23], a[124:127], a[44:47], v[20:23]
    ds_read_b128 a[140:143], v46 offset:192
    v_fma_f32 v28, v28, s43, v41
    v_fma_f32 v29, v29, s43, v41
    v_mfma_f32_16x16x32_bf16 v[64:67], a[160:163], v[32:35], v[64:67]
    ds_read_b128 a[144:147], v46 offset:512
    v_exp_f32 v28, v28
    v_mfma_f32_16x16x32_bf16 v[68:71], a[164:167], v[32:35], v[68:71]
    ds_read_b128 a[148:151], v46 offset:576
    v_exp_f32 v29, v29
    v_mfma_f32_16x16x32_bf16 v[72:75], a[168:171], v[32:35], v[72:75]
    v_fma_f32 v30, v30, s43, v41
    v_fma_f32 v31, v31, s43, v41
    v_mfma_f32_16x16x32_bf16 v[76:79], a[172:175], v[32:35], v[76:79]
    ds_read_b128 a[152:155], v46 offset:640
    ds_read_b128 a[156:159], v46 offset:704
    v_mfma_f32_16x16x32_bf16 v[80:83], a[176:179], v[32:35], v[80:83]
    v_exp_f32 v30, v30
    v_mfma_f32_16x16x32_bf16 v[84:87], a[180:183], v[32:35], v[84:87]
    v_exp_f32 v31, v31
    v_mfma_f32_16x16x32_bf16 v[88:91], a[184:187], v[32:35], v[88:91]
    v_cvt_pk_bf16_f32 v36, v24, v25
    v_cvt_pk_bf16_f32 v37, v26, v27
    v_mfma_f32_16x16x32_bf16 v[92:95], a[188:191], v[32:35], v[92:95]
    v_cvt_pk_bf16_f32 v38, v28, v29
    v_cvt_pk_bf16_f32 v39, v30, v31
    v_mfma_f32_16x16x32_bf16 a[224:227], a[248:251], v[32:35], a[224:227]
    s_add_u32 m0, s45, 99840
    s_add_u32 s40, s40, 4096
    buffer_load_dwordx4 v59, s[16:19], s40 offen nt lds
    s_waitcnt lgkmcnt(0)
    v_mfma_f32_16x16x32_bf16 v[24:27], a[128:131], a[0:3], 0
    v_fma_f32 v16, v16, s43, v42
    v_fma_f32 v17, v17, s43, v42
    v_mfma_f32_16x16x32_bf16 v[24:27], a[132:135], a[4:7], v[24:27]
    ds_read_b64_tr_b16 a[192:193], v47
    v_exp_f32 v16, v16
    v_mfma_f32_16x16x32_bf16 v[24:27], a[136:139], a[8:11], v[24:27]
    v_exp_f32 v17, v17
    v_mfma_f32_16x16x32_bf16 v[24:27], a[140:143], a[12:15], v[24:27]
    v_fma_f32 v18, v18, s43, v42
    v_fma_f32 v19, v19, s43, v42
    v_mfma_f32_16x16x32_bf16 v[28:31], a[144:147], a[0:3], 0
    v_exp_f32 v18, v18
    v_mfma_f32_16x16x32_bf16 v[28:31], a[148:151], a[4:7], v[28:31]
    ds_read_b64_tr_b16 a[194:195], v47 offset:512
    ds_read_b64_tr_b16 a[196:197], v47 offset:32
    v_mfma_f32_16x16x32_bf16 v[28:31], a[152:155], a[8:11], v[28:31]
    v_exp_f32 v19, v19
    v_mfma_f32_16x16x32_bf16 v[28:31], a[156:159], a[12:15], v[28:31]
    ds_read_b64_tr_b16 a[198:199], v47 offset:544
    v_fma_f32 v20, v20, s43, v42
    v_fma_f32 v21, v21, s43, v42
    v_mfma_f32_16x16x32_bf16 v[96:99], a[160:163], v[36:39], v[96:99]
    v_exp_f32 v20, v20
    v_mfma_f32_16x16x32_bf16 v[100:103], a[164:167], v[36:39], v[100:103]
    v_exp_f32 v21, v21
    v_mfma_f32_16x16x32_bf16 v[104:107], a[168:171], v[36:39], v[104:107]
    buffer_load_dwordx4 v59, s[20:23], s40 offen offset:1024 nt lds
    v_fma_f32 v22, v22, s43, v42
    v_fma_f32 v23, v23, s43, v42
    v_mfma_f32_16x16x32_bf16 v[108:111], a[172:175], v[36:39], v[108:111]
    ds_read_b64_tr_b16 a[200:201], v47 offset:64
    ds_read_b64_tr_b16 a[202:203], v47 offset:576
    v_mfma_f32_16x16x32_bf16 v[112:115], a[176:179], v[36:39], v[112:115]
    v_exp_f32 v22, v22
    v_mfma_f32_16x16x32_bf16 v[116:119], a[180:183], v[36:39], v[116:119]
    v_exp_f32 v23, v23
    v_mfma_f32_16x16x32_bf16 v[120:123], a[184:187], v[36:39], v[120:123]
    v_cvt_pk_bf16_f32 v32, v16, v17
    v_cvt_pk_bf16_f32 v33, v18, v19
    v_mfma_f32_16x16x32_bf16 v[124:127], a[188:191], v[36:39], v[124:127]
    v_cvt_pk_bf16_f32 v34, v20, v21
    v_cvt_pk_bf16_f32 v35, v22, v23
    v_mfma_f32_16x16x32_bf16 a[228:231], a[248:251], v[36:39], a[228:231]
    ds_read_b64_tr_b16 a[204:205], v47 offset:96
    ds_read_b64_tr_b16 a[206:207], v47 offset:608
    v_mfma_f32_16x16x32_bf16 v[16:19], a[128:131], a[16:19], 0
    v_fma_f32 v24, v24, s43, v40
    v_fma_f32 v25, v25, s43, v40
    v_mfma_f32_16x16x32_bf16 v[16:19], a[132:135], a[20:23], v[16:19]
    ds_read_b64_tr_b16 a[208:209], v47 offset:128
    v_exp_f32 v24, v24
    v_mfma_f32_16x16x32_bf16 v[16:19], a[136:139], a[24:27], v[16:19]
    v_exp_f32 v25, v25
    v_mfma_f32_16x16x32_bf16 v[16:19], a[140:143], a[28:31], v[16:19]
    v_fma_f32 v26, v26, s43, v40
    v_fma_f32 v27, v27, s43, v40
    v_mfma_f32_16x16x32_bf16 v[20:23], a[144:147], a[16:19], 0
    v_exp_f32 v26, v26
    v_mfma_f32_16x16x32_bf16 v[20:23], a[148:151], a[20:23], v[20:23]
    ds_read_b64_tr_b16 a[210:211], v47 offset:640
    ds_read_b64_tr_b16 a[212:213], v47 offset:160
    v_mfma_f32_16x16x32_bf16 v[20:23], a[152:155], a[24:27], v[20:23]
    v_exp_f32 v27, v27
    v_mfma_f32_16x16x32_bf16 v[20:23], a[156:159], a[28:31], v[20:23]
    ds_read_b64_tr_b16 a[214:215], v47 offset:672
    v_fma_f32 v28, v28, s43, v40
    v_fma_f32 v29, v29, s43, v40
    v_mfma_f32_16x16x32_bf16 v[128:131], a[160:163], v[32:35], v[128:131]
    v_exp_f32 v28, v28
    v_mfma_f32_16x16x32_bf16 v[132:135], a[164:167], v[32:35], v[132:135]
    v_exp_f32 v29, v29
    v_mfma_f32_16x16x32_bf16 v[136:139], a[168:171], v[32:35], v[136:139]
    buffer_load_dwordx4 v60, s[16:19], s40 offen offset:2080 nt lds
    v_fma_f32 v30, v30, s43, v40
    v_fma_f32 v31, v31, s43, v40
    v_mfma_f32_16x16x32_bf16 v[140:143], a[172:175], v[32:35], v[140:143]
    ds_read_b64_tr_b16 a[216:217], v47 offset:192
    ds_read_b64_tr_b16 a[218:219], v47 offset:704
    v_mfma_f32_16x16x32_bf16 v[144:147], a[176:179], v[32:35], v[144:147]
    v_exp_f32 v30, v30
    v_mfma_f32_16x16x32_bf16 v[148:151], a[180:183], v[32:35], v[148:151]
    v_exp_f32 v31, v31
    v_mfma_f32_16x16x32_bf16 v[152:155], a[184:187], v[32:35], v[152:155]
    v_cvt_pk_bf16_f32 v36, v24, v25
    v_cvt_pk_bf16_f32 v37, v26, v27
    v_mfma_f32_16x16x32_bf16 v[156:159], a[188:191], v[32:35], v[156:159]
    v_cvt_pk_bf16_f32 v38, v28, v29
    v_cvt_pk_bf16_f32 v39, v30, v31
    v_mfma_f32_16x16x32_bf16 a[232:235], a[248:251], v[32:35], a[232:235]
    ds_read_b64_tr_b16 a[220:221], v47 offset:224
    ds_read_b64_tr_b16 a[222:223], v47 offset:736
    v_mfma_f32_16x16x32_bf16 v[24:27], a[96:99], a[48:51], 0
    s_waitcnt vmcnt(11)
    v_fma_f32 v16, v16, s43, v41
    v_fma_f32 v17, v17, s43, v41
    v_mfma_f32_16x16x32_bf16 v[24:27], a[100:103], a[52:55], v[24:27]
    v_exp_f32 v16, v16
    v_mfma_f32_16x16x32_bf16 v[24:27], a[104:107], a[56:59], v[24:27]
    v_exp_f32 v17, v17
    v_mfma_f32_16x16x32_bf16 v[24:27], a[108:111], a[60:63], v[24:27]
    v_fma_f32 v18, v18, s43, v41
    v_fma_f32 v19, v19, s43, v41
    v_mfma_f32_16x16x32_bf16 v[28:31], a[112:115], a[48:51], 0
    v_exp_f32 v18, v18
    v_mfma_f32_16x16x32_bf16 v[28:31], a[116:119], a[52:55], v[28:31]
    ds_read_b128 a[0:3], v52
    ds_read_b128 a[4:7], v53
    v_mfma_f32_16x16x32_bf16 v[28:31], a[120:123], a[56:59], v[28:31]
    v_exp_f32 v19, v19
    v_mfma_f32_16x16x32_bf16 v[28:31], a[124:127], a[60:63], v[28:31]
    s_waitcnt lgkmcnt(2)
    v_fma_f32 v20, v20, s43, v41
    v_fma_f32 v21, v21, s43, v41
    v_mfma_f32_16x16x32_bf16 v[64:67], a[192:195], v[36:39], v[64:67]
    v_exp_f32 v20, v20
    v_mfma_f32_16x16x32_bf16 v[68:71], a[196:199], v[36:39], v[68:71]
    v_exp_f32 v21, v21
    v_mfma_f32_16x16x32_bf16 v[72:75], a[200:203], v[36:39], v[72:75]
    v_fma_f32 v22, v22, s43, v41
    v_fma_f32 v23, v23, s43, v41
    v_mfma_f32_16x16x32_bf16 v[76:79], a[204:207], v[36:39], v[76:79]
    ds_read_b128 a[8:11], v54
    buffer_load_dwordx4 v60, s[20:23], s40 offen offset:3104 nt lds
    v_mfma_f32_16x16x32_bf16 v[80:83], a[208:211], v[36:39], v[80:83]
    v_exp_f32 v22, v22
    v_mfma_f32_16x16x32_bf16 v[84:87], a[212:215], v[36:39], v[84:87]
    v_exp_f32 v23, v23
    v_mfma_f32_16x16x32_bf16 v[88:91], a[216:219], v[36:39], v[88:91]
    v_cvt_pk_bf16_f32 v32, v16, v17
    v_cvt_pk_bf16_f32 v33, v18, v19
    v_mfma_f32_16x16x32_bf16 v[92:95], a[220:223], v[36:39], v[92:95]
    v_cvt_pk_bf16_f32 v34, v20, v21
    v_cvt_pk_bf16_f32 v35, v22, v23
    v_mfma_f32_16x16x32_bf16 a[224:227], a[248:251], v[36:39], a[224:227]
    ds_read_b128 a[12:15], v55
    v_mfma_f32_16x16x32_bf16 v[16:19], a[128:131], a[32:35], 0
    v_fma_f32 v24, v24, s43, v43
    v_fma_f32 v25, v25, s43, v43
    v_mfma_f32_16x16x32_bf16 v[16:19], a[132:135], a[36:39], v[16:19]
    v_exp_f32 v24, v24
    v_mfma_f32_16x16x32_bf16 v[16:19], a[136:139], a[40:43], v[16:19]
    v_exp_f32 v25, v25
    v_mfma_f32_16x16x32_bf16 v[16:19], a[140:143], a[44:47], v[16:19]
    v_fma_f32 v26, v26, s43, v43
    v_fma_f32 v27, v27, s43, v43
    v_mfma_f32_16x16x32_bf16 v[20:23], a[144:147], a[32:35], 0
    v_exp_f32 v26, v26
    v_mfma_f32_16x16x32_bf16 v[20:23], a[148:151], a[36:39], v[20:23]
    ds_read_b128 a[16:19], v52 offset:16640
    ds_read_b128 a[20:23], v53 offset:16640
    v_mfma_f32_16x16x32_bf16 v[20:23], a[152:155], a[40:43], v[20:23]
    v_exp_f32 v27, v27
    v_mfma_f32_16x16x32_bf16 v[20:23], a[156:159], a[44:47], v[20:23]
    v_fma_f32 v28, v28, s43, v43
    v_fma_f32 v29, v29, s43, v43
    v_mfma_f32_16x16x32_bf16 v[96:99], a[192:195], v[32:35], v[96:99]
    v_exp_f32 v28, v28
    v_mfma_f32_16x16x32_bf16 v[100:103], a[196:199], v[32:35], v[100:103]
    v_exp_f32 v29, v29
    v_mfma_f32_16x16x32_bf16 v[104:107], a[200:203], v[32:35], v[104:107]
    s_add_u32 m0, s45, 116480
    s_add_u32 s40, s40, 4096
    buffer_load_dwordx4 v59, s[16:19], s40 offen nt lds
    v_fma_f32 v30, v30, s43, v43
    v_fma_f32 v31, v31, s43, v43
    v_mfma_f32_16x16x32_bf16 v[108:111], a[204:207], v[32:35], v[108:111]
    ds_read_b128 a[24:27], v54 offset:16640
    ds_read_b128 a[28:31], v55 offset:16640
    v_mfma_f32_16x16x32_bf16 v[112:115], a[208:211], v[32:35], v[112:115]
    v_exp_f32 v30, v30
    v_mfma_f32_16x16x32_bf16 v[116:119], a[212:215], v[32:35], v[116:119]
    v_exp_f32 v31, v31
    v_mfma_f32_16x16x32_bf16 v[120:123], a[216:219], v[32:35], v[120:123]
    v_cvt_pk_bf16_f32 v36, v24, v25
    v_cvt_pk_bf16_f32 v37, v26, v27
    v_mfma_f32_16x16x32_bf16 v[124:127], a[220:223], v[32:35], v[124:127]
    v_cvt_pk_bf16_f32 v38, v28, v29
    v_cvt_pk_bf16_f32 v39, v30, v31
    v_mfma_f32_16x16x32_bf16 a[228:231], a[248:251], v[32:35], a[228:231]
    v_accvgpr_read_b32 v3, a224
    v_rcp_f32 v2, v3
    v_subrev_u32 v3, 0.5, v3
    v_max_u32 v0, v0, v3
    v_pk_mul_f32 v[64:65], v[64:65], v[2:3] op_sel_hi:[1,0]
    v_pk_mul_f32 v[66:67], v[66:67], v[2:3] op_sel_hi:[1,0]
    v_pk_mul_f32 v[68:69], v[68:69], v[2:3] op_sel_hi:[1,0]
    v_pk_mul_f32 v[70:71], v[70:71], v[2:3] op_sel_hi:[1,0]
    v_pk_mul_f32 v[72:73], v[72:73], v[2:3] op_sel_hi:[1,0]
    v_pk_mul_f32 v[74:75], v[74:75], v[2:3] op_sel_hi:[1,0]
    v_cvt_pk_bf16_f32 v64, v64, v65
    v_cvt_pk_bf16_f32 v65, v66, v67
    v_mfma_f32_16x16x32_bf16 v[24:27], a[96:99], a[64:67], 0
    v_fma_f32 v16, v16, s43, v42
    v_fma_f32 v17, v17, s43, v42
    v_mfma_f32_16x16x32_bf16 v[24:27], a[100:103], a[68:71], v[24:27]
    v_exp_f32 v16, v16
    v_mfma_f32_16x16x32_bf16 v[24:27], a[104:107], a[72:75], v[24:27]
    v_exp_f32 v17, v17
    v_mfma_f32_16x16x32_bf16 v[24:27], a[108:111], a[76:79], v[24:27]
    v_fma_f32 v18, v18, s43, v42
    v_fma_f32 v19, v19, s43, v42
    v_mfma_f32_16x16x32_bf16 v[28:31], a[112:115], a[64:67], 0
    v_exp_f32 v18, v18
    v_mfma_f32_16x16x32_bf16 v[28:31], a[116:119], a[68:71], v[28:31]
    ds_write_b64 v5, v[64:65]
    v_mfma_f32_16x16x32_bf16 v[28:31], a[120:123], a[72:75], v[28:31]
    v_exp_f32 v19, v19
    v_mfma_f32_16x16x32_bf16 v[28:31], a[124:127], a[76:79], v[28:31]
    v_fma_f32 v20, v20, s43, v42
    v_fma_f32 v21, v21, s43, v42
    v_mfma_f32_16x16x32_bf16 v[160:163], a[160:163], v[36:39], v[160:163]
    v_exp_f32 v20, v20
    v_mfma_f32_16x16x32_bf16 v[164:167], a[164:167], v[36:39], v[164:167]
    v_exp_f32 v21, v21
    v_mfma_f32_16x16x32_bf16 v[168:171], a[168:171], v[36:39], v[168:171]
    v_fma_f32 v22, v22, s43, v42
    v_fma_f32 v23, v23, s43, v42
    v_mfma_f32_16x16x32_bf16 v[172:175], a[172:175], v[36:39], v[172:175]
    buffer_load_dwordx4 v59, s[20:23], s40 offen offset:1024 nt lds
    v_mfma_f32_16x16x32_bf16 v[176:179], a[176:179], v[36:39], v[176:179]
    v_exp_f32 v22, v22
    v_mfma_f32_16x16x32_bf16 v[180:183], a[180:183], v[36:39], v[180:183]
    v_exp_f32 v23, v23
    v_mfma_f32_16x16x32_bf16 v[184:187], a[184:187], v[36:39], v[184:187]
    v_cvt_pk_bf16_f32 v32, v16, v17
    v_cvt_pk_bf16_f32 v33, v18, v19
    v_mfma_f32_16x16x32_bf16 v[188:191], a[188:191], v[36:39], v[188:191]
    v_cvt_pk_bf16_f32 v34, v20, v21
    v_cvt_pk_bf16_f32 v35, v22, v23
    v_mfma_f32_16x16x32_bf16 a[236:239], a[248:251], v[36:39], a[236:239]
    v_cvt_pk_bf16_f32 v68, v68, v69
    v_cvt_pk_bf16_f32 v69, v70, v71
    v_cvt_pk_bf16_f32 v72, v72, v73
    v_cvt_pk_bf16_f32 v73, v74, v75
    v_pk_mul_f32 v[76:77], v[76:77], v[2:3] op_sel_hi:[1,0]
    v_pk_mul_f32 v[78:79], v[78:79], v[2:3] op_sel_hi:[1,0]
    v_pk_mul_f32 v[80:81], v[80:81], v[2:3] op_sel_hi:[1,0]
    v_pk_mul_f32 v[82:83], v[82:83], v[2:3] op_sel_hi:[1,0]
    v_pk_mul_f32 v[84:85], v[84:85], v[2:3] op_sel_hi:[1,0]
    v_pk_mul_f32 v[86:87], v[86:87], v[2:3] op_sel_hi:[1,0]
    v_cvt_pk_bf16_f32 v76, v76, v77
    v_cvt_pk_bf16_f32 v77, v78, v79
    v_mfma_f32_16x16x32_bf16 v[16:19], a[128:131], a[48:51], 0
    s_waitcnt vmcnt(10)
    v_fma_f32 v24, v24, s43, v44
    v_fma_f32 v25, v25, s43, v44
    v_mfma_f32_16x16x32_bf16 v[16:19], a[132:135], a[52:55], v[16:19]
    v_exp_f32 v24, v24
    v_mfma_f32_16x16x32_bf16 v[16:19], a[136:139], a[56:59], v[16:19]
    v_exp_f32 v25, v25
    v_mfma_f32_16x16x32_bf16 v[16:19], a[140:143], a[60:63], v[16:19]
    ds_write_b64 v6, v[68:69]
    v_fma_f32 v26, v26, s43, v44
    v_fma_f32 v27, v27, s43, v44
    v_mfma_f32_16x16x32_bf16 v[20:23], a[144:147], a[48:51], 0
    v_exp_f32 v26, v26
    v_mfma_f32_16x16x32_bf16 v[20:23], a[148:151], a[52:55], v[20:23]
    ds_read_b128 a[32:35], v52 offset:33280
    ds_read_b128 a[36:39], v53 offset:33280
    v_mfma_f32_16x16x32_bf16 v[20:23], a[152:155], a[56:59], v[20:23]
    v_exp_f32 v27, v27
    v_mfma_f32_16x16x32_bf16 v[20:23], a[156:159], a[60:63], v[20:23]
    v_fma_f32 v28, v28, s43, v44
    v_fma_f32 v29, v29, s43, v44
    v_mfma_f32_16x16x32_bf16 v[128:131], a[192:195], v[32:35], v[128:131]
    ds_write_b64 v7, v[72:73]
    v_exp_f32 v28, v28
    v_mfma_f32_16x16x32_bf16 v[132:135], a[196:199], v[32:35], v[132:135]
    v_exp_f32 v29, v29
    v_mfma_f32_16x16x32_bf16 v[136:139], a[200:203], v[32:35], v[136:139]
    buffer_load_dwordx4 v60, s[16:19], s40 offen offset:2080 nt lds
    v_fma_f32 v30, v30, s43, v44
    v_fma_f32 v31, v31, s43, v44
    v_mfma_f32_16x16x32_bf16 v[140:143], a[204:207], v[32:35], v[140:143]
    ds_read_b128 a[40:43], v54 offset:33280
    ds_read_b128 a[44:47], v55 offset:33280
    v_mfma_f32_16x16x32_bf16 v[144:147], a[208:211], v[32:35], v[144:147]
    v_exp_f32 v30, v30
    v_mfma_f32_16x16x32_bf16 v[148:151], a[212:215], v[32:35], v[148:151]
    ds_write_b64 v62, v[76:77]
    v_exp_f32 v31, v31
    v_mfma_f32_16x16x32_bf16 v[152:155], a[216:219], v[32:35], v[152:155]
    v_cvt_pk_bf16_f32 v36, v24, v25
    v_cvt_pk_bf16_f32 v37, v26, v27
    v_mfma_f32_16x16x32_bf16 v[156:159], a[220:223], v[32:35], v[156:159]
    v_cvt_pk_bf16_f32 v38, v28, v29
    v_cvt_pk_bf16_f32 v39, v30, v31
    v_mfma_f32_16x16x32_bf16 a[232:235], a[248:251], v[32:35], a[232:235]
    v_accvgpr_read_b32 v3, a228
    v_rcp_f32 v14, v3
    v_subrev_u32 v3, 0.5, v3
    v_max_u32 v0, v0, v3
    v_cvt_pk_bf16_f32 v80, v80, v81
    v_cvt_pk_bf16_f32 v81, v82, v83
    v_cvt_pk_bf16_f32 v84, v84, v85
    v_cvt_pk_bf16_f32 v85, v86, v87
    v_pk_mul_f32 v[88:89], v[88:89], v[2:3] op_sel_hi:[1,0]
    v_pk_mul_f32 v[90:91], v[90:91], v[2:3] op_sel_hi:[1,0]
    v_pk_mul_f32 v[92:93], v[92:93], v[2:3] op_sel_hi:[1,0]
    v_pk_mul_f32 v[94:95], v[94:95], v[2:3] op_sel_hi:[1,0]
    v_pk_mul_f32 v[96:97], v[96:97], v[14:15] op_sel_hi:[1,0]
    v_pk_mul_f32 v[98:99], v[98:99], v[14:15] op_sel_hi:[1,0]
    v_cvt_pk_bf16_f32 v88, v88, v89
    v_cvt_pk_bf16_f32 v89, v90, v91
    v_mfma_f32_16x16x32_bf16 v[24:27], a[96:99], a[80:83], 0
    s_waitcnt vmcnt(7)
    v_fma_f32 v16, v16, s43, v43
    v_fma_f32 v17, v17, s43, v43
    v_mfma_f32_16x16x32_bf16 v[24:27], a[100:103], a[84:87], v[24:27]
    v_exp_f32 v16, v16
    v_mfma_f32_16x16x32_bf16 v[24:27], a[104:107], a[88:91], v[24:27]
    v_exp_f32 v17, v17
    v_mfma_f32_16x16x32_bf16 v[24:27], a[108:111], a[92:95], v[24:27]
    ds_write_b64 v5, v[80:81] offset:128
    v_fma_f32 v18, v18, s43, v43
    v_fma_f32 v19, v19, s43, v43
    v_mfma_f32_16x16x32_bf16 v[28:31], a[112:115], a[80:83], 0
    v_exp_f32 v18, v18
    v_mfma_f32_16x16x32_bf16 v[28:31], a[116:119], a[84:87], v[28:31]
    ds_read_b128 a[48:51], v52 offset:49920
    ds_read_b128 a[52:55], v53 offset:49920
    v_mfma_f32_16x16x32_bf16 v[28:31], a[120:123], a[88:91], v[28:31]
    v_exp_f32 v19, v19
    v_mfma_f32_16x16x32_bf16 v[28:31], a[124:127], a[92:95], v[28:31]
    v_fma_f32 v20, v20, s43, v43
    v_fma_f32 v21, v21, s43, v43
    v_mfma_f32_16x16x32_bf16 v[192:195], a[160:163], v[36:39], v[192:195]
    ds_write_b64 v6, v[84:85] offset:128
    v_exp_f32 v20, v20
    v_mfma_f32_16x16x32_bf16 v[196:199], a[164:167], v[36:39], v[196:199]
    v_exp_f32 v21, v21
    v_mfma_f32_16x16x32_bf16 v[200:203], a[168:171], v[36:39], v[200:203]
    buffer_load_dwordx4 v60, s[20:23], s40 offen offset:3104 nt lds
    v_fma_f32 v22, v22, s43, v43
    v_fma_f32 v23, v23, s43, v43
    v_mfma_f32_16x16x32_bf16 v[204:207], a[172:175], v[36:39], v[204:207]
    ds_read_b128 a[56:59], v54 offset:49920
    ds_read_b128 a[60:63], v55 offset:49920
    v_mfma_f32_16x16x32_bf16 v[208:211], a[176:179], v[36:39], v[208:211]
    v_exp_f32 v22, v22
    v_mfma_f32_16x16x32_bf16 v[212:215], a[180:183], v[36:39], v[212:215]
    ds_write_b64 v7, v[88:89] offset:128
    v_exp_f32 v23, v23
    v_mfma_f32_16x16x32_bf16 v[216:219], a[184:187], v[36:39], v[216:219]
    v_cvt_pk_bf16_f32 v32, v16, v17
    v_cvt_pk_bf16_f32 v33, v18, v19
    v_mfma_f32_16x16x32_bf16 v[220:223], a[188:191], v[36:39], v[220:223]
    v_cvt_pk_bf16_f32 v34, v20, v21
    v_cvt_pk_bf16_f32 v35, v22, v23
    v_mfma_f32_16x16x32_bf16 a[240:243], a[248:251], v[36:39], a[240:243]
    v_cvt_pk_bf16_f32 v92, v92, v93
    v_cvt_pk_bf16_f32 v93, v94, v95
    v_cvt_pk_bf16_f32 v96, v96, v97
    v_cvt_pk_bf16_f32 v97, v98, v99
    v_pk_mul_f32 v[100:101], v[100:101], v[14:15] op_sel_hi:[1,0]
    v_pk_mul_f32 v[102:103], v[102:103], v[14:15] op_sel_hi:[1,0]
    v_pk_mul_f32 v[104:105], v[104:105], v[14:15] op_sel_hi:[1,0]
    v_pk_mul_f32 v[106:107], v[106:107], v[14:15] op_sel_hi:[1,0]
    v_pk_mul_f32 v[108:109], v[108:109], v[14:15] op_sel_hi:[1,0]
    v_pk_mul_f32 v[110:111], v[110:111], v[14:15] op_sel_hi:[1,0]
    v_cvt_pk_bf16_f32 v100, v100, v101
    v_cvt_pk_bf16_f32 v101, v102, v103
    v_mfma_f32_16x16x32_bf16 v[16:19], a[128:131], a[64:67], 0
    s_waitcnt vmcnt(24) lgkmcnt(0)
    v_fma_f32 v24, v24, s43, v45
    v_fma_f32 v25, v25, s43, v45
    v_mfma_f32_16x16x32_bf16 v[16:19], a[132:135], a[68:71], v[16:19]
    s_barrier
    v_exp_f32 v24, v24
    v_mfma_f32_16x16x32_bf16 v[16:19], a[136:139], a[72:75], v[16:19]
    s_add_u32 s40, s59, s49
    v_exp_f32 v25, v25
    v_add_u32 v46, s45, v48
    v_add_u32 v47, s45, v49
    v_mfma_f32_16x16x32_bf16 v[16:19], a[140:143], a[76:79], v[16:19]
    s_add_u32 s40, s40, 8192
    v_fma_f32 v26, v26, s43, v45
    v_fma_f32 v27, v27, s43, v45
    v_mfma_f32_16x16x32_bf16 v[20:23], a[144:147], a[64:67], 0
    ds_write_b64 v62, v[92:93] offset:128
    v_exp_f32 v26, v26
    v_mfma_f32_16x16x32_bf16 v[20:23], a[148:151], a[68:71], v[20:23]
    ds_read_b128 a[96:99], v46
    ds_read_b128 a[100:103], v46 offset:64
    v_mfma_f32_16x16x32_bf16 v[20:23], a[152:155], a[72:75], v[20:23]
    v_exp_f32 v27, v27
    v_mfma_f32_16x16x32_bf16 v[20:23], a[156:159], a[76:79], v[20:23]
    v_fma_f32 v28, v28, s43, v45
    v_fma_f32 v29, v29, s43, v45
    v_mfma_f32_16x16x32_bf16 v[160:163], a[192:195], v[32:35], v[160:163]
    v_exp_f32 v28, v28
    v_mfma_f32_16x16x32_bf16 v[164:167], a[196:199], v[32:35], v[164:167]
    ds_write_b64 v5, v[96:97] offset:16640
    v_exp_f32 v29, v29
    v_mfma_f32_16x16x32_bf16 v[168:171], a[200:203], v[32:35], v[168:171]
    s_add_u32 m0, s45, 133120
    s_add_u32 s40, s40, 8192
    buffer_load_dwordx4 v57, s[8:11], s40 offen nt lds
    v_fma_f32 v30, v30, s43, v45
    v_fma_f32 v31, v31, s43, v45
    v_mfma_f32_16x16x32_bf16 v[172:175], a[204:207], v[32:35], v[172:175]
    ds_read_b128 a[104:107], v46 offset:128
    ds_read_b128 a[108:111], v46 offset:192
    v_mfma_f32_16x16x32_bf16 v[176:179], a[208:211], v[32:35], v[176:179]
    v_exp_f32 v30, v30
    v_mfma_f32_16x16x32_bf16 v[180:183], a[212:215], v[32:35], v[180:183]
    ds_write_b64 v6, v[100:101] offset:16640
    v_exp_f32 v31, v31
    v_mfma_f32_16x16x32_bf16 v[184:187], a[216:219], v[32:35], v[184:187]
    v_cvt_pk_bf16_f32 v36, v24, v25
    v_cvt_pk_bf16_f32 v37, v26, v27
    v_mfma_f32_16x16x32_bf16 v[188:191], a[220:223], v[32:35], v[188:191]
    v_cvt_pk_bf16_f32 v38, v28, v29
    v_cvt_pk_bf16_f32 v39, v30, v31
    v_mfma_f32_16x16x32_bf16 a[236:239], a[248:251], v[32:35], a[236:239]
    v_cvt_pk_bf16_f32 v104, v104, v105
    v_cvt_pk_bf16_f32 v105, v106, v107
    v_cvt_pk_bf16_f32 v108, v108, v109
    v_cvt_pk_bf16_f32 v109, v110, v111
    v_pk_mul_f32 v[112:113], v[112:113], v[14:15] op_sel_hi:[1,0]
    v_pk_mul_f32 v[114:115], v[114:115], v[14:15] op_sel_hi:[1,0]
    v_pk_mul_f32 v[116:117], v[116:117], v[14:15] op_sel_hi:[1,0]
    v_pk_mul_f32 v[118:119], v[118:119], v[14:15] op_sel_hi:[1,0]
    v_pk_mul_f32 v[120:121], v[120:121], v[14:15] op_sel_hi:[1,0]
    v_pk_mul_f32 v[122:123], v[122:123], v[14:15] op_sel_hi:[1,0]
    v_cvt_pk_bf16_f32 v112, v112, v113
    v_cvt_pk_bf16_f32 v113, v114, v115
    v_mfma_f32_16x16x32_bf16 v[24:27], a[128:131], a[80:83], 0
    v_fma_f32 v16, v16, s43, v44
    v_fma_f32 v17, v17, s43, v44
    v_mfma_f32_16x16x32_bf16 v[24:27], a[132:135], a[84:87], v[24:27]
    ds_read_b128 v[64:67], v56
    v_exp_f32 v16, v16
    v_mfma_f32_16x16x32_bf16 v[24:27], a[136:139], a[88:91], v[24:27]
    v_exp_f32 v17, v17
    v_mfma_f32_16x16x32_bf16 v[24:27], a[140:143], a[92:95], v[24:27]
    ds_read_b128 v[72:75], v63 offset:1024
    v_fma_f32 v18, v18, s43, v44
    v_fma_f32 v19, v19, s43, v44
    v_mfma_f32_16x16x32_bf16 v[28:31], a[144:147], a[80:83], 0
    v_exp_f32 v18, v18
    v_mfma_f32_16x16x32_bf16 v[28:31], a[148:151], a[84:87], v[28:31]
    ds_read_b128 a[112:115], v46 offset:512
    ds_read_b128 a[116:119], v46 offset:576
    ds_read_b128 v[80:83], v56 offset:2048
    v_mfma_f32_16x16x32_bf16 v[28:31], a[152:155], a[88:91], v[28:31]
    v_exp_f32 v19, v19
    v_mfma_f32_16x16x32_bf16 v[28:31], a[156:159], a[92:95], v[28:31]
    buffer_load_dwordx4 v57, s[12:15], s40 offen offset:1024 nt lds
    v_fma_f32 v20, v20, s43, v44
    v_fma_f32 v21, v21, s43, v44
    v_mfma_f32_16x16x32_bf16 v[224:227], a[160:163], v[36:39], v[224:227]
    ds_read_b128 v[88:91], v63 offset:3072
    v_exp_f32 v20, v20
    v_mfma_f32_16x16x32_bf16 v[228:231], a[164:167], v[36:39], v[228:231]
    v_exp_f32 v21, v21
    v_mfma_f32_16x16x32_bf16 v[232:235], a[168:171], v[36:39], v[232:235]
    ds_write_b64 v7, v[104:105] offset:16640
    v_fma_f32 v22, v22, s43, v44
    v_fma_f32 v23, v23, s43, v44
    v_mfma_f32_16x16x32_bf16 v[236:239], a[172:175], v[36:39], v[236:239]
    ds_read_b128 a[120:123], v46 offset:640
    ds_read_b128 a[124:127], v46 offset:704
    v_mfma_f32_16x16x32_bf16 v[240:243], a[176:179], v[36:39], v[240:243]
    ds_write_b64 v62, v[108:109] offset:16640
    v_exp_f32 v22, v22
    v_mfma_f32_16x16x32_bf16 v[244:247], a[180:183], v[36:39], v[244:247]
    buffer_load_dwordx4 v58, s[8:11], s40 offen offset:2080 nt lds
    v_exp_f32 v23, v23
    v_mfma_f32_16x16x32_bf16 v[248:251], a[184:187], v[36:39], v[248:251]
    ds_write_b64 v5, v[112:113] offset:16768
    v_cvt_pk_bf16_f32 v32, v16, v17
    v_cvt_pk_bf16_f32 v33, v18, v19
    v_mfma_f32_16x16x32_bf16 v[252:255], a[188:191], v[36:39], v[252:255]
Lpad6:
    s_cbranch_execz Lret6
    v_cvt_pk_bf16_f32 v34, v20, v21
    v_cvt_pk_bf16_f32 v35, v22, v23
    v_mfma_f32_16x16x32_bf16 a[244:247], a[248:251], v[36:39], a[244:247]
    v_accvgpr_read_b32 v3, a232
    v_rcp_f32 v2, v3
    v_subrev_u32 v3, 0.5, v3
    v_max_u32 v0, v0, v3
    v_cvt_pk_bf16_f32 v116, v116, v117
    v_cvt_pk_bf16_f32 v117, v118, v119
    v_cvt_pk_bf16_f32 v120, v120, v121
    v_cvt_pk_bf16_f32 v121, v122, v123
    v_pk_mul_f32 v[124:125], v[124:125], v[14:15] op_sel_hi:[1,0]
    v_pk_mul_f32 v[126:127], v[126:127], v[14:15] op_sel_hi:[1,0]
    v_pk_mul_f32 v[128:129], v[128:129], v[2:3] op_sel_hi:[1,0]
    v_pk_mul_f32 v[130:131], v[130:131], v[2:3] op_sel_hi:[1,0]
    v_pk_mul_f32 v[132:133], v[132:133], v[2:3] op_sel_hi:[1,0]
    v_pk_mul_f32 v[134:135], v[134:135], v[2:3] op_sel_hi:[1,0]
    v_cvt_pk_bf16_f32 v124, v124, v125
    v_cvt_pk_bf16_f32 v125, v126, v127
    s_waitcnt lgkmcnt(2)
    v_mfma_f32_16x16x32_bf16 v[16:19], a[96:99], a[0:3], 0
    v_fma_f32 v24, v24, s43, v45
    v_fma_f32 v25, v25, s43, v45
    v_mfma_f32_16x16x32_bf16 v[16:19], a[100:103], a[4:7], v[16:19]
    ds_read_b64_tr_b16 a[160:161], v47
    v_exp_f32 v24, v24
    v_mfma_f32_16x16x32_bf16 v[16:19], a[104:107], a[8:11], v[16:19]
    s_waitcnt lgkmcnt(10)
    buffer_store_dwordx4 v[64:67], v58, s[24:27], s41 offen sc1
    v_exp_f32 v25, v25
    v_mfma_f32_16x16x32_bf16 v[16:19], a[108:111], a[12:15], v[16:19]
    v_fma_f32 v26, v26, s43, v45
    v_fma_f32 v27, v27, s43, v45
    v_mfma_f32_16x16x32_bf16 v[20:23], a[112:115], a[0:3], 0
    v_exp_f32 v26, v26
    v_mfma_f32_16x16x32_bf16 v[20:23], a[116:119], a[4:7], v[20:23]
    ds_read_b64_tr_b16 a[162:163], v47 offset:512
    ds_read_b64_tr_b16 a[164:165], v47 offset:32
    buffer_store_dwordx4 v[72:75], v58, s[24:27], s41 offen offset:1024 sc1
    v_mfma_f32_16x16x32_bf16 v[20:23], a[120:123], a[8:11], v[20:23]
    v_exp_f32 v27, v27
    v_mfma_f32_16x16x32_bf16 v[20:23], a[124:127], a[12:15], v[20:23]
    ds_read_b64_tr_b16 a[166:167], v47 offset:544
    v_fma_f32 v28, v28, s43, v45
    v_fma_f32 v29, v29, s43, v45
    v_mfma_f32_16x16x32_bf16 v[192:195], a[192:195], v[32:35], v[192:195]
    ds_write_b64 v6, v[116:117] offset:16768
    v_exp_f32 v28, v28
    v_mfma_f32_16x16x32_bf16 v[196:199], a[196:199], v[32:35], v[196:199]
    ds_read_b64_tr_b16 a[168:169], v47 offset:64
    v_exp_f32 v29, v29
    v_mfma_f32_16x16x32_bf16 v[200:203], a[200:203], v[32:35], v[200:203]
    buffer_load_dwordx4 v58, s[12:15], s40 offen offset:3104 nt lds
    v_fma_f32 v30, v30, s43, v45
    v_fma_f32 v31, v31, s43, v45
    v_mfma_f32_16x16x32_bf16 v[204:207], a[204:207], v[32:35], v[204:207]
    ds_read_b64_tr_b16 a[170:171], v47 offset:576
    v_max3_f32 v1, v16, v17, v18
    v_max3_f32 v4, v19, v20, v21
    v_mfma_f32_16x16x32_bf16 v[208:211], a[208:211], v[32:35], v[208:211]
    ds_write_b64 v7, v[120:121] offset:16768
    v_exp_f32 v30, v30
    v_max3_f32 v1, v1, v22, v23
    v_max_f32 v1, v1, v4
    v_mov_b32 v4, v1
    v_mfma_f32_16x16x32_bf16 v[212:215], a[212:215], v[32:35], v[212:215]
    ds_read_b64_tr_b16 a[172:173], v47 offset:96
    v_exp_f32 v31, v31
    v_permlane16_swap_b32 v1, v4
    v_mfma_f32_16x16x32_bf16 v[216:219], a[216:219], v[32:35], v[216:219]
    ds_write_b64 v62, v[124:125] offset:16768
    v_cvt_pk_bf16_f32 v36, v24, v25
    v_cvt_pk_bf16_f32 v37, v26, v27
    v_max_f32 v1, v1, v4
    v_mov_b32 v4, v1
    v_mfma_f32_16x16x32_bf16 v[220:223], a[220:223], v[32:35], v[220:223]
    ds_read_b64_tr_b16 a[174:175], v47 offset:608
    v_cvt_pk_bf16_f32 v38, v28, v29
    v_cvt_pk_bf16_f32 v39, v30, v31
    v_permlane32_swap_b32 v1, v4
    v_mfma_f32_16x16x32_bf16 a[240:243], a[248:251], v[32:35], a[240:243]
    v_max_f32 v1, v1, v4
    v_mul_f32 v40, s58, v1
    v_cvt_pk_bf16_f32 v128, v128, v129
    v_cvt_pk_bf16_f32 v129, v130, v131
    v_cvt_pk_bf16_f32 v132, v132, v133
    v_cvt_pk_bf16_f32 v133, v134, v135
    v_pk_mul_f32 v[136:137], v[136:137], v[2:3] op_sel_hi:[1,0]
    v_pk_mul_f32 v[138:139], v[138:139], v[2:3] op_sel_hi:[1,0]
    v_pk_mul_f32 v[140:141], v[140:141], v[2:3] op_sel_hi:[1,0]
    v_pk_mul_f32 v[142:143], v[142:143], v[2:3] op_sel_hi:[1,0]
    v_pk_mul_f32 v[144:145], v[144:145], v[2:3] op_sel_hi:[1,0]
    v_pk_mul_f32 v[146:147], v[146:147], v[2:3] op_sel_hi:[1,0]
    v_cvt_pk_bf16_f32 v136, v136, v137
    v_cvt_pk_bf16_f32 v137, v138, v139
    v_mfma_f32_16x16x32_bf16 v[24:27], a[96:99], a[16:19], 0
    s_waitcnt lgkmcnt(15)
    buffer_store_dwordx4 v[80:83], v58, s[24:27], s41 offen offset:2048 sc1
    v_fma_f32 v16, v16, s43, v40
    v_fma_f32 v17, v17, s43, v40
    v_mfma_f32_16x16x32_bf16 v[24:27], a[100:103], a[20:23], v[24:27]
    ds_read_b128 a[128:131], v46 offset:16640
    v_exp_f32 v16, v16
    v_mfma_f32_16x16x32_bf16 v[24:27], a[104:107], a[24:27], v[24:27]
    ds_read_b128 a[132:135], v46 offset:16704
    v_exp_f32 v17, v17
    v_mfma_f32_16x16x32_bf16 v[24:27], a[108:111], a[28:31], v[24:27]
    buffer_store_dwordx4 v[88:91], v58, s[24:27], s41 offen offset:3072 sc1
    s_add_u32 s41, s41, 4096
    v_fma_f32 v18, v18, s43, v40
    v_fma_f32 v19, v19, s43, v40
    v_mfma_f32_16x16x32_bf16 v[28:31], a[112:115], a[16:19], 0
    ds_read_b128 v[96:99], v56 offset:16640
    v_exp_f32 v18, v18
    v_mfma_f32_16x16x32_bf16 v[28:31], a[116:119], a[20:23], v[28:31]
    ds_read_b128 a[136:139], v46 offset:16768
    ds_read_b128 a[140:143], v46 offset:16832
    ds_read_b128 v[104:107], v63 offset:17664
    v_mfma_f32_16x16x32_bf16 v[28:31], a[120:123], a[24:27], v[28:31]
    ds_read_b128 v[112:115], v56 offset:18688
    v_exp_f32 v19, v19
    v_mfma_f32_16x16x32_bf16 v[28:31], a[124:127], a[28:31], v[28:31]
    ds_read_b128 a[144:147], v46 offset:17152
    v_fma_f32 v20, v20, s43, v40
    v_fma_f32 v21, v21, s43, v40
    v_mfma_f32_16x16x32_bf16 v[224:227], a[192:195], v[36:39], v[224:227]
    ds_read_b128 a[148:151], v46 offset:17216
    v_exp_f32 v20, v20
    v_mfma_f32_16x16x32_bf16 v[228:231], a[196:199], v[36:39], v[228:231]
    ds_read_b128 v[120:123], v63 offset:19712
    v_exp_f32 v21, v21
    v_mfma_f32_16x16x32_bf16 v[232:235], a[200:203], v[36:39], v[232:235]
    ds_read_b128 a[152:155], v46 offset:17280
    v_fma_f32 v22, v22, s43, v40
    v_fma_f32 v23, v23, s43, v40
    v_mfma_f32_16x16x32_bf16 v[236:239], a[204:207], v[36:39], v[236:239]
    ds_read_b128 a[156:159], v46 offset:17344
    v_max3_f32 v1, v24, v25, v26
    v_max3_f32 v4, v27, v28, v29
    v_mfma_f32_16x16x32_bf16 v[240:243], a[208:211], v[36:39], v[240:243]
    ds_write_b64 v5, v[128:129] offset:33280
    v_exp_f32 v22, v22
    v_max3_f32 v1, v1, v30, v31
    v_max_f32 v1, v1, v4
    v_mov_b32 v4, v1
    v_mfma_f32_16x16x32_bf16 v[244:247], a[212:215], v[36:39], v[244:247]
    ds_write_b64 v6, v[132:133] offset:33280
    v_exp_f32 v23, v23
    v_permlane16_swap_b32 v1, v4
    v_mfma_f32_16x16x32_bf16 v[248:251], a[216:219], v[36:39], v[248:251]
    ds_write_b64 v7, v[136:137] offset:33280
    v_cvt_pk_bf16_f32 v32, v16, v17
    v_cvt_pk_bf16_f32 v33, v18, v19
    v_max_f32 v1, v1, v4
    v_mov_b32 v4, v1
    v_mfma_f32_16x16x32_bf16 v[252:255], a[220:223], v[36:39], v[252:255]
    v_cvt_pk_bf16_f32 v34, v20, v21
    v_cvt_pk_bf16_f32 v35, v22, v23
    v_permlane32_swap_b32 v1, v4
    v_mfma_f32_16x16x32_bf16 a[244:247], a[248:251], v[36:39], a[244:247]
    v_max_f32 v1, v1, v4
    v_mul_f32 v41, s58, v1
    v_cvt_pk_bf16_f32 v140, v140, v141
    v_cvt_pk_bf16_f32 v141, v142, v143
    v_cvt_pk_bf16_f32 v144, v144, v145
    v_cvt_pk_bf16_f32 v145, v146, v147
    v_pk_mul_f32 v[148:149], v[148:149], v[2:3] op_sel_hi:[1,0]
    v_pk_mul_f32 v[150:151], v[150:151], v[2:3] op_sel_hi:[1,0]
    v_pk_mul_f32 v[152:153], v[152:153], v[2:3] op_sel_hi:[1,0]
    v_pk_mul_f32 v[154:155], v[154:155], v[2:3] op_sel_hi:[1,0]
    v_pk_mul_f32 v[156:157], v[156:157], v[2:3] op_sel_hi:[1,0]
    v_pk_mul_f32 v[158:159], v[158:159], v[2:3] op_sel_hi:[1,0]
    v_cvt_pk_bf16_f32 v148, v148, v149
    v_cvt_pk_bf16_f32 v149, v150, v151
    s_waitcnt lgkmcnt(3)
    v_mfma_f32_16x16x32_bf16 v[16:19], a[128:131], a[0:3], 0
    ds_read_b64_tr_b16 a[176:177], v47 offset:128
    v_fma_f32 v24, v24, s43, v41
    v_fma_f32 v25, v25, s43, v41
    v_mfma_f32_16x16x32_bf16 v[16:19], a[132:135], a[4:7], v[16:19]
    ds_read_b64_tr_b16 a[178:179], v47 offset:640
    v_exp_f32 v24, v24
    v_mfma_f32_16x16x32_bf16 v[16:19], a[136:139], a[8:11], v[16:19]
    ds_read_b64_tr_b16 a[180:181], v47 offset:160
    v_exp_f32 v25, v25
    v_mfma_f32_16x16x32_bf16 v[16:19], a[140:143], a[12:15], v[16:19]
    ds_read_b64_tr_b16 a[182:183], v47 offset:672
    v_fma_f32 v26, v26, s43, v41
    v_fma_f32 v27, v27, s43, v41
    v_mfma_f32_16x16x32_bf16 v[20:23], a[144:147], a[0:3], 0
    ds_read_b64_tr_b16 a[184:185], v47 offset:192
    v_exp_f32 v26, v26
    v_mfma_f32_16x16x32_bf16 v[20:23], a[148:151], a[4:7], v[20:23]
    ds_read_b64_tr_b16 a[186:187], v47 offset:704
    ds_read_b64_tr_b16 a[188:189], v47 offset:224
    ds_read_b64_tr_b16 a[190:191], v47 offset:736
    v_mfma_f32_16x16x32_bf16 v[20:23], a[152:155], a[8:11], v[20:23]
    s_waitcnt lgkmcnt(15)
    buffer_store_dwordx4 v[96:99], v58, s[24:27], s41 offen sc1
    v_exp_f32 v27, v27
    v_mfma_f32_16x16x32_bf16 v[20:23], a[156:159], a[12:15], v[20:23]
    s_waitcnt lgkmcnt(6)
    buffer_store_dwordx4 v[104:107], v58, s[24:27], s41 offen offset:1024 sc1
    v_fma_f32 v28, v28, s43, v41
    v_fma_f32 v29, v29, s43, v41
    v_mfma_f32_16x16x32_bf16 v[64:67], a[160:163], v[32:35], 0
    ds_write_b64 v62, v[140:141] offset:33280
    v_exp_f32 v28, v28
    v_mfma_f32_16x16x32_bf16 v[68:71], a[164:167], v[32:35], 0
    v_exp_f32 v29, v29
    v_mfma_f32_16x16x32_bf16 v[72:75], a[168:171], v[32:35], 0
    v_fma_f32 v30, v30, s43, v41
    v_fma_f32 v31, v31, s43, v41
    v_mfma_f32_16x16x32_bf16 v[76:79], a[172:175], v[32:35], 0
    s_waitcnt lgkmcnt(1)
    s_add_u32 m0, s45, 33280
    s_add_u32 s40, s40, 8192
    buffer_load_dwordx4 v57, s[8:11], s40 offen nt lds
    ds_write_b64 v5, v[144:145] offset:33408
    v_mfma_f32_16x16x32_bf16 v[80:83], a[176:179], v[32:35], 0
    v_exp_f32 v30, v30
    v_mfma_f32_16x16x32_bf16 v[84:87], a[180:183], v[32:35], 0
    v_exp_f32 v31, v31
    v_mfma_f32_16x16x32_bf16 v[88:91], a[184:187], v[32:35], 0
    ds_write_b64 v6, v[148:149] offset:33408
    v_cvt_pk_bf16_f32 v36, v24, v25
    v_cvt_pk_bf16_f32 v37, v26, v27
    v_mfma_f32_16x16x32_bf16 v[92:95], a[188:191], v[32:35], 0
    v_cvt_pk_bf16_f32 v38, v28, v29
    v_cvt_pk_bf16_f32 v39, v30, v31
    v_mfma_f32_16x16x32_bf16 a[224:227], a[248:251], v[32:35], 0
    v_accvgpr_read_b32 v3, a236
    v_rcp_f32 v14, v3
    v_subrev_u32 v3, 0.5, v3
    v_max_u32 v0, v0, v3
    v_cvt_pk_bf16_f32 v152, v152, v153
    v_cvt_pk_bf16_f32 v153, v154, v155
    v_cvt_pk_bf16_f32 v156, v156, v157
    v_cvt_pk_bf16_f32 v157, v158, v159
    v_pk_mul_f32 v[160:161], v[160:161], v[14:15] op_sel_hi:[1,0]
    v_pk_mul_f32 v[162:163], v[162:163], v[14:15] op_sel_hi:[1,0]
    v_pk_mul_f32 v[164:165], v[164:165], v[14:15] op_sel_hi:[1,0]
    v_pk_mul_f32 v[166:167], v[166:167], v[14:15] op_sel_hi:[1,0]
    v_pk_mul_f32 v[168:169], v[168:169], v[14:15] op_sel_hi:[1,0]
    v_pk_mul_f32 v[170:171], v[170:171], v[14:15] op_sel_hi:[1,0]
    v_cvt_pk_bf16_f32 v160, v160, v161
    v_cvt_pk_bf16_f32 v161, v162, v163
    v_mfma_f32_16x16x32_bf16 v[24:27], a[96:99], a[32:35], 0
    v_fma_f32 v16, v16, s43, v40
    v_fma_f32 v17, v17, s43, v40
    v_mfma_f32_16x16x32_bf16 v[24:27], a[100:103], a[36:39], v[24:27]
    ds_read_b64_tr_b16 a[192:193], v47 offset:16640
    v_exp_f32 v16, v16
    v_mfma_f32_16x16x32_bf16 v[24:27], a[104:107], a[40:43], v[24:27]
    ds_read_b64_tr_b16 a[194:195], v47 offset:17152
    v_exp_f32 v17, v17
    v_mfma_f32_16x16x32_bf16 v[24:27], a[108:111], a[44:47], v[24:27]
    s_waitcnt lgkmcnt(15)
    buffer_store_dwordx4 v[112:115], v58, s[24:27], s41 offen offset:2048 sc1
    v_fma_f32 v18, v18, s43, v40
    v_fma_f32 v19, v19, s43, v40
    v_mfma_f32_16x16x32_bf16 v[28:31], a[112:115], a[32:35], 0
    v_exp_f32 v18, v18
    v_mfma_f32_16x16x32_bf16 v[28:31], a[116:119], a[36:39], v[28:31]
    ds_read_b64_tr_b16 a[196:197], v47 offset:16672
    ds_read_b64_tr_b16 a[198:199], v47 offset:17184
    buffer_store_dwordx4 v[120:123], v58, s[24:27], s41 offen offset:3072 sc1
    s_add_u32 s41, s41, 4096
    v_mfma_f32_16x16x32_bf16 v[28:31], a[120:123], a[40:43], v[28:31]
    ds_write_b64 v7, v[152:153] offset:33408
    v_exp_f32 v19, v19
    v_mfma_f32_16x16x32_bf16 v[28:31], a[124:127], a[44:47], v[28:31]
    ds_read_b64_tr_b16 a[200:201], v47 offset:16704
    v_fma_f32 v20, v20, s43, v40
    v_fma_f32 v21, v21, s43, v40
    v_mfma_f32_16x16x32_bf16 v[96:99], a[160:163], v[36:39], 0
    ds_write_b64 v62, v[156:157] offset:33408
    v_exp_f32 v20, v20
    v_mfma_f32_16x16x32_bf16 v[100:103], a[164:167], v[36:39], 0
    ds_read_b64_tr_b16 a[202:203], v47 offset:17216
    v_exp_f32 v21, v21
    v_mfma_f32_16x16x32_bf16 v[104:107], a[168:171], v[36:39], 0
    ds_read_b64_tr_b16 a[204:205], v47 offset:16736
    v_fma_f32 v22, v22, s43, v40
    v_fma_f32 v23, v23, s43, v40
    v_mfma_f32_16x16x32_bf16 v[108:111], a[172:175], v[36:39], 0
    buffer_load_dwordx4 v57, s[12:15], s40 offen offset:1024 nt lds
    v_max3_f32 v1, v24, v25, v26
    v_max3_f32 v4, v27, v28, v29
    v_mfma_f32_16x16x32_bf16 v[112:115], a[176:179], v[36:39], 0
    ds_read_b64_tr_b16 a[206:207], v47 offset:17248
    v_exp_f32 v22, v22
    v_max3_f32 v1, v1, v30, v31
    v_max_f32 v1, v1, v4
    v_mov_b32 v4, v1
    v_mfma_f32_16x16x32_bf16 v[116:119], a[180:183], v[36:39], 0
    ds_write_b64 v5, v[160:161] offset:49920
    v_exp_f32 v23, v23
    v_permlane16_swap_b32 v1, v4
    v_mfma_f32_16x16x32_bf16 v[120:123], a[184:187], v[36:39], 0
    ds_read_b64_tr_b16 a[208:209], v47 offset:16768
    v_cvt_pk_bf16_f32 v32, v16, v17
    v_cvt_pk_bf16_f32 v33, v18, v19
    v_max_f32 v1, v1, v4
    v_mov_b32 v4, v1
    v_mfma_f32_16x16x32_bf16 v[124:127], a[188:191], v[36:39], 0
    ds_read_b64_tr_b16 a[210:211], v47 offset:17280
    v_cvt_pk_bf16_f32 v34, v20, v21
    v_cvt_pk_bf16_f32 v35, v22, v23
    v_permlane32_swap_b32 v1, v4
    v_mfma_f32_16x16x32_bf16 a[228:231], a[248:251], v[36:39], 0
    v_max_f32 v1, v1, v4
    v_mul_f32 v42, s58, v1
    v_cvt_pk_bf16_f32 v164, v164, v165
    v_cvt_pk_bf16_f32 v165, v166, v167
    v_cvt_pk_bf16_f32 v168, v168, v169
    v_cvt_pk_bf16_f32 v169, v170, v171
    v_pk_mul_f32 v[172:173], v[172:173], v[14:15] op_sel_hi:[1,0]
    v_pk_mul_f32 v[174:175], v[174:175], v[14:15] op_sel_hi:[1,0]
    v_pk_mul_f32 v[176:177], v[176:177], v[14:15] op_sel_hi:[1,0]
    v_pk_mul_f32 v[178:179], v[178:179], v[14:15] op_sel_hi:[1,0]
    v_pk_mul_f32 v[180:181], v[180:181], v[14:15] op_sel_hi:[1,0]
    v_pk_mul_f32 v[182:183], v[182:183], v[14:15] op_sel_hi:[1,0]
    v_cvt_pk_bf16_f32 v172, v172, v173
    v_cvt_pk_bf16_f32 v173, v174, v175
    v_mfma_f32_16x16x32_bf16 v[16:19], a[128:131], a[16:19], 0
    v_fma_f32 v24, v24, s43, v42
    v_fma_f32 v25, v25, s43, v42
    v_mfma_f32_16x16x32_bf16 v[16:19], a[132:135], a[20:23], v[16:19]
    ds_read_b64_tr_b16 a[212:213], v47 offset:16800
    v_exp_f32 v24, v24
    v_mfma_f32_16x16x32_bf16 v[16:19], a[136:139], a[24:27], v[16:19]
    ds_read_b64_tr_b16 a[214:215], v47 offset:17312
    v_exp_f32 v25, v25
    v_mfma_f32_16x16x32_bf16 v[16:19], a[140:143], a[28:31], v[16:19]
    ds_read_b64_tr_b16 a[216:217], v47 offset:16832
    v_fma_f32 v26, v26, s43, v42
    v_fma_f32 v27, v27, s43, v42
    v_mfma_f32_16x16x32_bf16 v[20:23], a[144:147], a[16:19], 0
    ds_read_b64_tr_b16 a[218:219], v47 offset:17344
    v_exp_f32 v26, v26
    v_mfma_f32_16x16x32_bf16 v[20:23], a[148:151], a[20:23], v[20:23]
    ds_read_b64_tr_b16 a[220:221], v47 offset:16864
    ds_read_b64_tr_b16 a[222:223], v47 offset:17376
    ds_write_b64 v6, v[164:165] offset:49920
    v_mfma_f32_16x16x32_bf16 v[20:23], a[152:155], a[24:27], v[20:23]
    v_exp_f32 v27, v27
    v_mfma_f32_16x16x32_bf16 v[20:23], a[156:159], a[28:31], v[20:23]
    s_waitcnt lgkmcnt(7)
    v_fma_f32 v28, v28, s43, v42
    v_fma_f32 v29, v29, s43, v42
    v_mfma_f32_16x16x32_bf16 v[64:67], a[192:195], v[32:35], v[64:67]
    ds_write_b64 v7, v[168:169] offset:49920
    v_exp_f32 v28, v28
    v_mfma_f32_16x16x32_bf16 v[68:71], a[196:199], v[32:35], v[68:71]
    v_exp_f32 v29, v29
    v_add_u32 v52, 66560, v52
    v_add_u32 v53, 66560, v53
    v_add_u32 v54, 66560, v54
    v_add_u32 v55, 66560, v55
    v_mfma_f32_16x16x32_bf16 v[72:75], a[200:203], v[32:35], v[72:75]
    v_fma_f32 v30, v30, s43, v42
    v_fma_f32 v31, v31, s43, v42
    v_mfma_f32_16x16x32_bf16 v[76:79], a[204:207], v[32:35], v[76:79]
    buffer_load_dwordx4 v58, s[8:11], s40 offen offset:2080 nt lds
    ds_write_b64 v62, v[172:173] offset:49920
    v_mfma_f32_16x16x32_bf16 v[80:83], a[208:211], v[32:35], v[80:83]
    s_waitcnt lgkmcnt(3)
    v_exp_f32 v30, v30
    v_mfma_f32_16x16x32_bf16 v[84:87], a[212:215], v[32:35], v[84:87]
    v_exp_f32 v31, v31
    v_mfma_f32_16x16x32_bf16 v[88:91], a[216:219], v[32:35], v[88:91]
    v_cvt_pk_bf16_f32 v36, v24, v25
    v_cvt_pk_bf16_f32 v37, v26, v27
    v_mfma_f32_16x16x32_bf16 v[92:95], a[220:223], v[32:35], v[92:95]
    v_cvt_pk_bf16_f32 v38, v28, v29
    v_cvt_pk_bf16_f32 v39, v30, v31
    v_mfma_f32_16x16x32_bf16 a[224:227], a[248:251], v[32:35], a[224:227]
    v_accvgpr_read_b32 v3, a240
    v_rcp_f32 v2, v3
    v_subrev_u32 v3, 0.5, v3
    v_max_u32 v0, v0, v3
    v_cvt_pk_bf16_f32 v176, v176, v177
    v_cvt_pk_bf16_f32 v177, v178, v179
    v_cvt_pk_bf16_f32 v180, v180, v181
    v_cvt_pk_bf16_f32 v181, v182, v183
    v_pk_mul_f32 v[184:185], v[184:185], v[14:15] op_sel_hi:[1,0]
    v_pk_mul_f32 v[186:187], v[186:187], v[14:15] op_sel_hi:[1,0]
    v_pk_mul_f32 v[188:189], v[188:189], v[14:15] op_sel_hi:[1,0]
    v_pk_mul_f32 v[190:191], v[190:191], v[14:15] op_sel_hi:[1,0]
    v_pk_mul_f32 v[192:193], v[192:193], v[2:3] op_sel_hi:[1,0]
    v_pk_mul_f32 v[194:195], v[194:195], v[2:3] op_sel_hi:[1,0]
    v_cvt_pk_bf16_f32 v184, v184, v185
    v_cvt_pk_bf16_f32 v185, v186, v187
    v_mfma_f32_16x16x32_bf16 v[24:27], a[96:99], a[48:51], 0
    s_waitcnt vmcnt(19) lgkmcnt(0)
    v_fma_f32 v16, v16, s43, v41
    v_fma_f32 v17, v17, s43, v41
    v_mfma_f32_16x16x32_bf16 v[24:27], a[100:103], a[52:55], v[24:27]
    s_barrier
    v_exp_f32 v16, v16
    v_mfma_f32_16x16x32_bf16 v[24:27], a[104:107], a[56:59], v[24:27]
    v_exp_f32 v17, v17
    v_mfma_f32_16x16x32_bf16 v[24:27], a[108:111], a[60:63], v[24:27]
    v_fma_f32 v18, v18, s43, v41
    v_fma_f32 v19, v19, s43, v41
    v_mfma_f32_16x16x32_bf16 v[28:31], a[112:115], a[48:51], 0
    ds_write_b64 v5, v[176:177] offset:50048
    v_exp_f32 v18, v18
    v_mfma_f32_16x16x32_bf16 v[28:31], a[116:119], a[52:55], v[28:31]
    ds_read_b128 a[64:67], v52
    ds_read_b128 a[68:71], v53
    v_mfma_f32_16x16x32_bf16 v[28:31], a[120:123], a[56:59], v[28:31]
    v_exp_f32 v19, v19
    v_mfma_f32_16x16x32_bf16 v[28:31], a[124:127], a[60:63], v[28:31]
    v_fma_f32 v20, v20, s43, v41
    v_fma_f32 v21, v21, s43, v41
    v_mfma_f32_16x16x32_bf16 v[128:131], a[160:163], v[36:39], 0
    v_exp_f32 v20, v20
    v_mfma_f32_16x16x32_bf16 v[132:135], a[164:167], v[36:39], 0
    ds_write_b64 v6, v[180:181] offset:50048
    v_exp_f32 v21, v21
    v_mfma_f32_16x16x32_bf16 v[136:139], a[168:171], v[36:39], 0
    buffer_load_dwordx4 v58, s[12:15], s40 offen offset:3104 nt lds
    v_fma_f32 v22, v22, s43, v41
    v_fma_f32 v23, v23, s43, v41
    v_mfma_f32_16x16x32_bf16 v[140:143], a[172:175], v[36:39], 0
    ds_read_b128 a[72:75], v54
    v_max3_f32 v1, v24, v25, v26
    v_max3_f32 v4, v27, v28, v29
    v_mfma_f32_16x16x32_bf16 v[144:147], a[176:179], v[36:39], 0
    v_exp_f32 v22, v22
    v_max3_f32 v1, v1, v30, v31
    v_max_f32 v1, v1, v4
    v_mov_b32 v4, v1
    v_mfma_f32_16x16x32_bf16 v[148:151], a[180:183], v[36:39], 0
    ds_write_b64 v7, v[184:185] offset:50048
    v_exp_f32 v23, v23
    v_permlane16_swap_b32 v1, v4
    v_mfma_f32_16x16x32_bf16 v[152:155], a[184:187], v[36:39], 0
    ds_read_b128 a[76:79], v55
    v_cvt_pk_bf16_f32 v32, v16, v17
    v_cvt_pk_bf16_f32 v33, v18, v19
    v_max_f32 v1, v1, v4
    v_mov_b32 v4, v1
    v_mfma_f32_16x16x32_bf16 v[156:159], a[188:191], v[36:39], 0
    v_cvt_pk_bf16_f32 v34, v20, v21
    v_cvt_pk_bf16_f32 v35, v22, v23
    v_permlane32_swap_b32 v1, v4
    v_mfma_f32_16x16x32_bf16 a[232:235], a[248:251], v[36:39], 0
    v_max_f32 v1, v1, v4
    v_mul_f32 v43, s58, v1
    v_cvt_pk_bf16_f32 v188, v188, v189
    v_cvt_pk_bf16_f32 v189, v190, v191
    v_cvt_pk_bf16_f32 v192, v192, v193
    v_cvt_pk_bf16_f32 v193, v194, v195
    v_pk_mul_f32 v[196:197], v[196:197], v[2:3] op_sel_hi:[1,0]
    v_pk_mul_f32 v[198:199], v[198:199], v[2:3] op_sel_hi:[1,0]
    v_pk_mul_f32 v[200:201], v[200:201], v[2:3] op_sel_hi:[1,0]
    v_pk_mul_f32 v[202:203], v[202:203], v[2:3] op_sel_hi:[1,0]
    v_pk_mul_f32 v[204:205], v[204:205], v[2:3] op_sel_hi:[1,0]
    v_pk_mul_f32 v[206:207], v[206:207], v[2:3] op_sel_hi:[1,0]
    v_cvt_pk_bf16_f32 v196, v196, v197
    v_cvt_pk_bf16_f32 v197, v198, v199
    v_mfma_f32_16x16x32_bf16 v[16:19], a[128:131], a[32:35], 0
    v_fma_f32 v24, v24, s43, v43
    v_fma_f32 v25, v25, s43, v43
    v_mfma_f32_16x16x32_bf16 v[16:19], a[132:135], a[36:39], v[16:19]
    v_exp_f32 v24, v24
    v_mfma_f32_16x16x32_bf16 v[16:19], a[136:139], a[40:43], v[16:19]
    v_exp_f32 v25, v25
    v_mfma_f32_16x16x32_bf16 v[16:19], a[140:143], a[44:47], v[16:19]
    v_fma_f32 v26, v26, s43, v43
    v_fma_f32 v27, v27, s43, v43
    v_mfma_f32_16x16x32_bf16 v[20:23], a[144:147], a[32:35], 0
    v_exp_f32 v26, v26
    v_mfma_f32_16x16x32_bf16 v[20:23], a[148:151], a[36:39], v[20:23]
    ds_write_b64 v62, v[188:189] offset:50048
    v_mfma_f32_16x16x32_bf16 v[20:23], a[152:155], a[40:43], v[20:23]
    v_exp_f32 v27, v27
    v_mfma_f32_16x16x32_bf16 v[20:23], a[156:159], a[44:47], v[20:23]
    v_fma_f32 v28, v28, s43, v43
    v_fma_f32 v29, v29, s43, v43
    v_mfma_f32_16x16x32_bf16 v[96:99], a[192:195], v[32:35], v[96:99]
    v_add_u32 v5, 66560, v5
    ds_write_b64 v5, v[192:193]
    v_exp_f32 v28, v28
    v_mfma_f32_16x16x32_bf16 v[100:103], a[196:199], v[32:35], v[100:103]
    v_exp_f32 v29, v29
    v_mfma_f32_16x16x32_bf16 v[104:107], a[200:203], v[32:35], v[104:107]
    v_fma_f32 v30, v30, s43, v43
    v_fma_f32 v31, v31, s43, v43
    v_mfma_f32_16x16x32_bf16 v[108:111], a[204:207], v[32:35], v[108:111]
    s_mov_b32 m0, s45
    s_add_u32 s40, s40, 8192
    buffer_load_dwordx4 v57, s[8:11], s40 offen nt lds
    v_mfma_f32_16x16x32_bf16 v[112:115], a[208:211], v[32:35], v[112:115]
    v_exp_f32 v30, v30
    v_mfma_f32_16x16x32_bf16 v[116:119], a[212:215], v[32:35], v[116:119]
    v_add_u32 v6, 66560, v6
    ds_write_b64 v6, v[196:197]
    v_exp_f32 v31, v31
    v_mfma_f32_16x16x32_bf16 v[120:123], a[216:219], v[32:35], v[120:123]
    v_cvt_pk_bf16_f32 v36, v24, v25
    v_cvt_pk_bf16_f32 v37, v26, v27
    v_mfma_f32_16x16x32_bf16 v[124:127], a[220:223], v[32:35], v[124:127]
    s_waitcnt lgkmcnt(3)
    v_cvt_pk_bf16_f32 v38, v28, v29
    v_cvt_pk_bf16_f32 v39, v30, v31
    v_mfma_f32_16x16x32_bf16 a[228:231], a[248:251], v[32:35], a[228:231]
    v_cvt_pk_bf16_f32 v200, v200, v201
    v_cvt_pk_bf16_f32 v201, v202, v203
    v_cvt_pk_bf16_f32 v204, v204, v205
    v_cvt_pk_bf16_f32 v205, v206, v207
    v_pk_mul_f32 v[208:209], v[208:209], v[2:3] op_sel_hi:[1,0]
    v_pk_mul_f32 v[210:211], v[210:211], v[2:3] op_sel_hi:[1,0]
    v_pk_mul_f32 v[212:213], v[212:213], v[2:3] op_sel_hi:[1,0]
    v_pk_mul_f32 v[214:215], v[214:215], v[2:3] op_sel_hi:[1,0]
    v_pk_mul_f32 v[216:217], v[216:217], v[2:3] op_sel_hi:[1,0]
    v_pk_mul_f32 v[218:219], v[218:219], v[2:3] op_sel_hi:[1,0]
    v_cvt_pk_bf16_f32 v208, v208, v209
    v_cvt_pk_bf16_f32 v209, v210, v211
    v_mfma_f32_16x16x32_bf16 v[24:27], a[96:99], a[64:67], 0
    s_waitcnt vmcnt(17)
    v_fma_f32 v16, v16, s43, v42
    v_fma_f32 v17, v17, s43, v42
    v_mfma_f32_16x16x32_bf16 v[24:27], a[100:103], a[68:71], v[24:27]
    v_exp_f32 v16, v16
    v_mfma_f32_16x16x32_bf16 v[24:27], a[104:107], a[72:75], v[24:27]
    v_exp_f32 v17, v17
    v_mfma_f32_16x16x32_bf16 v[24:27], a[108:111], a[76:79], v[24:27]
    v_add_u32 v7, 66560, v7
    ds_write_b64 v7, v[200:201]
    v_fma_f32 v18, v18, s43, v42
    v_fma_f32 v19, v19, s43, v42
    v_mfma_f32_16x16x32_bf16 v[28:31], a[112:115], a[64:67], 0
    v_exp_f32 v18, v18
    v_mfma_f32_16x16x32_bf16 v[28:31], a[116:119], a[68:71], v[28:31]
    ds_read_b128 a[80:83], v52 offset:16640
    ds_read_b128 a[84:87], v53 offset:16640
    v_mfma_f32_16x16x32_bf16 v[28:31], a[120:123], a[72:75], v[28:31]
    v_exp_f32 v19, v19
    v_mfma_f32_16x16x32_bf16 v[28:31], a[124:127], a[76:79], v[28:31]
    v_fma_f32 v20, v20, s43, v42
    v_fma_f32 v21, v21, s43, v42
    v_mfma_f32_16x16x32_bf16 v[160:163], a[160:163], v[36:39], 0
    v_add_u32 v62, 66560, v62
    ds_write_b64 v62, v[204:205]
    v_exp_f32 v20, v20
    v_mfma_f32_16x16x32_bf16 v[164:167], a[164:167], v[36:39], 0
    v_exp_f32 v21, v21
    v_mfma_f32_16x16x32_bf16 v[168:171], a[168:171], v[36:39], 0
    ds_read_b128 a[88:91], v54 offset:16640
    v_fma_f32 v22, v22, s43, v42
    v_fma_f32 v23, v23, s43, v42
    v_mfma_f32_16x16x32_bf16 v[172:175], a[172:175], v[36:39], 0
    buffer_load_dwordx4 v57, s[12:15], s40 offen offset:1024 nt lds
    v_max3_f32 v1, v24, v25, v26
    v_max3_f32 v4, v27, v28, v29
    v_mfma_f32_16x16x32_bf16 v[176:179], a[176:179], v[36:39], 0
    v_exp_f32 v22, v22
    v_max3_f32 v1, v1, v30, v31
    v_max_f32 v1, v1, v4
    v_mov_b32 v4, v1
    v_mfma_f32_16x16x32_bf16 v[180:183], a[180:183], v[36:39], 0
    ds_write_b64 v5, v[208:209] offset:128
    v_exp_f32 v23, v23
    v_permlane16_swap_b32 v1, v4
    v_mfma_f32_16x16x32_bf16 v[184:187], a[184:187], v[36:39], 0
    ds_read_b128 a[92:95], v55 offset:16640
    v_cvt_pk_bf16_f32 v32, v16, v17
    v_cvt_pk_bf16_f32 v33, v18, v19
    v_max_f32 v1, v1, v4
    v_mov_b32 v4, v1
    v_mfma_f32_16x16x32_bf16 v[188:191], a[188:191], v[36:39], 0
Lpad7:
    s_cbranch_execz Lret7
    v_cvt_pk_bf16_f32 v34, v20, v21
    v_cvt_pk_bf16_f32 v35, v22, v23
    v_permlane32_swap_b32 v1, v4
    v_mfma_f32_16x16x32_bf16 a[236:239], a[248:251], v[36:39], 0
    v_max_f32 v1, v1, v4
    v_mul_f32 v44, s58, v1
    v_accvgpr_read_b32 v3, a244
    v_rcp_f32 v14, v3
    v_subrev_u32 v3, 0.5, v3
    v_max_u32 v0, v0, v3
    v_cvt_pk_bf16_f32 v212, v212, v213
    v_cvt_pk_bf16_f32 v213, v214, v215
    v_cvt_pk_bf16_f32 v216, v216, v217
    v_cvt_pk_bf16_f32 v217, v218, v219
    v_pk_mul_f32 v[220:221], v[220:221], v[2:3] op_sel_hi:[1,0]
    v_pk_mul_f32 v[222:223], v[222:223], v[2:3] op_sel_hi:[1,0]
    v_pk_mul_f32 v[224:225], v[224:225], v[14:15] op_sel_hi:[1,0]
    v_pk_mul_f32 v[226:227], v[226:227], v[14:15] op_sel_hi:[1,0]
    v_pk_mul_f32 v[228:229], v[228:229], v[14:15] op_sel_hi:[1,0]
    v_pk_mul_f32 v[230:231], v[230:231], v[14:15] op_sel_hi:[1,0]
    v_cvt_pk_bf16_f32 v220, v220, v221
    v_cvt_pk_bf16_f32 v221, v222, v223
    v_mfma_f32_16x16x32_bf16 v[16:19], a[128:131], a[48:51], 0
    v_fma_f32 v24, v24, s43, v44
    v_fma_f32 v25, v25, s43, v44
    v_mfma_f32_16x16x32_bf16 v[16:19], a[132:135], a[52:55], v[16:19]
    v_exp_f32 v24, v24
    v_mfma_f32_16x16x32_bf16 v[16:19], a[136:139], a[56:59], v[16:19]
    v_exp_f32 v25, v25
    v_mfma_f32_16x16x32_bf16 v[16:19], a[140:143], a[60:63], v[16:19]
    v_fma_f32 v26, v26, s43, v44
    v_fma_f32 v27, v27, s43, v44
    v_mfma_f32_16x16x32_bf16 v[20:23], a[144:147], a[48:51], 0
    v_exp_f32 v26, v26
    v_mfma_f32_16x16x32_bf16 v[20:23], a[148:151], a[52:55], v[20:23]
    ds_write_b64 v6, v[212:213] offset:128
    v_mfma_f32_16x16x32_bf16 v[20:23], a[152:155], a[56:59], v[20:23]
    v_exp_f32 v27, v27
    v_mfma_f32_16x16x32_bf16 v[20:23], a[156:159], a[60:63], v[20:23]
    v_fma_f32 v28, v28, s43, v44
    v_fma_f32 v29, v29, s43, v44
    v_mfma_f32_16x16x32_bf16 v[128:131], a[192:195], v[32:35], v[128:131]
    ds_write_b64 v7, v[216:217] offset:128
    v_exp_f32 v28, v28
    v_mfma_f32_16x16x32_bf16 v[132:135], a[196:199], v[32:35], v[132:135]
    v_exp_f32 v29, v29
    v_mfma_f32_16x16x32_bf16 v[136:139], a[200:203], v[32:35], v[136:139]
    v_fma_f32 v30, v30, s43, v44
    v_fma_f32 v31, v31, s43, v44
    v_mfma_f32_16x16x32_bf16 v[140:143], a[204:207], v[32:35], v[140:143]
    buffer_load_dwordx4 v58, s[8:11], s40 offen offset:2080 nt lds
    ds_write_b64 v62, v[220:221] offset:128
    v_mfma_f32_16x16x32_bf16 v[144:147], a[208:211], v[32:35], v[144:147]
    v_exp_f32 v30, v30
    v_mfma_f32_16x16x32_bf16 v[148:151], a[212:215], v[32:35], v[148:151]
    v_exp_f32 v31, v31
    v_mfma_f32_16x16x32_bf16 v[152:155], a[216:219], v[32:35], v[152:155]
    v_cvt_pk_bf16_f32 v36, v24, v25
    v_cvt_pk_bf16_f32 v37, v26, v27
    v_mfma_f32_16x16x32_bf16 v[156:159], a[220:223], v[32:35], v[156:159]
    s_waitcnt lgkmcnt(3)
    v_cvt_pk_bf16_f32 v38, v28, v29
    v_cvt_pk_bf16_f32 v39, v30, v31
    v_mfma_f32_16x16x32_bf16 a[232:235], a[248:251], v[32:35], a[232:235]
    v_cvt_pk_bf16_f32 v224, v224, v225
    v_cvt_pk_bf16_f32 v225, v226, v227
    v_cvt_pk_bf16_f32 v228, v228, v229
    v_cvt_pk_bf16_f32 v229, v230, v231
    v_pk_mul_f32 v[232:233], v[232:233], v[14:15] op_sel_hi:[1,0]
    v_pk_mul_f32 v[234:235], v[234:235], v[14:15] op_sel_hi:[1,0]
    v_pk_mul_f32 v[236:237], v[236:237], v[14:15] op_sel_hi:[1,0]
    v_pk_mul_f32 v[238:239], v[238:239], v[14:15] op_sel_hi:[1,0]
    v_pk_mul_f32 v[240:241], v[240:241], v[14:15] op_sel_hi:[1,0]
    v_pk_mul_f32 v[242:243], v[242:243], v[14:15] op_sel_hi:[1,0]
    v_cvt_pk_bf16_f32 v232, v232, v233
    v_cvt_pk_bf16_f32 v233, v234, v235
    v_mfma_f32_16x16x32_bf16 v[24:27], a[96:99], a[80:83], 0
    v_fma_f32 v16, v16, s43, v43
    v_fma_f32 v17, v17, s43, v43
    v_mfma_f32_16x16x32_bf16 v[24:27], a[100:103], a[84:87], v[24:27]
    v_exp_f32 v16, v16
    v_mfma_f32_16x16x32_bf16 v[24:27], a[104:107], a[88:91], v[24:27]
    v_exp_f32 v17, v17
    v_mfma_f32_16x16x32_bf16 v[24:27], a[108:111], a[92:95], v[24:27]
    v_fma_f32 v18, v18, s43, v43
    v_fma_f32 v19, v19, s43, v43
    v_mfma_f32_16x16x32_bf16 v[28:31], a[112:115], a[80:83], 0
    v_exp_f32 v18, v18
    v_mfma_f32_16x16x32_bf16 v[28:31], a[116:119], a[84:87], v[28:31]
    buffer_load_dwordx4 v58, s[12:15], s40 offen offset:3104 nt lds
    ds_write_b64 v5, v[224:225] offset:16640
    v_mfma_f32_16x16x32_bf16 v[28:31], a[120:123], a[88:91], v[28:31]
    v_exp_f32 v19, v19
    v_mfma_f32_16x16x32_bf16 v[28:31], a[124:127], a[92:95], v[28:31]
    v_fma_f32 v20, v20, s43, v43
    v_fma_f32 v21, v21, s43, v43
    v_mfma_f32_16x16x32_bf16 v[192:195], a[160:163], v[36:39], 0
    ds_write_b64 v6, v[228:229] offset:16640
    v_exp_f32 v20, v20
    v_mfma_f32_16x16x32_bf16 v[196:199], a[164:167], v[36:39], 0
    v_exp_f32 v21, v21
    v_mfma_f32_16x16x32_bf16 v[200:203], a[168:171], v[36:39], 0
    v_fma_f32 v22, v22, s43, v43
    v_fma_f32 v23, v23, s43, v43
    v_mfma_f32_16x16x32_bf16 v[204:207], a[172:175], v[36:39], 0
    v_max3_f32 v1, v24, v25, v26
    v_max3_f32 v4, v27, v28, v29
    v_mfma_f32_16x16x32_bf16 v[208:211], a[176:179], v[36:39], 0
    v_exp_f32 v22, v22
    v_max3_f32 v1, v1, v30, v31
    v_max_f32 v1, v1, v4
    v_mov_b32 v4, v1
    v_mfma_f32_16x16x32_bf16 v[212:215], a[180:183], v[36:39], 0
    ds_write_b64 v7, v[232:233] offset:16640
    v_exp_f32 v23, v23
    v_permlane16_swap_b32 v1, v4
    v_mfma_f32_16x16x32_bf16 v[216:219], a[184:187], v[36:39], 0
    v_cvt_pk_bf16_f32 v32, v16, v17
    v_cvt_pk_bf16_f32 v33, v18, v19
    v_max_f32 v1, v1, v4
    v_mov_b32 v4, v1
    v_mfma_f32_16x16x32_bf16 v[220:223], a[188:191], v[36:39], 0
    v_cvt_pk_bf16_f32 v34, v20, v21
    v_cvt_pk_bf16_f32 v35, v22, v23
    v_permlane32_swap_b32 v1, v4
    v_mfma_f32_16x16x32_bf16 a[240:243], a[248:251], v[36:39], 0
    v_max_f32 v1, v1, v4
    v_mul_f32 v45, s58, v1
    v_cvt_pk_bf16_f32 v236, v236, v237
    v_cvt_pk_bf16_f32 v237, v238, v239
    v_cvt_pk_bf16_f32 v240, v240, v241
    v_cvt_pk_bf16_f32 v241, v242, v243
    v_pk_mul_f32 v[244:245], v[244:245], v[14:15] op_sel_hi:[1,0]
    v_pk_mul_f32 v[246:247], v[246:247], v[14:15] op_sel_hi:[1,0]
    v_pk_mul_f32 v[248:249], v[248:249], v[14:15] op_sel_hi:[1,0]
    v_pk_mul_f32 v[250:251], v[250:251], v[14:15] op_sel_hi:[1,0]
    v_pk_mul_f32 v[252:253], v[252:253], v[14:15] op_sel_hi:[1,0]
    v_pk_mul_f32 v[254:255], v[254:255], v[14:15] op_sel_hi:[1,0]
    v_cvt_pk_bf16_f32 v244, v244, v245
    v_cvt_pk_bf16_f32 v245, v246, v247
    v_cvt_pk_bf16_f32 v248, v248, v249
    v_cvt_pk_bf16_f32 v249, v250, v251
    v_cvt_pk_bf16_f32 v252, v252, v253
    v_cvt_pk_bf16_f32 v253, v254, v255
    v_mfma_f32_16x16x32_bf16 v[16:19], a[128:131], a[64:67], 0
    s_waitcnt vmcnt(14) lgkmcnt(0)
    v_fma_f32 v24, v24, s43, v45
    v_fma_f32 v25, v25, s43, v45
    v_mfma_f32_16x16x32_bf16 v[16:19], a[132:135], a[68:71], v[16:19]
    s_barrier
    v_exp_f32 v24, v24
    v_mfma_f32_16x16x32_bf16 v[16:19], a[136:139], a[72:75], v[16:19]
    s_add_u32 s47, s45, 133120
    v_exp_f32 v25, v25
    v_add_u32 v46, s47, v48
    v_add_u32 v47, s47, v49
    v_mfma_f32_16x16x32_bf16 v[16:19], a[140:143], a[76:79], v[16:19]
    s_add_u32 s92, s45, 16640
    ds_write_b64 v62, v[236:237] offset:16640
    v_fma_f32 v26, v26, s43, v45
    v_fma_f32 v27, v27, s43, v45
    v_mfma_f32_16x16x32_bf16 v[20:23], a[144:147], a[64:67], 0
    v_exp_f32 v26, v26
    v_mfma_f32_16x16x32_bf16 v[20:23], a[148:151], a[68:71], v[20:23]
    ds_read_b128 a[96:99], v46
    ds_write_b64 v5, v[240:241] offset:16768
    v_mfma_f32_16x16x32_bf16 v[20:23], a[152:155], a[72:75], v[20:23]
    v_exp_f32 v27, v27
    v_mfma_f32_16x16x32_bf16 v[20:23], a[156:159], a[76:79], v[20:23]
    v_fma_f32 v28, v28, s43, v45
    v_fma_f32 v29, v29, s43, v45
    v_mfma_f32_16x16x32_bf16 v[160:163], a[192:195], v[32:35], v[160:163]
    v_exp_f32 v28, v28
    v_mfma_f32_16x16x32_bf16 v[164:167], a[196:199], v[32:35], v[164:167]
    ds_write_b64 v6, v[244:245] offset:16768
    v_exp_f32 v29, v29
    v_mfma_f32_16x16x32_bf16 v[168:171], a[200:203], v[32:35], v[168:171]
    s_add_u32 m0, s45, 16640
    s_add_u32 s40, s40, 8192
    buffer_load_dwordx4 v57, s[8:11], s40 offen nt lds
    v_fma_f32 v30, v30, s43, v45
    v_fma_f32 v31, v31, s43, v45
    v_mfma_f32_16x16x32_bf16 v[172:175], a[204:207], v[32:35], v[172:175]
    ds_read_b128 a[100:103], v46 offset:64
    ds_read_b128 a[104:107], v46 offset:128
    ds_write_b64 v7, v[248:249] offset:16768
    v_mfma_f32_16x16x32_bf16 v[176:179], a[208:211], v[32:35], v[176:179]
    v_exp_f32 v30, v30
    v_mfma_f32_16x16x32_bf16 v[180:183], a[212:215], v[32:35], v[180:183]
    v_exp_f32 v31, v31
    v_mfma_f32_16x16x32_bf16 v[184:187], a[216:219], v[32:35], v[184:187]
    ds_write_b64 v62, v[252:253] offset:16768
    v_cvt_pk_bf16_f32 v36, v24, v25
    v_cvt_pk_bf16_f32 v37, v26, v27
    v_mfma_f32_16x16x32_bf16 v[188:191], a[220:223], v[32:35], v[188:191]
    v_cvt_pk_bf16_f32 v38, v28, v29
    v_cvt_pk_bf16_f32 v39, v30, v31
    v_mfma_f32_16x16x32_bf16 a[236:239], a[248:251], v[32:35], a[236:239]
    ds_read_b128 a[108:111], v46 offset:192
    v_mfma_f32_16x16x32_bf16 v[24:27], a[128:131], a[80:83], 0
    v_fma_f32 v16, v16, s43, v44
    v_fma_f32 v17, v17, s43, v44
    v_mfma_f32_16x16x32_bf16 v[24:27], a[132:135], a[84:87], v[24:27]
    v_exp_f32 v16, v16
    v_mfma_f32_16x16x32_bf16 v[24:27], a[136:139], a[88:91], v[24:27]
    v_exp_f32 v17, v17
    v_mfma_f32_16x16x32_bf16 v[24:27], a[140:143], a[92:95], v[24:27]
    v_fma_f32 v18, v18, s43, v44
    v_fma_f32 v19, v19, s43, v44
    v_mfma_f32_16x16x32_bf16 v[28:31], a[144:147], a[80:83], 0
    v_exp_f32 v18, v18
    v_mfma_f32_16x16x32_bf16 v[28:31], a[148:151], a[84:87], v[28:31]
    ds_read_b128 a[112:115], v46 offset:512
    ds_read_b128 a[116:119], v46 offset:576
    v_mfma_f32_16x16x32_bf16 v[28:31], a[152:155], a[88:91], v[28:31]
    v_exp_f32 v19, v19
    v_mfma_f32_16x16x32_bf16 v[28:31], a[156:159], a[92:95], v[28:31]
    v_fma_f32 v20, v20, s43, v44
    v_fma_f32 v21, v21, s43, v44
    v_mfma_f32_16x16x32_bf16 v[224:227], a[160:163], v[36:39], 0
    v_exp_f32 v20, v20
    v_mfma_f32_16x16x32_bf16 v[228:231], a[164:167], v[36:39], 0
    v_exp_f32 v21, v21
    v_mfma_f32_16x16x32_bf16 v[232:235], a[168:171], v[36:39], 0
    v_fma_f32 v22, v22, s43, v44
    v_fma_f32 v23, v23, s43, v44
    v_mfma_f32_16x16x32_bf16 v[236:239], a[172:175], v[36:39], 0
    ds_read_b128 a[120:123], v46 offset:640
    ds_read_b128 a[124:127], v46 offset:704
    v_mfma_f32_16x16x32_bf16 v[240:243], a[176:179], v[36:39], 0
    v_exp_f32 v22, v22
    v_mfma_f32_16x16x32_bf16 v[244:247], a[180:183], v[36:39], 0
    v_exp_f32 v23, v23
    v_mfma_f32_16x16x32_bf16 v[248:251], a[184:187], v[36:39], 0
    v_cvt_pk_bf16_f32 v32, v16, v17
    v_cvt_pk_bf16_f32 v33, v18, v19
    v_mfma_f32_16x16x32_bf16 v[252:255], a[188:191], v[36:39], 0
    v_cvt_pk_bf16_f32 v34, v20, v21
    v_cvt_pk_bf16_f32 v35, v22, v23
    v_mfma_f32_16x16x32_bf16 a[244:247], a[248:251], v[36:39], 0
    buffer_load_dwordx4 v57, s[12:15], s40 offen offset:1024 nt lds
    s_waitcnt lgkmcnt(0)
    v_mfma_f32_16x16x32_bf16 v[16:19], a[96:99], a[0:3], 0
    v_fma_f32 v24, v24, s43, v45
    v_fma_f32 v25, v25, s43, v45
    v_mfma_f32_16x16x32_bf16 v[16:19], a[100:103], a[4:7], v[16:19]
    ds_read_b64_tr_b16 a[160:161], v47
    v_exp_f32 v24, v24
    v_mfma_f32_16x16x32_bf16 v[16:19], a[104:107], a[8:11], v[16:19]
    v_exp_f32 v25, v25
    v_mfma_f32_16x16x32_bf16 v[16:19], a[108:111], a[12:15], v[16:19]
    v_fma_f32 v26, v26, s43, v45
    v_fma_f32 v27, v27, s43, v45
    v_mfma_f32_16x16x32_bf16 v[20:23], a[112:115], a[0:3], 0
    v_exp_f32 v26, v26
    v_mfma_f32_16x16x32_bf16 v[20:23], a[116:119], a[4:7], v[20:23]
    ds_read_b64_tr_b16 a[162:163], v47 offset:512
    ds_read_b64_tr_b16 a[164:165], v47 offset:32
    v_mfma_f32_16x16x32_bf16 v[20:23], a[120:123], a[8:11], v[20:23]
    v_exp_f32 v27, v27
    v_mfma_f32_16x16x32_bf16 v[20:23], a[124:127], a[12:15], v[20:23]
    ds_read_b64_tr_b16 a[166:167], v47 offset:544
    v_fma_f32 v28, v28, s43, v45
    v_fma_f32 v29, v29, s43, v45
    v_mfma_f32_16x16x32_bf16 v[192:195], a[192:195], v[32:35], v[192:195]
    v_exp_f32 v28, v28
    v_mfma_f32_16x16x32_bf16 v[196:199], a[196:199], v[32:35], v[196:199]
    v_exp_f32 v29, v29
    v_mfma_f32_16x16x32_bf16 v[200:203], a[200:203], v[32:35], v[200:203]
    buffer_load_dwordx4 v58, s[8:11], s40 offen offset:2080 nt lds
    v_fma_f32 v30, v30, s43, v45
    v_fma_f32 v31, v31, s43, v45
    v_mfma_f32_16x16x32_bf16 v[204:207], a[204:207], v[32:35], v[204:207]
    ds_read_b64_tr_b16 a[168:169], v47 offset:64
    ds_read_b64_tr_b16 a[170:171], v47 offset:576
    v_mfma_f32_16x16x32_bf16 v[208:211], a[208:211], v[32:35], v[208:211]
    v_exp_f32 v30, v30
    v_mfma_f32_16x16x32_bf16 v[212:215], a[212:215], v[32:35], v[212:215]
    v_exp_f32 v31, v31
    v_mfma_f32_16x16x32_bf16 v[216:219], a[216:219], v[32:35], v[216:219]
    v_cvt_pk_bf16_f32 v36, v24, v25
    v_cvt_pk_bf16_f32 v37, v26, v27
    v_mfma_f32_16x16x32_bf16 v[220:223], a[220:223], v[32:35], v[220:223]
    v_cvt_pk_bf16_f32 v38, v28, v29
    v_cvt_pk_bf16_f32 v39, v30, v31
    v_mfma_f32_16x16x32_bf16 a[240:243], a[248:251], v[32:35], a[240:243]
    ds_read_b64_tr_b16 a[172:173], v47 offset:96
    ds_read_b64_tr_b16 a[174:175], v47 offset:608
    v_subrev_u32 v5, 66560, v5
    v_subrev_u32 v6, 66560, v6
    v_subrev_u32 v7, 66560, v7
    v_subrev_u32 v62, 66560, v62
    v_add_u32 v50, 33280, v56
    v_add_u32 v51, 33280, v63
    v_mfma_f32_16x16x32_bf16 v[24:27], a[96:99], a[16:19], 0
    s_mov_b32 s46, 0
    v_fma_f32 v16, v16, s43, v40
    v_fma_f32 v17, v17, s43, v40
    v_mfma_f32_16x16x32_bf16 v[24:27], a[100:103], a[20:23], v[24:27]
    ds_read_b64_tr_b16 a[176:177], v47 offset:128
    v_exp_f32 v16, v16
    v_mfma_f32_16x16x32_bf16 v[24:27], a[104:107], a[24:27], v[24:27]
    ds_read_b64_tr_b16 a[178:179], v47 offset:640
    v_exp_f32 v17, v17
    v_mfma_f32_16x16x32_bf16 v[24:27], a[108:111], a[28:31], v[24:27]
    s_movk_i32 s54, 14592
    v_fma_f32 v18, v18, s43, v40
    v_fma_f32 v19, v19, s43, v40
    v_mfma_f32_16x16x32_bf16 v[28:31], a[112:115], a[16:19], 0
    s_add_u32 s57, s59, s50
    v_exp_f32 v18, v18
    v_mfma_f32_16x16x32_bf16 v[28:31], a[116:119], a[20:23], v[28:31]
    ds_read_b64_tr_b16 a[180:181], v47 offset:160
    ds_read_b64_tr_b16 a[182:183], v47 offset:672
    v_mfma_f32_16x16x32_bf16 v[28:31], a[120:123], a[24:27], v[28:31]
    v_exp_f32 v19, v19
    v_mfma_f32_16x16x32_bf16 v[28:31], a[124:127], a[28:31], v[28:31]
    ds_read_b64_tr_b16 a[184:185], v47 offset:192
    v_fma_f32 v20, v20, s43, v40
    v_fma_f32 v21, v21, s43, v40
    v_mfma_f32_16x16x32_bf16 v[224:227], a[192:195], v[36:39], v[224:227]
    ds_read_b64_tr_b16 a[186:187], v47 offset:704
    v_exp_f32 v20, v20
    v_mfma_f32_16x16x32_bf16 v[228:231], a[196:199], v[36:39], v[228:231]
    v_exp_f32 v21, v21
    v_mfma_f32_16x16x32_bf16 v[232:235], a[200:203], v[36:39], v[232:235]
    v_fma_f32 v22, v22, s43, v40
    v_fma_f32 v23, v23, s43, v40
    v_mfma_f32_16x16x32_bf16 v[236:239], a[204:207], v[36:39], v[236:239]
    ds_read_b64_tr_b16 a[188:189], v47 offset:224
    ds_read_b64_tr_b16 a[190:191], v47 offset:736
    v_mfma_f32_16x16x32_bf16 v[240:243], a[208:211], v[36:39], v[240:243]
    v_exp_f32 v22, v22
    v_mfma_f32_16x16x32_bf16 v[244:247], a[212:215], v[36:39], v[244:247]
    v_exp_f32 v23, v23
    v_mfma_f32_16x16x32_bf16 v[248:251], a[216:219], v[36:39], v[248:251]
    v_cvt_pk_bf16_f32 v32, v16, v17
    v_cvt_pk_bf16_f32 v33, v18, v19
    v_mfma_f32_16x16x32_bf16 v[252:255], a[220:223], v[36:39], v[252:255]
    v_cvt_pk_bf16_f32 v34, v20, v21
    v_cvt_pk_bf16_f32 v35, v22, v23
    v_mfma_f32_16x16x32_bf16 a[244:247], a[248:251], v[36:39], a[244:247]
    buffer_load_dwordx4 v58, s[12:15], s40 offen offset:3104 nt lds
    s_waitcnt vmcnt(8)
    v_mfma_f32_16x16x32_bf16 v[16:19], a[96:99], a[32:35], 0
    s_waitcnt vmcnt(8) lgkmcnt(0)
    v_fma_f32 v24, v24, s43, v41
    v_fma_f32 v25, v25, s43, v41
    v_mfma_f32_16x16x32_bf16 v[16:19], a[100:103], a[36:39], v[16:19]
    s_barrier
    v_exp_f32 v24, v24
    v_mfma_f32_16x16x32_bf16 v[16:19], a[104:107], a[40:43], v[16:19]
    s_mov_b32 m0, s47
    v_exp_f32 v25, v25
    v_mfma_f32_16x16x32_bf16 v[16:19], a[108:111], a[44:47], v[16:19]
    s_xor_b32 s92, s92, s94
    v_fma_f32 v26, v26, s43, v41
    v_fma_f32 v27, v27, s43, v41
    v_mfma_f32_16x16x32_bf16 v[20:23], a[112:115], a[32:35], 0
    s_add_u32 s40, s40, 8192
    v_exp_f32 v26, v26
    v_add_u32 v46, s92, v48
    v_add_u32 v47, s92, v49
    v_mfma_f32_16x16x32_bf16 v[20:23], a[116:119], a[36:39], v[20:23]
    v_mfma_f32_16x16x32_bf16 v[20:23], a[120:123], a[40:43], v[20:23]
    v_exp_f32 v27, v27
    ds_read_b128 a[128:131], v46
    v_mfma_f32_16x16x32_bf16 v[20:23], a[124:127], a[44:47], v[20:23]
    v_fma_f32 v28, v28, s43, v41
    v_fma_f32 v29, v29, s43, v41
    v_mfma_f32_16x16x32_bf16 v[64:67], a[160:163], v[32:35], v[64:67]
    v_exp_f32 v28, v28
    ds_read_b128 a[132:135], v46 offset:64
    v_mfma_f32_16x16x32_bf16 v[68:71], a[164:167], v[32:35], v[68:71]
    v_exp_f32 v29, v29
    v_mfma_f32_16x16x32_bf16 v[72:75], a[168:171], v[32:35], v[72:75]
    v_fma_f32 v30, v30, s43, v41
    v_fma_f32 v31, v31, s43, v41
    v_mfma_f32_16x16x32_bf16 v[76:79], a[172:175], v[32:35], v[76:79]
    buffer_load_dwordx4 v57, s[8:11], s40 offen nt lds
    v_mfma_f32_16x16x32_bf16 v[80:83], a[176:179], v[32:35], v[80:83]
    v_exp_f32 v30, v30
    ds_read_b128 a[136:139], v46 offset:128
    v_mfma_f32_16x16x32_bf16 v[84:87], a[180:183], v[32:35], v[84:87]
    v_exp_f32 v31, v31
    ds_read_b128 a[140:143], v46 offset:192
    v_mfma_f32_16x16x32_bf16 v[88:91], a[184:187], v[32:35], v[88:91]
    v_cvt_pk_bf16_f32 v36, v24, v25
    v_cvt_pk_bf16_f32 v37, v26, v27
    v_mfma_f32_16x16x32_bf16 v[92:95], a[188:191], v[32:35], v[92:95]
    v_cvt_pk_bf16_f32 v38, v28, v29
    v_cvt_pk_bf16_f32 v39, v30, v31
    v_mfma_f32_16x16x32_bf16 a[224:227], a[248:251], v[32:35], a[224:227]
    v_mfma_f32_16x16x32_bf16 v[24:27], a[96:99], a[48:51], 0
    v_fma_f32 v16, v16, s43, v42
    v_fma_f32 v17, v17, s43, v42
    v_mfma_f32_16x16x32_bf16 v[24:27], a[100:103], a[52:55], v[24:27]
    v_exp_f32 v16, v16
    v_mfma_f32_16x16x32_bf16 v[24:27], a[104:107], a[56:59], v[24:27]
    v_exp_f32 v17, v17
    v_mfma_f32_16x16x32_bf16 v[24:27], a[108:111], a[60:63], v[24:27]
    v_fma_f32 v18, v18, s43, v42
    v_fma_f32 v19, v19, s43, v42
    v_mfma_f32_16x16x32_bf16 v[28:31], a[112:115], a[48:51], 0
    v_exp_f32 v18, v18
    v_mfma_f32_16x16x32_bf16 v[28:31], a[116:119], a[52:55], v[28:31]
    v_mfma_f32_16x16x32_bf16 v[28:31], a[120:123], a[56:59], v[28:31]
    v_exp_f32 v19, v19
    ds_read_b128 a[144:147], v46 offset:512
    v_mfma_f32_16x16x32_bf16 v[28:31], a[124:127], a[60:63], v[28:31]
    v_fma_f32 v20, v20, s43, v42
    v_fma_f32 v21, v21, s43, v42
    v_mfma_f32_16x16x32_bf16 v[96:99], a[160:163], v[36:39], v[96:99]
    v_exp_f32 v20, v20
    ds_read_b128 a[148:151], v46 offset:576
    v_mfma_f32_16x16x32_bf16 v[100:103], a[164:167], v[36:39], v[100:103]
    v_exp_f32 v21, v21
    v_mfma_f32_16x16x32_bf16 v[104:107], a[168:171], v[36:39], v[104:107]
    v_fma_f32 v22, v22, s43, v42
    v_fma_f32 v23, v23, s43, v42
    v_mfma_f32_16x16x32_bf16 v[108:111], a[172:175], v[36:39], v[108:111]
    buffer_load_dwordx4 v57, s[12:15], s40 offen offset:1024 nt lds
    v_mfma_f32_16x16x32_bf16 v[112:115], a[176:179], v[36:39], v[112:115]
    v_exp_f32 v22, v22
    ds_read_b128 a[152:155], v46 offset:640
    v_mfma_f32_16x16x32_bf16 v[116:119], a[180:183], v[36:39], v[116:119]
    v_exp_f32 v23, v23
    ds_read_b128 a[156:159], v46 offset:704
    v_mfma_f32_16x16x32_bf16 v[120:123], a[184:187], v[36:39], v[120:123]
    v_cvt_pk_bf16_f32 v32, v16, v17
    v_cvt_pk_bf16_f32 v33, v18, v19
    v_mfma_f32_16x16x32_bf16 v[124:127], a[188:191], v[36:39], v[124:127]
    v_cvt_pk_bf16_f32 v34, v20, v21
    v_cvt_pk_bf16_f32 v35, v22, v23
    v_mfma_f32_16x16x32_bf16 a[228:231], a[248:251], v[36:39], a[228:231]
    v_mfma_f32_16x16x32_bf16 v[16:19], a[96:99], a[64:67], 0
    v_fma_f32 v24, v24, s43, v43
    v_fma_f32 v25, v25, s43, v43
    v_mfma_f32_16x16x32_bf16 v[16:19], a[100:103], a[68:71], v[16:19]
    v_exp_f32 v24, v24
    v_mfma_f32_16x16x32_bf16 v[16:19], a[104:107], a[72:75], v[16:19]
    v_exp_f32 v25, v25
    v_mfma_f32_16x16x32_bf16 v[16:19], a[108:111], a[76:79], v[16:19]
    v_fma_f32 v26, v26, s43, v43
    v_fma_f32 v27, v27, s43, v43
    v_mfma_f32_16x16x32_bf16 v[20:23], a[112:115], a[64:67], 0
    v_exp_f32 v26, v26
    v_mfma_f32_16x16x32_bf16 v[20:23], a[116:119], a[68:71], v[20:23]
    v_mfma_f32_16x16x32_bf16 v[20:23], a[120:123], a[72:75], v[20:23]
    v_exp_f32 v27, v27
    ds_read_b64_tr_b16 a[192:193], v47
    v_mfma_f32_16x16x32_bf16 v[20:23], a[124:127], a[76:79], v[20:23]
    v_fma_f32 v28, v28, s43, v43
    v_fma_f32 v29, v29, s43, v43
    v_mfma_f32_16x16x32_bf16 v[128:131], a[160:163], v[32:35], v[128:131]
    v_exp_f32 v28, v28
    ds_read_b64_tr_b16 a[194:195], v47 offset:512
    v_mfma_f32_16x16x32_bf16 v[132:135], a[164:167], v[32:35], v[132:135]
    v_exp_f32 v29, v29
    v_mfma_f32_16x16x32_bf16 v[136:139], a[168:171], v[32:35], v[136:139]
    v_fma_f32 v30, v30, s43, v43
    v_fma_f32 v31, v31, s43, v43
    v_mfma_f32_16x16x32_bf16 v[140:143], a[172:175], v[32:35], v[140:143]
    buffer_load_dwordx4 v58, s[8:11], s40 offen offset:2080 nt lds
    v_mfma_f32_16x16x32_bf16 v[144:147], a[176:179], v[32:35], v[144:147]
    v_exp_f32 v30, v30
    ds_read_b64_tr_b16 a[196:197], v47 offset:32
    v_mfma_f32_16x16x32_bf16 v[148:151], a[180:183], v[32:35], v[148:151]
    v_exp_f32 v31, v31
    ds_read_b64_tr_b16 a[198:199], v47 offset:544
    v_mfma_f32_16x16x32_bf16 v[152:155], a[184:187], v[32:35], v[152:155]
    v_cvt_pk_bf16_f32 v36, v24, v25
    v_cvt_pk_bf16_f32 v37, v26, v27
    v_mfma_f32_16x16x32_bf16 v[156:159], a[188:191], v[32:35], v[156:159]
    v_cvt_pk_bf16_f32 v38, v28, v29
    v_cvt_pk_bf16_f32 v39, v30, v31
    v_mfma_f32_16x16x32_bf16 a[232:235], a[248:251], v[32:35], a[232:235]
    v_mfma_f32_16x16x32_bf16 v[24:27], a[96:99], a[80:83], 0
    v_fma_f32 v16, v16, s43, v44
    v_fma_f32 v17, v17, s43, v44
    v_mfma_f32_16x16x32_bf16 v[24:27], a[100:103], a[84:87], v[24:27]
    v_exp_f32 v16, v16
    v_mfma_f32_16x16x32_bf16 v[24:27], a[104:107], a[88:91], v[24:27]
    v_exp_f32 v17, v17
    v_mfma_f32_16x16x32_bf16 v[24:27], a[108:111], a[92:95], v[24:27]
    v_fma_f32 v18, v18, s43, v44
    v_fma_f32 v19, v19, s43, v44
    v_mfma_f32_16x16x32_bf16 v[28:31], a[112:115], a[80:83], 0
    v_exp_f32 v18, v18
    v_mfma_f32_16x16x32_bf16 v[28:31], a[116:119], a[84:87], v[28:31]
    v_mfma_f32_16x16x32_bf16 v[28:31], a[120:123], a[88:91], v[28:31]
    v_exp_f32 v19, v19
    ds_read_b64_tr_b16 a[200:201], v47 offset:64
    v_mfma_f32_16x16x32_bf16 v[28:31], a[124:127], a[92:95], v[28:31]
    v_fma_f32 v20, v20, s43, v44
    v_fma_f32 v21, v21, s43, v44
    v_mfma_f32_16x16x32_bf16 v[160:163], a[160:163], v[36:39], v[160:163]
    v_exp_f32 v20, v20
    ds_read_b64_tr_b16 a[202:203], v47 offset:576
    v_mfma_f32_16x16x32_bf16 v[164:167], a[164:167], v[36:39], v[164:167]
    v_exp_f32 v21, v21
    v_mfma_f32_16x16x32_bf16 v[168:171], a[168:171], v[36:39], v[168:171]
    v_fma_f32 v22, v22, s43, v44
    v_fma_f32 v23, v23, s43, v44
    v_mfma_f32_16x16x32_bf16 v[172:175], a[172:175], v[36:39], v[172:175]
    buffer_load_dwordx4 v58, s[12:15], s40 offen offset:3104 nt lds
    v_mfma_f32_16x16x32_bf16 v[176:179], a[176:179], v[36:39], v[176:179]
    v_exp_f32 v22, v22
    ds_read_b64_tr_b16 a[204:205], v47 offset:96
    v_mfma_f32_16x16x32_bf16 v[180:183], a[180:183], v[36:39], v[180:183]
    v_exp_f32 v23, v23
    ds_read_b64_tr_b16 a[206:207], v47 offset:608
    v_mfma_f32_16x16x32_bf16 v[184:187], a[184:187], v[36:39], v[184:187]
    v_cvt_pk_bf16_f32 v32, v16, v17
    v_cvt_pk_bf16_f32 v33, v18, v19
    v_mfma_f32_16x16x32_bf16 v[188:191], a[188:191], v[36:39], v[188:191]
    s_waitcnt lgkmcnt(8)
    v_cvt_pk_bf16_f32 v34, v20, v21
    v_cvt_pk_bf16_f32 v35, v22, v23
    v_mfma_f32_16x16x32_bf16 a[236:239], a[248:251], v[36:39], a[236:239]
    v_mfma_f32_16x16x32_bf16 v[16:19], a[128:131], a[0:3], 0
    v_fma_f32 v24, v24, s43, v45
    v_fma_f32 v25, v25, s43, v45
    v_mfma_f32_16x16x32_bf16 v[16:19], a[132:135], a[4:7], v[16:19]
    v_exp_f32 v24, v24
    v_mfma_f32_16x16x32_bf16 v[16:19], a[136:139], a[8:11], v[16:19]
    v_exp_f32 v25, v25
    v_mfma_f32_16x16x32_bf16 v[16:19], a[140:143], a[12:15], v[16:19]
    v_fma_f32 v26, v26, s43, v45
    v_fma_f32 v27, v27, s43, v45
    v_mfma_f32_16x16x32_bf16 v[20:23], a[144:147], a[0:3], 0
    v_exp_f32 v26, v26
    v_mfma_f32_16x16x32_bf16 v[20:23], a[148:151], a[4:7], v[20:23]
    v_mfma_f32_16x16x32_bf16 v[20:23], a[152:155], a[8:11], v[20:23]
    v_exp_f32 v27, v27
    ds_read_b64_tr_b16 a[208:209], v47 offset:128
    v_mfma_f32_16x16x32_bf16 v[20:23], a[156:159], a[12:15], v[20:23]
    v_fma_f32 v28, v28, s43, v45
    v_fma_f32 v29, v29, s43, v45
    v_mfma_f32_16x16x32_bf16 v[192:195], a[160:163], v[32:35], v[192:195]
    v_exp_f32 v28, v28
    ds_read_b64_tr_b16 a[210:211], v47 offset:640
    v_mfma_f32_16x16x32_bf16 v[196:199], a[164:167], v[32:35], v[196:199]
    v_exp_f32 v29, v29
    v_mfma_f32_16x16x32_bf16 v[200:203], a[168:171], v[32:35], v[200:203]
    v_fma_f32 v30, v30, s43, v45
    v_fma_f32 v31, v31, s43, v45
    v_mfma_f32_16x16x32_bf16 v[204:207], a[172:175], v[32:35], v[204:207]
    v_mfma_f32_16x16x32_bf16 v[208:211], a[176:179], v[32:35], v[208:211]
    v_exp_f32 v30, v30
    ds_read_b64_tr_b16 a[212:213], v47 offset:160
    v_mfma_f32_16x16x32_bf16 v[212:215], a[180:183], v[32:35], v[212:215]
    v_exp_f32 v31, v31
    ds_read_b64_tr_b16 a[214:215], v47 offset:672
    v_mfma_f32_16x16x32_bf16 v[216:219], a[184:187], v[32:35], v[216:219]
    v_cvt_pk_bf16_f32 v36, v24, v25
    v_cvt_pk_bf16_f32 v37, v26, v27
    v_mfma_f32_16x16x32_bf16 v[220:223], a[188:191], v[32:35], v[220:223]
    v_cvt_pk_bf16_f32 v38, v28, v29
    v_cvt_pk_bf16_f32 v39, v30, v31
    v_mfma_f32_16x16x32_bf16 a[240:243], a[248:251], v[32:35], a[240:243]
    v_mfma_f32_16x16x32_bf16 v[24:27], a[128:131], a[16:19], 0
    v_fma_f32 v16, v16, s43, v40
    v_fma_f32 v17, v17, s43, v40
    v_mfma_f32_16x16x32_bf16 v[24:27], a[132:135], a[20:23], v[24:27]
    v_exp_f32 v16, v16
    v_mfma_f32_16x16x32_bf16 v[24:27], a[136:139], a[24:27], v[24:27]
    v_exp_f32 v17, v17
    ds_read_b64_tr_b16 a[216:217], v47 offset:192
    v_mfma_f32_16x16x32_bf16 v[24:27], a[140:143], a[28:31], v[24:27]
    v_fma_f32 v18, v18, s43, v40
    v_fma_f32 v19, v19, s43, v40
    v_mfma_f32_16x16x32_bf16 v[28:31], a[144:147], a[16:19], 0
Lpad8:
    s_cbranch_execz Lret8
    v_exp_f32 v18, v18
    v_mfma_f32_16x16x32_bf16 v[28:31], a[148:151], a[20:23], v[28:31]
    v_mfma_f32_16x16x32_bf16 v[28:31], a[152:155], a[24:27], v[28:31]
    v_exp_f32 v19, v19
    ds_read_b64_tr_b16 a[218:219], v47 offset:704
    v_mfma_f32_16x16x32_bf16 v[28:31], a[156:159], a[28:31], v[28:31]
    v_fma_f32 v20, v20, s43, v40
    v_fma_f32 v21, v21, s43, v40
    v_mfma_f32_16x16x32_bf16 v[224:227], a[160:163], v[36:39], v[224:227]
    v_exp_f32 v20, v20
    ds_read_b64_tr_b16 a[220:221], v47 offset:224
    v_mfma_f32_16x16x32_bf16 v[228:231], a[164:167], v[36:39], v[228:231]
    v_exp_f32 v21, v21
    ds_read_b64_tr_b16 a[222:223], v47 offset:736
    v_mfma_f32_16x16x32_bf16 v[232:235], a[168:171], v[36:39], v[232:235]
    v_fma_f32 v22, v22, s43, v40
    v_fma_f32 v23, v23, s43, v40
    v_mfma_f32_16x16x32_bf16 v[236:239], a[172:175], v[36:39], v[236:239]
    v_mfma_f32_16x16x32_bf16 v[240:243], a[176:179], v[36:39], v[240:243]
    v_exp_f32 v22, v22
    v_mfma_f32_16x16x32_bf16 v[244:247], a[180:183], v[36:39], v[244:247]
    v_exp_f32 v23, v23
    v_mfma_f32_16x16x32_bf16 v[248:251], a[184:187], v[36:39], v[248:251]
    v_cvt_pk_bf16_f32 v32, v16, v17
    v_cvt_pk_bf16_f32 v33, v18, v19
    v_mfma_f32_16x16x32_bf16 v[252:255], a[188:191], v[36:39], v[252:255]
    v_cvt_pk_bf16_f32 v34, v20, v21
    v_cvt_pk_bf16_f32 v35, v22, v23
    v_mfma_f32_16x16x32_bf16 a[244:247], a[248:251], v[36:39], a[244:247]
    v_mfma_f32_16x16x32_bf16 v[16:19], a[128:131], a[32:35], 0
    s_waitcnt vmcnt(8) lgkmcnt(0)
    v_fma_f32 v24, v24, s43, v41
    v_fma_f32 v25, v25, s43, v41
    v_mfma_f32_16x16x32_bf16 v[16:19], a[132:135], a[36:39], v[16:19]
    s_barrier
    v_exp_f32 v24, v24
    v_mfma_f32_16x16x32_bf16 v[16:19], a[136:139], a[40:43], v[16:19]
    s_mov_b32 m0, s92
    v_exp_f32 v25, v25
    v_mfma_f32_16x16x32_bf16 v[16:19], a[140:143], a[44:47], v[16:19]
    s_xor_b32 s47, s47, s93
    v_fma_f32 v26, v26, s43, v41
    v_fma_f32 v27, v27, s43, v41
    v_mfma_f32_16x16x32_bf16 v[20:23], a[144:147], a[32:35], 0
    s_add_u32 s40, s40, 8192
    v_exp_f32 v26, v26
    v_add_u32 v46, s47, v48
    v_add_u32 v47, s47, v49
    v_mfma_f32_16x16x32_bf16 v[20:23], a[148:151], a[36:39], v[20:23]
    v_mfma_f32_16x16x32_bf16 v[20:23], a[152:155], a[40:43], v[20:23]
    v_exp_f32 v27, v27
    ds_read_b128 a[96:99], v46
    v_mfma_f32_16x16x32_bf16 v[20:23], a[156:159], a[44:47], v[20:23]
    v_fma_f32 v28, v28, s43, v41
    v_fma_f32 v29, v29, s43, v41
    v_mfma_f32_16x16x32_bf16 v[64:67], a[192:195], v[32:35], v[64:67]
    v_exp_f32 v28, v28
    ds_read_b128 a[100:103], v46 offset:64
    v_mfma_f32_16x16x32_bf16 v[68:71], a[196:199], v[32:35], v[68:71]
    v_exp_f32 v29, v29
    v_mfma_f32_16x16x32_bf16 v[72:75], a[200:203], v[32:35], v[72:75]
    v_fma_f32 v30, v30, s43, v41
    v_fma_f32 v31, v31, s43, v41
    v_mfma_f32_16x16x32_bf16 v[76:79], a[204:207], v[32:35], v[76:79]
    buffer_load_dwordx4 v57, s[8:11], s40 offen nt lds
    v_mfma_f32_16x16x32_bf16 v[80:83], a[208:211], v[32:35], v[80:83]
    v_exp_f32 v30, v30
    v_mfma_f32_16x16x32_bf16 v[84:87], a[212:215], v[32:35], v[84:87]
    v_exp_f32 v31, v31
    v_mfma_f32_16x16x32_bf16 v[88:91], a[216:219], v[32:35], v[88:91]
    v_cvt_pk_bf16_f32 v36, v24, v25
    v_cvt_pk_bf16_f32 v37, v26, v27
    v_mfma_f32_16x16x32_bf16 v[92:95], a[220:223], v[32:35], v[92:95]
    v_cvt_pk_bf16_f32 v38, v28, v29
    v_cvt_pk_bf16_f32 v39, v30, v31
    v_mfma_f32_16x16x32_bf16 a[224:227], a[248:251], v[32:35], a[224:227]
    ds_read_b128 a[104:107], v46 offset:128
    ds_read_b128 a[108:111], v46 offset:192
    v_mfma_f32_16x16x32_bf16 v[24:27], a[128:131], a[48:51], 0
    v_fma_f32 v16, v16, s43, v42
    v_fma_f32 v17, v17, s43, v42
    v_mfma_f32_16x16x32_bf16 v[24:27], a[132:135], a[52:55], v[24:27]
    v_exp_f32 v16, v16
    v_mfma_f32_16x16x32_bf16 v[24:27], a[136:139], a[56:59], v[24:27]
    v_exp_f32 v17, v17
    v_mfma_f32_16x16x32_bf16 v[24:27], a[140:143], a[60:63], v[24:27]
    v_fma_f32 v18, v18, s43, v42
    v_fma_f32 v19, v19, s43, v42
    v_mfma_f32_16x16x32_bf16 v[28:31], a[144:147], a[48:51], 0
    v_exp_f32 v18, v18
    v_mfma_f32_16x16x32_bf16 v[28:31], a[148:151], a[52:55], v[28:31]
    v_mfma_f32_16x16x32_bf16 v[28:31], a[152:155], a[56:59], v[28:31]
    v_exp_f32 v19, v19
    ds_read_b128 a[112:115], v46 offset:512
    v_mfma_f32_16x16x32_bf16 v[28:31], a[156:159], a[60:63], v[28:31]
    v_fma_f32 v20, v20, s43, v42
    v_fma_f32 v21, v21, s43, v42
    v_mfma_f32_16x16x32_bf16 v[96:99], a[192:195], v[36:39], v[96:99]
    v_exp_f32 v20, v20
    ds_read_b128 a[116:119], v46 offset:576
    v_mfma_f32_16x16x32_bf16 v[100:103], a[196:199], v[36:39], v[100:103]
    v_exp_f32 v21, v21
    v_mfma_f32_16x16x32_bf16 v[104:107], a[200:203], v[36:39], v[104:107]
    v_fma_f32 v22, v22, s43, v42
    v_fma_f32 v23, v23, s43, v42
    v_mfma_f32_16x16x32_bf16 v[108:111], a[204:207], v[36:39], v[108:111]
    buffer_load_dwordx4 v57, s[12:15], s40 offen offset:1024 nt lds
    v_mfma_f32_16x16x32_bf16 v[112:115], a[208:211], v[36:39], v[112:115]
    v_exp_f32 v22, v22
    v_mfma_f32_16x16x32_bf16 v[116:119], a[212:215], v[36:39], v[116:119]
    v_exp_f32 v23, v23
    v_mfma_f32_16x16x32_bf16 v[120:123], a[216:219], v[36:39], v[120:123]
    v_cvt_pk_bf16_f32 v32, v16, v17
    v_cvt_pk_bf16_f32 v33, v18, v19
    v_mfma_f32_16x16x32_bf16 v[124:127], a[220:223], v[36:39], v[124:127]
    v_cvt_pk_bf16_f32 v34, v20, v21
    v_cvt_pk_bf16_f32 v35, v22, v23
    v_mfma_f32_16x16x32_bf16 a[228:231], a[248:251], v[36:39], a[228:231]
    ds_read_b128 a[120:123], v46 offset:640
    ds_read_b128 a[124:127], v46 offset:704
    v_mfma_f32_16x16x32_bf16 v[16:19], a[128:131], a[64:67], 0
    v_fma_f32 v24, v24, s43, v43
    v_fma_f32 v25, v25, s43, v43
    v_mfma_f32_16x16x32_bf16 v[16:19], a[132:135], a[68:71], v[16:19]
    v_exp_f32 v24, v24
    v_mfma_f32_16x16x32_bf16 v[16:19], a[136:139], a[72:75], v[16:19]
    v_exp_f32 v25, v25
    v_mfma_f32_16x16x32_bf16 v[16:19], a[140:143], a[76:79], v[16:19]
    v_fma_f32 v26, v26, s43, v43
    v_fma_f32 v27, v27, s43, v43
    v_mfma_f32_16x16x32_bf16 v[20:23], a[144:147], a[64:67], 0
    v_exp_f32 v26, v26
    v_mfma_f32_16x16x32_bf16 v[20:23], a[148:151], a[68:71], v[20:23]
    v_mfma_f32_16x16x32_bf16 v[20:23], a[152:155], a[72:75], v[20:23]
    v_exp_f32 v27, v27
    ds_read_b64_tr_b16 a[160:161], v47
    v_mfma_f32_16x16x32_bf16 v[20:23], a[156:159], a[76:79], v[20:23]
    v_fma_f32 v28, v28, s43, v43
    v_fma_f32 v29, v29, s43, v43
    v_mfma_f32_16x16x32_bf16 v[128:131], a[192:195], v[32:35], v[128:131]
    v_exp_f32 v28, v28
    ds_read_b64_tr_b16 a[162:163], v47 offset:512
    v_mfma_f32_16x16x32_bf16 v[132:135], a[196:199], v[32:35], v[132:135]
    v_exp_f32 v29, v29
    v_mfma_f32_16x16x32_bf16 v[136:139], a[200:203], v[32:35], v[136:139]
    v_fma_f32 v30, v30, s43, v43
    v_fma_f32 v31, v31, s43, v43
    v_mfma_f32_16x16x32_bf16 v[140:143], a[204:207], v[32:35], v[140:143]
    buffer_load_dwordx4 v58, s[8:11], s40 offen offset:2080 nt lds
    v_mfma_f32_16x16x32_bf16 v[144:147], a[208:211], v[32:35], v[144:147]
    v_exp_f32 v30, v30
    v_mfma_f32_16x16x32_bf16 v[148:151], a[212:215], v[32:35], v[148:151]
    v_exp_f32 v31, v31
    v_mfma_f32_16x16x32_bf16 v[152:155], a[216:219], v[32:35], v[152:155]
    v_cvt_pk_bf16_f32 v36, v24, v25
    v_cvt_pk_bf16_f32 v37, v26, v27
    v_mfma_f32_16x16x32_bf16 v[156:159], a[220:223], v[32:35], v[156:159]
    v_cvt_pk_bf16_f32 v38, v28, v29
    v_cvt_pk_bf16_f32 v39, v30, v31
    v_mfma_f32_16x16x32_bf16 a[232:235], a[248:251], v[32:35], a[232:235]
    ds_read_b64_tr_b16 a[164:165], v47 offset:32
    ds_read_b64_tr_b16 a[166:167], v47 offset:544
    v_mfma_f32_16x16x32_bf16 v[24:27], a[128:131], a[80:83], 0
    v_fma_f32 v16, v16, s43, v44
    v_fma_f32 v17, v17, s43, v44
    v_mfma_f32_16x16x32_bf16 v[24:27], a[132:135], a[84:87], v[24:27]
    v_exp_f32 v16, v16
    v_mfma_f32_16x16x32_bf16 v[24:27], a[136:139], a[88:91], v[24:27]
    v_exp_f32 v17, v17
    v_mfma_f32_16x16x32_bf16 v[24:27], a[140:143], a[92:95], v[24:27]
    v_fma_f32 v18, v18, s43, v44
    v_fma_f32 v19, v19, s43, v44
    v_mfma_f32_16x16x32_bf16 v[28:31], a[144:147], a[80:83], 0
    v_exp_f32 v18, v18
    v_mfma_f32_16x16x32_bf16 v[28:31], a[148:151], a[84:87], v[28:31]
    v_mfma_f32_16x16x32_bf16 v[28:31], a[152:155], a[88:91], v[28:31]
    v_exp_f32 v19, v19
    ds_read_b64_tr_b16 a[168:169], v47 offset:64
    v_mfma_f32_16x16x32_bf16 v[28:31], a[156:159], a[92:95], v[28:31]
    v_fma_f32 v20, v20, s43, v44
    v_fma_f32 v21, v21, s43, v44
    v_mfma_f32_16x16x32_bf16 v[160:163], a[192:195], v[36:39], v[160:163]
    v_exp_f32 v20, v20
    ds_read_b64_tr_b16 a[170:171], v47 offset:576
    v_mfma_f32_16x16x32_bf16 v[164:167], a[196:199], v[36:39], v[164:167]
    v_exp_f32 v21, v21
    v_mfma_f32_16x16x32_bf16 v[168:171], a[200:203], v[36:39], v[168:171]
    v_fma_f32 v22, v22, s43, v44
    v_fma_f32 v23, v23, s43, v44
    v_mfma_f32_16x16x32_bf16 v[172:175], a[204:207], v[36:39], v[172:175]
    buffer_load_dwordx4 v58, s[12:15], s40 offen offset:3104 nt lds
    v_mfma_f32_16x16x32_bf16 v[176:179], a[208:211], v[36:39], v[176:179]
    v_exp_f32 v22, v22
    v_mfma_f32_16x16x32_bf16 v[180:183], a[212:215], v[36:39], v[180:183]
    v_exp_f32 v23, v23
    v_mfma_f32_16x16x32_bf16 v[184:187], a[216:219], v[36:39], v[184:187]
    v_cvt_pk_bf16_f32 v32, v16, v17
    v_cvt_pk_bf16_f32 v33, v18, v19
    v_mfma_f32_16x16x32_bf16 v[188:191], a[220:223], v[36:39], v[188:191]
    s_waitcnt lgkmcnt(6)
    v_cvt_pk_bf16_f32 v34, v20, v21
    v_cvt_pk_bf16_f32 v35, v22, v23
    v_mfma_f32_16x16x32_bf16 a[236:239], a[248:251], v[36:39], a[236:239]
    ds_read_b64_tr_b16 a[172:173], v47 offset:96
    ds_read_b64_tr_b16 a[174:175], v47 offset:608
    v_mfma_f32_16x16x32_bf16 v[16:19], a[96:99], a[0:3], 0
    v_fma_f32 v24, v24, s43, v45
    v_fma_f32 v25, v25, s43, v45
    v_mfma_f32_16x16x32_bf16 v[16:19], a[100:103], a[4:7], v[16:19]
    v_exp_f32 v24, v24
    v_mfma_f32_16x16x32_bf16 v[16:19], a[104:107], a[8:11], v[16:19]
    v_exp_f32 v25, v25
    v_mfma_f32_16x16x32_bf16 v[16:19], a[108:111], a[12:15], v[16:19]
    v_fma_f32 v26, v26, s43, v45
    v_fma_f32 v27, v27, s43, v45
    v_mfma_f32_16x16x32_bf16 v[20:23], a[112:115], a[0:3], 0
    v_exp_f32 v26, v26
    v_mfma_f32_16x16x32_bf16 v[20:23], a[116:119], a[4:7], v[20:23]
    v_mfma_f32_16x16x32_bf16 v[20:23], a[120:123], a[8:11], v[20:23]
    v_exp_f32 v27, v27
    ds_read_b64_tr_b16 a[176:177], v47 offset:128
    v_mfma_f32_16x16x32_bf16 v[20:23], a[124:127], a[12:15], v[20:23]
    v_fma_f32 v28, v28, s43, v45
    v_fma_f32 v29, v29, s43, v45
    v_mfma_f32_16x16x32_bf16 v[192:195], a[192:195], v[32:35], v[192:195]
    v_exp_f32 v28, v28
    ds_read_b64_tr_b16 a[178:179], v47 offset:640
    v_mfma_f32_16x16x32_bf16 v[196:199], a[196:199], v[32:35], v[196:199]
    v_exp_f32 v29, v29
    v_mfma_f32_16x16x32_bf16 v[200:203], a[200:203], v[32:35], v[200:203]
    v_fma_f32 v30, v30, s43, v45
    v_fma_f32 v31, v31, s43, v45
    v_mfma_f32_16x16x32_bf16 v[204:207], a[204:207], v[32:35], v[204:207]
    v_mfma_f32_16x16x32_bf16 v[208:211], a[208:211], v[32:35], v[208:211]
    v_exp_f32 v30, v30
    v_mfma_f32_16x16x32_bf16 v[212:215], a[212:215], v[32:35], v[212:215]
    v_exp_f32 v31, v31
    v_mfma_f32_16x16x32_bf16 v[216:219], a[216:219], v[32:35], v[216:219]
    v_cvt_pk_bf16_f32 v36, v24, v25
    v_cvt_pk_bf16_f32 v37, v26, v27
    v_mfma_f32_16x16x32_bf16 v[220:223], a[220:223], v[32:35], v[220:223]
    v_cvt_pk_bf16_f32 v38, v28, v29
    v_cvt_pk_bf16_f32 v39, v30, v31
    v_mfma_f32_16x16x32_bf16 a[240:243], a[248:251], v[32:35], a[240:243]
    ds_read_b64_tr_b16 a[180:181], v47 offset:160
    ds_read_b64_tr_b16 a[182:183], v47 offset:672
    v_mfma_f32_16x16x32_bf16 v[24:27], a[96:99], a[16:19], 0
    v_fma_f32 v16, v16, s43, v40
    v_fma_f32 v17, v17, s43, v40
    v_mfma_f32_16x16x32_bf16 v[24:27], a[100:103], a[20:23], v[24:27]
    v_exp_f32 v16, v16
    v_mfma_f32_16x16x32_bf16 v[24:27], a[104:107], a[24:27], v[24:27]
    v_exp_f32 v17, v17
    ds_read_b64_tr_b16 a[184:185], v47 offset:192
    v_mfma_f32_16x16x32_bf16 v[24:27], a[108:111], a[28:31], v[24:27]
    v_fma_f32 v18, v18, s43, v40
    v_fma_f32 v19, v19, s43, v40
    v_mfma_f32_16x16x32_bf16 v[28:31], a[112:115], a[16:19], 0
    v_exp_f32 v18, v18
    v_mfma_f32_16x16x32_bf16 v[28:31], a[116:119], a[20:23], v[28:31]
    v_mfma_f32_16x16x32_bf16 v[28:31], a[120:123], a[24:27], v[28:31]
    v_exp_f32 v19, v19
    ds_read_b64_tr_b16 a[186:187], v47 offset:704
    v_mfma_f32_16x16x32_bf16 v[28:31], a[124:127], a[28:31], v[28:31]
    v_fma_f32 v20, v20, s43, v40
    v_fma_f32 v21, v21, s43, v40
    v_mfma_f32_16x16x32_bf16 v[224:227], a[192:195], v[36:39], v[224:227]
    v_exp_f32 v20, v20
    v_mfma_f32_16x16x32_bf16 v[228:231], a[196:199], v[36:39], v[228:231]
    v_exp_f32 v21, v21
    v_mfma_f32_16x16x32_bf16 v[232:235], a[200:203], v[36:39], v[232:235]
    v_fma_f32 v22, v22, s43, v40
    v_fma_f32 v23, v23, s43, v40
    v_mfma_f32_16x16x32_bf16 v[236:239], a[204:207], v[36:39], v[236:239]
    ds_read_b64_tr_b16 a[188:189], v47 offset:224
    ds_read_b64_tr_b16 a[190:191], v47 offset:736
    v_mfma_f32_16x16x32_bf16 v[240:243], a[208:211], v[36:39], v[240:243]
    v_exp_f32 v22, v22
    v_mfma_f32_16x16x32_bf16 v[244:247], a[212:215], v[36:39], v[244:247]
    v_exp_f32 v23, v23
    v_mfma_f32_16x16x32_bf16 v[248:251], a[216:219], v[36:39], v[248:251]
    v_cvt_pk_bf16_f32 v32, v16, v17
    v_cvt_pk_bf16_f32 v33, v18, v19
    v_mfma_f32_16x16x32_bf16 v[252:255], a[220:223], v[36:39], v[252:255]
    v_cvt_pk_bf16_f32 v34, v20, v21
    v_cvt_pk_bf16_f32 v35, v22, v23
    v_mfma_f32_16x16x32_bf16 a[244:247], a[248:251], v[36:39], a[244:247]
.p2align 3
LloopB:
    v_mfma_f32_16x16x32_bf16 v[16:19], a[96:99], a[32:35], 0
    s_waitcnt vmcnt(8) lgkmcnt(0)
    v_fma_f32 v24, v24, s43, v41
    v_fma_f32 v25, v25, s43, v41
    v_mfma_f32_16x16x32_bf16 v[16:19], a[100:103], a[36:39], v[16:19]
    s_barrier
    v_exp_f32 v24, v24
    v_mfma_f32_16x16x32_bf16 v[16:19], a[104:107], a[40:43], v[16:19]
    s_mov_b32 m0, s47
    v_exp_f32 v25, v25
    v_mfma_f32_16x16x32_bf16 v[16:19], a[108:111], a[44:47], v[16:19]
    s_xor_b32 s92, s92, s94
    v_fma_f32 v26, v26, s43, v41
    v_fma_f32 v27, v27, s43, v41
    v_mfma_f32_16x16x32_bf16 v[20:23], a[112:115], a[32:35], 0
    s_add_u32 s40, s40, 8192
    v_exp_f32 v26, v26
    v_add_u32 v46, s92, v48
    v_add_u32 v47, s92, v49
    v_mfma_f32_16x16x32_bf16 v[20:23], a[116:119], a[36:39], v[20:23]
    ds_read_b128 a[128:131], v46
    ds_read_b128 a[132:135], v46 offset:64
    v_mfma_f32_16x16x32_bf16 v[20:23], a[120:123], a[40:43], v[20:23]
    v_exp_f32 v27, v27
    v_mfma_f32_16x16x32_bf16 v[20:23], a[124:127], a[44:47], v[20:23]
    v_fma_f32 v28, v28, s43, v41
    v_fma_f32 v29, v29, s43, v41
    v_mfma_f32_16x16x32_bf16 v[64:67], a[160:163], v[32:35], v[64:67]
    v_exp_f32 v28, v28
    v_mfma_f32_16x16x32_bf16 v[68:71], a[164:167], v[32:35], v[68:71]
    v_exp_f32 v29, v29
    v_mfma_f32_16x16x32_bf16 v[72:75], a[168:171], v[32:35], v[72:75]
    v_fma_f32 v30, v30, s43, v41
    v_fma_f32 v31, v31, s43, v41
    v_mfma_f32_16x16x32_bf16 v[76:79], a[172:175], v[32:35], v[76:79]
    buffer_load_dwordx4 v57, s[8:11], s40 offen nt lds
    v_mfma_f32_16x16x32_bf16 v[80:83], a[176:179], v[32:35], v[80:83]
    v_exp_f32 v30, v30
    v_mfma_f32_16x16x32_bf16 v[84:87], a[180:183], v[32:35], v[84:87]
    v_exp_f32 v31, v31
    v_mfma_f32_16x16x32_bf16 v[88:91], a[184:187], v[32:35], v[88:91]
    v_cvt_pk_bf16_f32 v36, v24, v25
    v_cvt_pk_bf16_f32 v37, v26, v27
    v_mfma_f32_16x16x32_bf16 v[92:95], a[188:191], v[32:35], v[92:95]
    v_cvt_pk_bf16_f32 v38, v28, v29
    v_cvt_pk_bf16_f32 v39, v30, v31
    v_mfma_f32_16x16x32_bf16 a[224:227], a[248:251], v[32:35], a[224:227]
    ds_read_b128 a[136:139], v46 offset:128
    ds_read_b128 a[140:143], v46 offset:192
    v_mfma_f32_16x16x32_bf16 v[24:27], a[96:99], a[48:51], 0
    v_fma_f32 v16, v16, s43, v42
    v_fma_f32 v17, v17, s43, v42
    v_mfma_f32_16x16x32_bf16 v[24:27], a[100:103], a[52:55], v[24:27]
    v_exp_f32 v16, v16
    v_mfma_f32_16x16x32_bf16 v[24:27], a[104:107], a[56:59], v[24:27]
    v_exp_f32 v17, v17
    v_mfma_f32_16x16x32_bf16 v[24:27], a[108:111], a[60:63], v[24:27]
    v_fma_f32 v18, v18, s43, v42
    v_fma_f32 v19, v19, s43, v42
    v_mfma_f32_16x16x32_bf16 v[28:31], a[112:115], a[48:51], 0
    v_exp_f32 v18, v18
    v_mfma_f32_16x16x32_bf16 v[28:31], a[116:119], a[52:55], v[28:31]
    ds_read_b128 a[144:147], v46 offset:512
    ds_read_b128 a[148:151], v46 offset:576
    v_mfma_f32_16x16x32_bf16 v[28:31], a[120:123], a[56:59], v[28:31]
    v_exp_f32 v19, v19
    v_mfma_f32_16x16x32_bf16 v[28:31], a[124:127], a[60:63], v[28:31]
    v_fma_f32 v20, v20, s43, v42
    v_fma_f32 v21, v21, s43, v42
    v_mfma_f32_16x16x32_bf16 v[96:99], a[160:163], v[36:39], v[96:99]
    v_exp_f32 v20, v20
    v_mfma_f32_16x16x32_bf16 v[100:103], a[164:167], v[36:39], v[100:103]
    v_exp_f32 v21, v21
    v_mfma_f32_16x16x32_bf16 v[104:107], a[168:171], v[36:39], v[104:107]
    v_fma_f32 v22, v22, s43, v42
    v_fma_f32 v23, v23, s43, v42
    v_mfma_f32_16x16x32_bf16 v[108:111], a[172:175], v[36:39], v[108:111]
    buffer_load_dwordx4 v57, s[12:15], s40 offen offset:1024 nt lds
    v_mfma_f32_16x16x32_bf16 v[112:115], a[176:179], v[36:39], v[112:115]
    v_exp_f32 v22, v22
    v_mfma_f32_16x16x32_bf16 v[116:119], a[180:183], v[36:39], v[116:119]
    v_exp_f32 v23, v23
    v_mfma_f32_16x16x32_bf16 v[120:123], a[184:187], v[36:39], v[120:123]
    v_cvt_pk_bf16_f32 v32, v16, v17
    v_cvt_pk_bf16_f32 v33, v18, v19
    v_mfma_f32_16x16x32_bf16 v[124:127], a[188:191], v[36:39], v[124:127]
    v_cvt_pk_bf16_f32 v34, v20, v21
    v_cvt_pk_bf16_f32 v35, v22, v23
    v_mfma_f32_16x16x32_bf16 a[228:231], a[248:251], v[36:39], a[228:231]
    ds_read_b128 a[152:155], v46 offset:640
    ds_read_b128 a[156:159], v46 offset:704
    v_mfma_f32_16x16x32_bf16 v[16:19], a[96:99], a[64:67], 0
    v_fma_f32 v24, v24, s43, v43
    v_fma_f32 v25, v25, s43, v43
    v_mfma_f32_16x16x32_bf16 v[16:19], a[100:103], a[68:71], v[16:19]
    v_exp_f32 v24, v24
    v_mfma_f32_16x16x32_bf16 v[16:19], a[104:107], a[72:75], v[16:19]
    v_exp_f32 v25, v25
    v_mfma_f32_16x16x32_bf16 v[16:19], a[108:111], a[76:79], v[16:19]
    v_fma_f32 v26, v26, s43, v43
    v_fma_f32 v27, v27, s43, v43
    v_mfma_f32_16x16x32_bf16 v[20:23], a[112:115], a[64:67], 0
    v_exp_f32 v26, v26
    v_mfma_f32_16x16x32_bf16 v[20:23], a[116:119], a[68:71], v[20:23]
    ds_read_b64_tr_b16 a[192:193], v47
    ds_read_b64_tr_b16 a[194:195], v47 offset:512
    v_mfma_f32_16x16x32_bf16 v[20:23], a[120:123], a[72:75], v[20:23]
    v_exp_f32 v27, v27
    v_mfma_f32_16x16x32_bf16 v[20:23], a[124:127], a[76:79], v[20:23]
    v_fma_f32 v28, v28, s43, v43
    v_fma_f32 v29, v29, s43, v43
    v_mfma_f32_16x16x32_bf16 v[128:131], a[160:163], v[32:35], v[128:131]
    v_exp_f32 v28, v28
    v_mfma_f32_16x16x32_bf16 v[132:135], a[164:167], v[32:35], v[132:135]
    v_exp_f32 v29, v29
    v_mfma_f32_16x16x32_bf16 v[136:139], a[168:171], v[32:35], v[136:139]
    v_fma_f32 v30, v30, s43, v43
    v_fma_f32 v31, v31, s43, v43
    v_mfma_f32_16x16x32_bf16 v[140:143], a[172:175], v[32:35], v[140:143]
    buffer_load_dwordx4 v58, s[8:11], s40 offen offset:2080 nt lds
    v_mfma_f32_16x16x32_bf16 v[144:147], a[176:179], v[32:35], v[144:147]
    v_exp_f32 v30, v30
    v_mfma_f32_16x16x32_bf16 v[148:151], a[180:183], v[32:35], v[148:151]
    v_exp_f32 v31, v31
    v_mfma_f32_16x16x32_bf16 v[152:155], a[184:187], v[32:35], v[152:155]
    v_cvt_pk_bf16_f32 v36, v24, v25
    v_cvt_pk_bf16_f32 v37, v26, v27
    v_mfma_f32_16x16x32_bf16 v[156:159], a[188:191], v[32:35], v[156:159]
    v_cvt_pk_bf16_f32 v38, v28, v29
    v_cvt_pk_bf16_f32 v39, v30, v31
    v_mfma_f32_16x16x32_bf16 a[232:235], a[248:251], v[32:35], a[232:235]
    ds_read_b64_tr_b16 a[196:197], v47 offset:32
    ds_read_b64_tr_b16 a[198:199], v47 offset:544
    v_mfma_f32_16x16x32_bf16 v[24:27], a[96:99], a[80:83], 0
    v_fma_f32 v16, v16, s43, v44
    v_fma_f32 v17, v17, s43, v44
    v_mfma_f32_16x16x32_bf16 v[24:27], a[100:103], a[84:87], v[24:27]
    v_exp_f32 v16, v16
    v_mfma_f32_16x16x32_bf16 v[24:27], a[104:107], a[88:91], v[24:27]
    v_exp_f32 v17, v17
    v_mfma_f32_16x16x32_bf16 v[24:27], a[108:111], a[92:95], v[24:27]
    v_fma_f32 v18, v18, s43, v44
    v_fma_f32 v19, v19, s43, v44
    v_mfma_f32_16x16x32_bf16 v[28:31], a[112:115], a[80:83], 0
    v_exp_f32 v18, v18
    v_mfma_f32_16x16x32_bf16 v[28:31], a[116:119], a[84:87], v[28:31]
    ds_read_b64_tr_b16 a[200:201], v47 offset:64
    ds_read_b64_tr_b16 a[202:203], v47 offset:576
    v_mfma_f32_16x16x32_bf16 v[28:31], a[120:123], a[88:91], v[28:31]
    v_exp_f32 v19, v19
    v_mfma_f32_16x16x32_bf16 v[28:31], a[124:127], a[92:95], v[28:31]
    v_fma_f32 v20, v20, s43, v44
    v_fma_f32 v21, v21, s43, v44
    v_mfma_f32_16x16x32_bf16 v[160:163], a[160:163], v[36:39], v[160:163]
    v_exp_f32 v20, v20
    v_mfma_f32_16x16x32_bf16 v[164:167], a[164:167], v[36:39], v[164:167]
    v_exp_f32 v21, v21
    v_mfma_f32_16x16x32_bf16 v[168:171], a[168:171], v[36:39], v[168:171]
    v_fma_f32 v22, v22, s43, v44
    v_fma_f32 v23, v23, s43, v44
    v_mfma_f32_16x16x32_bf16 v[172:175], a[172:175], v[36:39], v[172:175]
    buffer_load_dwordx4 v58, s[12:15], s40 offen offset:3104 nt lds
    v_mfma_f32_16x16x32_bf16 v[176:179], a[176:179], v[36:39], v[176:179]
    v_exp_f32 v22, v22
    v_mfma_f32_16x16x32_bf16 v[180:183], a[180:183], v[36:39], v[180:183]
    v_exp_f32 v23, v23
    v_mfma_f32_16x16x32_bf16 v[184:187], a[184:187], v[36:39], v[184:187]
    v_cvt_pk_bf16_f32 v32, v16, v17
    v_cvt_pk_bf16_f32 v33, v18, v19
    v_mfma_f32_16x16x32_bf16 v[188:191], a[188:191], v[36:39], v[188:191]
    s_waitcnt lgkmcnt(6)
    v_cvt_pk_bf16_f32 v34, v20, v21
    v_cvt_pk_bf16_f32 v35, v22, v23
    v_mfma_f32_16x16x32_bf16 a[236:239], a[248:251], v[36:39], a[236:239]
    ds_read_b64_tr_b16 a[204:205], v47 offset:96
    ds_read_b64_tr_b16 a[206:207], v47 offset:608
    v_mfma_f32_16x16x32_bf16 v[16:19], a[128:131], a[0:3], 0
    v_fma_f32 v24, v24, s43, v45
    v_fma_f32 v25, v25, s43, v45
    v_mfma_f32_16x16x32_bf16 v[16:19], a[132:135], a[4:7], v[16:19]
    v_exp_f32 v24, v24
    v_mfma_f32_16x16x32_bf16 v[16:19], a[136:139], a[8:11], v[16:19]
    v_exp_f32 v25, v25
    v_mfma_f32_16x16x32_bf16 v[16:19], a[140:143], a[12:15], v[16:19]
    v_fma_f32 v26, v26, s43, v45
    v_fma_f32 v27, v27, s43, v45
    v_mfma_f32_16x16x32_bf16 v[20:23], a[144:147], a[0:3], 0
    v_exp_f32 v26, v26
    v_mfma_f32_16x16x32_bf16 v[20:23], a[148:151], a[4:7], v[20:23]
    ds_read_b64_tr_b16 a[208:209], v47 offset:128
    ds_read_b64_tr_b16 a[210:211], v47 offset:640
    v_mfma_f32_16x16x32_bf16 v[20:23], a[152:155], a[8:11], v[20:23]
    v_exp_f32 v27, v27
    v_mfma_f32_16x16x32_bf16 v[20:23], a[156:159], a[12:15], v[20:23]
    v_fma_f32 v28, v28, s43, v45
    v_fma_f32 v29, v29, s43, v45
    v_mfma_f32_16x16x32_bf16 v[192:195], a[160:163], v[32:35], v[192:195]
    v_exp_f32 v28, v28
    v_mfma_f32_16x16x32_bf16 v[196:199], a[164:167], v[32:35], v[196:199]
    v_exp_f32 v29, v29
    v_mfma_f32_16x16x32_bf16 v[200:203], a[168:171], v[32:35], v[200:203]
    v_fma_f32 v30, v30, s43, v45
    v_fma_f32 v31, v31, s43, v45
    v_mfma_f32_16x16x32_bf16 v[204:207], a[172:175], v[32:35], v[204:207]
    v_mfma_f32_16x16x32_bf16 v[208:211], a[176:179], v[32:35], v[208:211]
    v_exp_f32 v30, v30
    v_mfma_f32_16x16x32_bf16 v[212:215], a[180:183], v[32:35], v[212:215]
    v_exp_f32 v31, v31
    v_mfma_f32_16x16x32_bf16 v[216:219], a[184:187], v[32:35], v[216:219]
    v_cvt_pk_bf16_f32 v36, v24, v25
    v_cvt_pk_bf16_f32 v37, v26, v27
    v_mfma_f32_16x16x32_bf16 v[220:223], a[188:191], v[32:35], v[220:223]
    v_cvt_pk_bf16_f32 v38, v28, v29
    v_cvt_pk_bf16_f32 v39, v30, v31
    v_mfma_f32_16x16x32_bf16 a[240:243], a[248:251], v[32:35], a[240:243]
    ds_read_b64_tr_b16 a[212:213], v47 offset:160
    ds_read_b64_tr_b16 a[214:215], v47 offset:672
    v_mfma_f32_16x16x32_bf16 v[24:27], a[128:131], a[16:19], 0
    v_fma_f32 v16, v16, s43, v40
    v_fma_f32 v17, v17, s43, v40
    v_mfma_f32_16x16x32_bf16 v[24:27], a[132:135], a[20:23], v[24:27]
    v_exp_f32 v16, v16
    v_mfma_f32_16x16x32_bf16 v[24:27], a[136:139], a[24:27], v[24:27]
    v_exp_f32 v17, v17
    v_mfma_f32_16x16x32_bf16 v[24:27], a[140:143], a[28:31], v[24:27]
    v_fma_f32 v18, v18, s43, v40
    v_fma_f32 v19, v19, s43, v40
    v_mfma_f32_16x16x32_bf16 v[28:31], a[144:147], a[16:19], 0
    v_exp_f32 v18, v18
    v_mfma_f32_16x16x32_bf16 v[28:31], a[148:151], a[20:23], v[28:31]
    ds_read_b64_tr_b16 a[216:217], v47 offset:192
    ds_read_b64_tr_b16 a[218:219], v47 offset:704
    v_mfma_f32_16x16x32_bf16 v[28:31], a[152:155], a[24:27], v[28:31]
    v_exp_f32 v19, v19
    v_mfma_f32_16x16x32_bf16 v[28:31], a[156:159], a[28:31], v[28:31]
    v_fma_f32 v20, v20, s43, v40
    v_fma_f32 v21, v21, s43, v40
    v_mfma_f32_16x16x32_bf16 v[224:227], a[160:163], v[36:39], v[224:227]
    v_exp_f32 v20, v20
    v_mfma_f32_16x16x32_bf16 v[228:231], a[164:167], v[36:39], v[228:231]
    v_exp_f32 v21, v21
    v_mfma_f32_16x16x32_bf16 v[232:235], a[168:171], v[36:39], v[232:235]
    v_fma_f32 v22, v22, s43, v40
    v_fma_f32 v23, v23, s43, v40
    v_mfma_f32_16x16x32_bf16 v[236:239], a[172:175], v[36:39], v[236:239]
    ds_read_b64_tr_b16 a[220:221], v47 offset:224
    ds_read_b64_tr_b16 a[222:223], v47 offset:736
    v_mfma_f32_16x16x32_bf16 v[240:243], a[176:179], v[36:39], v[240:243]
    v_exp_f32 v22, v22
    v_mfma_f32_16x16x32_bf16 v[244:247], a[180:183], v[36:39], v[244:247]
    v_exp_f32 v23, v23
    v_mfma_f32_16x16x32_bf16 v[248:251], a[184:187], v[36:39], v[248:251]
    v_cvt_pk_bf16_f32 v32, v16, v17
    v_cvt_pk_bf16_f32 v33, v18, v19
    v_mfma_f32_16x16x32_bf16 v[252:255], a[188:191], v[36:39], v[252:255]
    v_cvt_pk_bf16_f32 v34, v20, v21
    v_cvt_pk_bf16_f32 v35, v22, v23
    v_mfma_f32_16x16x32_bf16 a[244:247], a[248:251], v[36:39], a[244:247]
    v_mfma_f32_16x16x32_bf16 v[16:19], a[128:131], a[32:35], 0
    s_waitcnt vmcnt(8) lgkmcnt(0)
    v_fma_f32 v24, v24, s43, v41
    v_fma_f32 v25, v25, s43, v41
    v_mfma_f32_16x16x32_bf16 v[16:19], a[132:135], a[36:39], v[16:19]
    s_barrier
    v_exp_f32 v24, v24
    v_mfma_f32_16x16x32_bf16 v[16:19], a[136:139], a[40:43], v[16:19]
    s_mov_b32 m0, s92
    v_exp_f32 v25, v25
    v_mfma_f32_16x16x32_bf16 v[16:19], a[140:143], a[44:47], v[16:19]
    s_xor_b32 s47, s47, s93
    v_fma_f32 v26, v26, s43, v41
    v_fma_f32 v27, v27, s43, v41
    v_mfma_f32_16x16x32_bf16 v[20:23], a[144:147], a[32:35], 0
    s_add_u32 s40, s40, 8192
    v_exp_f32 v26, v26
    v_add_u32 v46, s47, v48
    v_add_u32 v47, s47, v49
    v_mfma_f32_16x16x32_bf16 v[20:23], a[148:151], a[36:39], v[20:23]
    ds_read_b128 a[96:99], v46
    ds_read_b128 a[100:103], v46 offset:64
    v_mfma_f32_16x16x32_bf16 v[20:23], a[152:155], a[40:43], v[20:23]
    v_exp_f32 v27, v27
    v_mfma_f32_16x16x32_bf16 v[20:23], a[156:159], a[44:47], v[20:23]
    v_fma_f32 v28, v28, s43, v41
    v_fma_f32 v29, v29, s43, v41
    v_mfma_f32_16x16x32_bf16 v[64:67], a[192:195], v[32:35], v[64:67]
Lpad9:
    s_cbranch_execz Lret9
    v_exp_f32 v28, v28
    v_mfma_f32_16x16x32_bf16 v[68:71], a[196:199], v[32:35], v[68:71]
    v_exp_f32 v29, v29
    v_mfma_f32_16x16x32_bf16 v[72:75], a[200:203], v[32:35], v[72:75]
    v_fma_f32 v30, v30, s43, v41
    v_fma_f32 v31, v31, s43, v41
    v_mfma_f32_16x16x32_bf16 v[76:79], a[204:207], v[32:35], v[76:79]
    buffer_load_dwordx4 v57, s[8:11], s40 offen nt lds
    v_mfma_f32_16x16x32_bf16 v[80:83], a[208:211], v[32:35], v[80:83]
    v_exp_f32 v30, v30
    v_mfma_f32_16x16x32_bf16 v[84:87], a[212:215], v[32:35], v[84:87]
    v_exp_f32 v31, v31
    v_mfma_f32_16x16x32_bf16 v[88:91], a[216:219], v[32:35], v[88:91]
    v_cvt_pk_bf16_f32 v36, v24, v25
    v_cvt_pk_bf16_f32 v37, v26, v27
    v_mfma_f32_16x16x32_bf16 v[92:95], a[220:223], v[32:35], v[92:95]
    v_cvt_pk_bf16_f32 v38, v28, v29
    v_cvt_pk_bf16_f32 v39, v30, v31
    v_mfma_f32_16x16x32_bf16 a[224:227], a[248:251], v[32:35], a[224:227]
    ds_read_b128 a[104:107], v46 offset:128
    ds_read_b128 a[108:111], v46 offset:192
    v_mfma_f32_16x16x32_bf16 v[24:27], a[128:131], a[48:51], 0
    v_fma_f32 v16, v16, s43, v42
    v_fma_f32 v17, v17, s43, v42
    v_mfma_f32_16x16x32_bf16 v[24:27], a[132:135], a[52:55], v[24:27]
    v_exp_f32 v16, v16
    v_mfma_f32_16x16x32_bf16 v[24:27], a[136:139], a[56:59], v[24:27]
    v_exp_f32 v17, v17
    v_mfma_f32_16x16x32_bf16 v[24:27], a[140:143], a[60:63], v[24:27]
    v_fma_f32 v18, v18, s43, v42
    v_fma_f32 v19, v19, s43, v42
    v_mfma_f32_16x16x32_bf16 v[28:31], a[144:147], a[48:51], 0
    v_exp_f32 v18, v18
    v_mfma_f32_16x16x32_bf16 v[28:31], a[148:151], a[52:55], v[28:31]
    ds_read_b128 a[112:115], v46 offset:512
    ds_read_b128 a[116:119], v46 offset:576
    v_mfma_f32_16x16x32_bf16 v[28:31], a[152:155], a[56:59], v[28:31]
    v_exp_f32 v19, v19
    v_mfma_f32_16x16x32_bf16 v[28:31], a[156:159], a[60:63], v[28:31]
    v_fma_f32 v20, v20, s43, v42
    v_fma_f32 v21, v21, s43, v42
    v_mfma_f32_16x16x32_bf16 v[96:99], a[192:195], v[36:39], v[96:99]
    v_exp_f32 v20, v20
    v_mfma_f32_16x16x32_bf16 v[100:103], a[196:199], v[36:39], v[100:103]
    v_exp_f32 v21, v21
    v_mfma_f32_16x16x32_bf16 v[104:107], a[200:203], v[36:39], v[104:107]
    v_fma_f32 v22, v22, s43, v42
    v_fma_f32 v23, v23, s43, v42
    v_mfma_f32_16x16x32_bf16 v[108:111], a[204:207], v[36:39], v[108:111]
    buffer_load_dwordx4 v57, s[12:15], s40 offen offset:1024 nt lds
    v_mfma_f32_16x16x32_bf16 v[112:115], a[208:211], v[36:39], v[112:115]
    v_exp_f32 v22, v22
    v_mfma_f32_16x16x32_bf16 v[116:119], a[212:215], v[36:39], v[116:119]
    v_exp_f32 v23, v23
    v_mfma_f32_16x16x32_bf16 v[120:123], a[216:219], v[36:39], v[120:123]
    v_cvt_pk_bf16_f32 v32, v16, v17
    v_cvt_pk_bf16_f32 v33, v18, v19
    v_mfma_f32_16x16x32_bf16 v[124:127], a[220:223], v[36:39], v[124:127]
    v_cvt_pk_bf16_f32 v34, v20, v21
    v_cvt_pk_bf16_f32 v35, v22, v23
    v_mfma_f32_16x16x32_bf16 a[228:231], a[248:251], v[36:39], a[228:231]
    ds_read_b128 a[120:123], v46 offset:640
    ds_read_b128 a[124:127], v46 offset:704
    v_mfma_f32_16x16x32_bf16 v[16:19], a[128:131], a[64:67], 0
    v_fma_f32 v24, v24, s43, v43
    v_fma_f32 v25, v25, s43, v43
    v_mfma_f32_16x16x32_bf16 v[16:19], a[132:135], a[68:71], v[16:19]
    v_exp_f32 v24, v24
    v_mfma_f32_16x16x32_bf16 v[16:19], a[136:139], a[72:75], v[16:19]
    v_exp_f32 v25, v25
    v_mfma_f32_16x16x32_bf16 v[16:19], a[140:143], a[76:79], v[16:19]
    v_fma_f32 v26, v26, s43, v43
    v_fma_f32 v27, v27, s43, v43
    v_mfma_f32_16x16x32_bf16 v[20:23], a[144:147], a[64:67], 0
    v_exp_f32 v26, v26
    v_mfma_f32_16x16x32_bf16 v[20:23], a[148:151], a[68:71], v[20:23]
    ds_read_b64_tr_b16 a[160:161], v47
    ds_read_b64_tr_b16 a[162:163], v47 offset:512
    v_mfma_f32_16x16x32_bf16 v[20:23], a[152:155], a[72:75], v[20:23]
    v_exp_f32 v27, v27
    v_mfma_f32_16x16x32_bf16 v[20:23], a[156:159], a[76:79], v[20:23]
    v_fma_f32 v28, v28, s43, v43
    v_fma_f32 v29, v29, s43, v43
    v_mfma_f32_16x16x32_bf16 v[128:131], a[192:195], v[32:35], v[128:131]
    v_exp_f32 v28, v28
    v_mfma_f32_16x16x32_bf16 v[132:135], a[196:199], v[32:35], v[132:135]
    v_exp_f32 v29, v29
    v_mfma_f32_16x16x32_bf16 v[136:139], a[200:203], v[32:35], v[136:139]
    v_fma_f32 v30, v30, s43, v43
    v_fma_f32 v31, v31, s43, v43
    v_mfma_f32_16x16x32_bf16 v[140:143], a[204:207], v[32:35], v[140:143]
    buffer_load_dwordx4 v58, s[8:11], s40 offen offset:2080 nt lds
    v_mfma_f32_16x16x32_bf16 v[144:147], a[208:211], v[32:35], v[144:147]
    v_exp_f32 v30, v30
    v_mfma_f32_16x16x32_bf16 v[148:151], a[212:215], v[32:35], v[148:151]
    v_exp_f32 v31, v31
    v_mfma_f32_16x16x32_bf16 v[152:155], a[216:219], v[32:35], v[152:155]
    v_cvt_pk_bf16_f32 v36, v24, v25
    v_cvt_pk_bf16_f32 v37, v26, v27
    v_mfma_f32_16x16x32_bf16 v[156:159], a[220:223], v[32:35], v[156:159]
    v_cvt_pk_bf16_f32 v38, v28, v29
    v_cvt_pk_bf16_f32 v39, v30, v31
    v_mfma_f32_16x16x32_bf16 a[232:235], a[248:251], v[32:35], a[232:235]
    ds_read_b64_tr_b16 a[164:165], v47 offset:32
    ds_read_b64_tr_b16 a[166:167], v47 offset:544
    v_mfma_f32_16x16x32_bf16 v[24:27], a[128:131], a[80:83], 0
    v_fma_f32 v16, v16, s43, v44
    v_fma_f32 v17, v17, s43, v44
    v_mfma_f32_16x16x32_bf16 v[24:27], a[132:135], a[84:87], v[24:27]
    v_exp_f32 v16, v16
    v_mfma_f32_16x16x32_bf16 v[24:27], a[136:139], a[88:91], v[24:27]
    v_exp_f32 v17, v17
    v_mfma_f32_16x16x32_bf16 v[24:27], a[140:143], a[92:95], v[24:27]
    v_fma_f32 v18, v18, s43, v44
    v_fma_f32 v19, v19, s43, v44
    v_mfma_f32_16x16x32_bf16 v[28:31], a[144:147], a[80:83], 0
    v_exp_f32 v18, v18
    v_mfma_f32_16x16x32_bf16 v[28:31], a[148:151], a[84:87], v[28:31]
    ds_read_b64_tr_b16 a[168:169], v47 offset:64
    ds_read_b64_tr_b16 a[170:171], v47 offset:576
    v_mfma_f32_16x16x32_bf16 v[28:31], a[152:155], a[88:91], v[28:31]
    v_exp_f32 v19, v19
    v_mfma_f32_16x16x32_bf16 v[28:31], a[156:159], a[92:95], v[28:31]
    v_fma_f32 v20, v20, s43, v44
    v_fma_f32 v21, v21, s43, v44
    v_mfma_f32_16x16x32_bf16 v[160:163], a[192:195], v[36:39], v[160:163]
    v_exp_f32 v20, v20
    v_mfma_f32_16x16x32_bf16 v[164:167], a[196:199], v[36:39], v[164:167]
    v_exp_f32 v21, v21
    v_mfma_f32_16x16x32_bf16 v[168:171], a[200:203], v[36:39], v[168:171]
    v_fma_f32 v22, v22, s43, v44
    v_fma_f32 v23, v23, s43, v44
    v_mfma_f32_16x16x32_bf16 v[172:175], a[204:207], v[36:39], v[172:175]
    buffer_load_dwordx4 v58, s[12:15], s40 offen offset:3104 nt lds
    v_mfma_f32_16x16x32_bf16 v[176:179], a[208:211], v[36:39], v[176:179]
    v_exp_f32 v22, v22
    v_mfma_f32_16x16x32_bf16 v[180:183], a[212:215], v[36:39], v[180:183]
    v_exp_f32 v23, v23
    v_mfma_f32_16x16x32_bf16 v[184:187], a[216:219], v[36:39], v[184:187]
    v_cvt_pk_bf16_f32 v32, v16, v17
    v_cvt_pk_bf16_f32 v33, v18, v19
    v_mfma_f32_16x16x32_bf16 v[188:191], a[220:223], v[36:39], v[188:191]
    s_waitcnt lgkmcnt(6)
    v_cvt_pk_bf16_f32 v34, v20, v21
    v_cvt_pk_bf16_f32 v35, v22, v23
    v_mfma_f32_16x16x32_bf16 a[236:239], a[248:251], v[36:39], a[236:239]
    ds_read_b64_tr_b16 a[172:173], v47 offset:96
    ds_read_b64_tr_b16 a[174:175], v47 offset:608
    v_mfma_f32_16x16x32_bf16 v[16:19], a[96:99], a[0:3], 0
    v_fma_f32 v24, v24, s43, v45
    v_fma_f32 v25, v25, s43, v45
    v_mfma_f32_16x16x32_bf16 v[16:19], a[100:103], a[4:7], v[16:19]
    v_exp_f32 v24, v24
    v_mfma_f32_16x16x32_bf16 v[16:19], a[104:107], a[8:11], v[16:19]
    v_exp_f32 v25, v25
    v_mfma_f32_16x16x32_bf16 v[16:19], a[108:111], a[12:15], v[16:19]
    v_fma_f32 v26, v26, s43, v45
    v_fma_f32 v27, v27, s43, v45
    v_mfma_f32_16x16x32_bf16 v[20:23], a[112:115], a[0:3], 0
    v_exp_f32 v26, v26
    v_mfma_f32_16x16x32_bf16 v[20:23], a[116:119], a[4:7], v[20:23]
    ds_read_b64_tr_b16 a[176:177], v47 offset:128
    ds_read_b64_tr_b16 a[178:179], v47 offset:640
    v_mfma_f32_16x16x32_bf16 v[20:23], a[120:123], a[8:11], v[20:23]
    v_exp_f32 v27, v27
    v_mfma_f32_16x16x32_bf16 v[20:23], a[124:127], a[12:15], v[20:23]
    v_fma_f32 v28, v28, s43, v45
    v_fma_f32 v29, v29, s43, v45
    v_mfma_f32_16x16x32_bf16 v[192:195], a[192:195], v[32:35], v[192:195]
    v_exp_f32 v28, v28
    v_mfma_f32_16x16x32_bf16 v[196:199], a[196:199], v[32:35], v[196:199]
    v_exp_f32 v29, v29
    v_mfma_f32_16x16x32_bf16 v[200:203], a[200:203], v[32:35], v[200:203]
    v_fma_f32 v30, v30, s43, v45
    v_fma_f32 v31, v31, s43, v45
    v_mfma_f32_16x16x32_bf16 v[204:207], a[204:207], v[32:35], v[204:207]
    v_mfma_f32_16x16x32_bf16 v[208:211], a[208:211], v[32:35], v[208:211]
    v_exp_f32 v30, v30
    v_mfma_f32_16x16x32_bf16 v[212:215], a[212:215], v[32:35], v[212:215]
    v_exp_f32 v31, v31
    v_mfma_f32_16x16x32_bf16 v[216:219], a[216:219], v[32:35], v[216:219]
    v_cvt_pk_bf16_f32 v36, v24, v25
    v_cvt_pk_bf16_f32 v37, v26, v27
    v_mfma_f32_16x16x32_bf16 v[220:223], a[220:223], v[32:35], v[220:223]
    v_cvt_pk_bf16_f32 v38, v28, v29
    v_cvt_pk_bf16_f32 v39, v30, v31
    v_mfma_f32_16x16x32_bf16 a[240:243], a[248:251], v[32:35], a[240:243]
    ds_read_b64_tr_b16 a[180:181], v47 offset:160
    ds_read_b64_tr_b16 a[182:183], v47 offset:672
    v_mfma_f32_16x16x32_bf16 v[24:27], a[96:99], a[16:19], 0
    v_fma_f32 v16, v16, s43, v40
    v_fma_f32 v17, v17, s43, v40
    v_mfma_f32_16x16x32_bf16 v[24:27], a[100:103], a[20:23], v[24:27]
    v_exp_f32 v16, v16
    v_mfma_f32_16x16x32_bf16 v[24:27], a[104:107], a[24:27], v[24:27]
    v_exp_f32 v17, v17
    v_mfma_f32_16x16x32_bf16 v[24:27], a[108:111], a[28:31], v[24:27]
    v_fma_f32 v18, v18, s43, v40
    v_fma_f32 v19, v19, s43, v40
    v_mfma_f32_16x16x32_bf16 v[28:31], a[112:115], a[16:19], 0
    v_exp_f32 v18, v18
    v_mfma_f32_16x16x32_bf16 v[28:31], a[116:119], a[20:23], v[28:31]
    ds_read_b64_tr_b16 a[184:185], v47 offset:192
    ds_read_b64_tr_b16 a[186:187], v47 offset:704
    v_mfma_f32_16x16x32_bf16 v[28:31], a[120:123], a[24:27], v[28:31]
    v_exp_f32 v19, v19
    v_mfma_f32_16x16x32_bf16 v[28:31], a[124:127], a[28:31], v[28:31]
    v_fma_f32 v20, v20, s43, v40
    v_fma_f32 v21, v21, s43, v40
    v_mfma_f32_16x16x32_bf16 v[224:227], a[192:195], v[36:39], v[224:227]
    v_exp_f32 v20, v20
    v_mfma_f32_16x16x32_bf16 v[228:231], a[196:199], v[36:39], v[228:231]
    v_exp_f32 v21, v21
    v_mfma_f32_16x16x32_bf16 v[232:235], a[200:203], v[36:39], v[232:235]
    v_fma_f32 v22, v22, s43, v40
    v_fma_f32 v23, v23, s43, v40
    v_mfma_f32_16x16x32_bf16 v[236:239], a[204:207], v[36:39], v[236:239]
    ds_read_b64_tr_b16 a[188:189], v47 offset:224
    ds_read_b64_tr_b16 a[190:191], v47 offset:736
    v_mfma_f32_16x16x32_bf16 v[240:243], a[208:211], v[36:39], v[240:243]
    v_exp_f32 v22, v22
    v_mfma_f32_16x16x32_bf16 v[244:247], a[212:215], v[36:39], v[244:247]
    s_add_u32 s46, s46, 1
    v_exp_f32 v23, v23
    v_mfma_f32_16x16x32_bf16 v[248:251], a[216:219], v[36:39], v[248:251]
    v_cvt_pk_bf16_f32 v32, v16, v17
    v_cvt_pk_bf16_f32 v33, v18, v19
    v_mfma_f32_16x16x32_bf16 v[252:255], a[220:223], v[36:39], v[252:255]
    s_cmp_lt_u32 s46, 2
    v_cvt_pk_bf16_f32 v34, v20, v21
    v_cvt_pk_bf16_f32 v35, v22, v23
    v_mfma_f32_16x16x32_bf16 a[244:247], a[248:251], v[36:39], a[244:247]
    s_cbranch_scc1 LloopB
    v_mfma_f32_16x16x32_bf16 v[16:19], a[96:99], a[32:35], 0
    s_waitcnt vmcnt(8) lgkmcnt(0)
    v_fma_f32 v24, v24, s43, v41
    v_fma_f32 v25, v25, s43, v41
    v_mfma_f32_16x16x32_bf16 v[16:19], a[100:103], a[36:39], v[16:19]
    s_barrier
    v_exp_f32 v24, v24
    v_exp_f32 v25, v25
    v_mfma_f32_16x16x32_bf16 v[16:19], a[104:107], a[40:43], v[16:19]
    s_xor_b32 s92, s92, s94
    v_mfma_f32_16x16x32_bf16 v[16:19], a[108:111], a[44:47], v[16:19]
    v_fma_f32 v26, v26, s43, v41
    v_fma_f32 v27, v27, s43, v41
    v_mfma_f32_16x16x32_bf16 v[20:23], a[112:115], a[32:35], 0
    v_exp_f32 v26, v26
    v_add_u32 v46, s92, v48
    v_add_u32 v47, s92, v49
    v_mfma_f32_16x16x32_bf16 v[20:23], a[116:119], a[36:39], v[20:23]
    ds_read_b128 a[128:131], v46
    v_mfma_f32_16x16x32_bf16 v[20:23], a[120:123], a[40:43], v[20:23]
    v_exp_f32 v27, v27
    v_mfma_f32_16x16x32_bf16 v[20:23], a[124:127], a[44:47], v[20:23]
    v_fma_f32 v28, v28, s43, v41
    v_fma_f32 v29, v29, s43, v41
    v_mfma_f32_16x16x32_bf16 v[64:67], a[160:163], v[32:35], v[64:67]
    v_exp_f32 v28, v28
    v_exp_f32 v29, v29
    v_mfma_f32_16x16x32_bf16 v[68:71], a[164:167], v[32:35], v[68:71]
    v_mfma_f32_16x16x32_bf16 v[72:75], a[168:171], v[32:35], v[72:75]
    v_fma_f32 v30, v30, s43, v41
    v_fma_f32 v31, v31, s43, v41
    v_mfma_f32_16x16x32_bf16 v[76:79], a[172:175], v[32:35], v[76:79]
    ds_read_b128 a[132:135], v46 offset:64
    ds_read_b128 a[136:139], v46 offset:128
    v_mfma_f32_16x16x32_bf16 v[80:83], a[176:179], v[32:35], v[80:83]
    v_exp_f32 v30, v30
    v_exp_f32 v31, v31
    v_mfma_f32_16x16x32_bf16 v[84:87], a[180:183], v[32:35], v[84:87]
    v_mfma_f32_16x16x32_bf16 v[88:91], a[184:187], v[32:35], v[88:91]
    v_cvt_pk_bf16_f32 v36, v24, v25
    v_cvt_pk_bf16_f32 v37, v26, v27
    v_mfma_f32_16x16x32_bf16 v[92:95], a[188:191], v[32:35], v[92:95]
    v_cvt_pk_bf16_f32 v38, v28, v29
    v_cvt_pk_bf16_f32 v39, v30, v31
    v_mfma_f32_16x16x32_bf16 a[224:227], a[248:251], v[32:35], a[224:227]
    ds_read_b128 a[140:143], v46 offset:192
    ds_read_b128 v[8:11], v50
    v_mfma_f32_16x16x32_bf16 v[24:27], a[96:99], a[48:51], 0
    v_fma_f32 v16, v16, s43, v42
    v_fma_f32 v17, v17, s43, v42
    v_mfma_f32_16x16x32_bf16 v[24:27], a[100:103], a[52:55], v[24:27]
    v_exp_f32 v16, v16
    v_exp_f32 v17, v17
    v_mfma_f32_16x16x32_bf16 v[24:27], a[104:107], a[56:59], v[24:27]
    v_mfma_f32_16x16x32_bf16 v[24:27], a[108:111], a[60:63], v[24:27]
    v_fma_f32 v18, v18, s43, v42
    v_fma_f32 v19, v19, s43, v42
    v_mfma_f32_16x16x32_bf16 v[28:31], a[112:115], a[48:51], 0
    s_waitcnt lgkmcnt(0)
    buffer_store_dwordx4 v[8:11], v58, s[24:27], s41 offen sc1
    v_exp_f32 v18, v18
    v_mfma_f32_16x16x32_bf16 v[28:31], a[116:119], a[52:55], v[28:31]
    ds_read_b128 a[144:147], v46 offset:512
    ds_read_b128 a[148:151], v46 offset:576
    v_mfma_f32_16x16x32_bf16 v[28:31], a[120:123], a[56:59], v[28:31]
    v_exp_f32 v19, v19
    v_mfma_f32_16x16x32_bf16 v[28:31], a[124:127], a[60:63], v[28:31]
    v_fma_f32 v20, v20, s43, v42
    v_fma_f32 v21, v21, s43, v42
    v_mfma_f32_16x16x32_bf16 v[96:99], a[160:163], v[36:39], v[96:99]
    v_exp_f32 v20, v20
    v_exp_f32 v21, v21
    v_mfma_f32_16x16x32_bf16 v[100:103], a[164:167], v[36:39], v[100:103]
    v_mfma_f32_16x16x32_bf16 v[104:107], a[168:171], v[36:39], v[104:107]
    v_fma_f32 v22, v22, s43, v42
    v_fma_f32 v23, v23, s43, v42
    v_mfma_f32_16x16x32_bf16 v[108:111], a[172:175], v[36:39], v[108:111]
    ds_read_b128 a[152:155], v46 offset:640
    ds_read_b128 v[12:15], v51 offset:1024
    v_mfma_f32_16x16x32_bf16 v[112:115], a[176:179], v[36:39], v[112:115]
    v_exp_f32 v22, v22
    v_exp_f32 v23, v23
    v_mfma_f32_16x16x32_bf16 v[116:119], a[180:183], v[36:39], v[116:119]
    v_mfma_f32_16x16x32_bf16 v[120:123], a[184:187], v[36:39], v[120:123]
    v_cvt_pk_bf16_f32 v32, v16, v17
    v_cvt_pk_bf16_f32 v33, v18, v19
    v_mfma_f32_16x16x32_bf16 v[124:127], a[188:191], v[36:39], v[124:127]
    v_cvt_pk_bf16_f32 v34, v20, v21
    v_cvt_pk_bf16_f32 v35, v22, v23
    v_mfma_f32_16x16x32_bf16 a[228:231], a[248:251], v[36:39], a[228:231]
    ds_read_b128 a[156:159], v46 offset:704
    ds_read_b128 v[8:11], v50 offset:2048
    v_mfma_f32_16x16x32_bf16 v[16:19], a[96:99], a[64:67], 0
    v_fma_f32 v24, v24, s43, v43
    v_fma_f32 v25, v25, s43, v43
    v_mfma_f32_16x16x32_bf16 v[16:19], a[100:103], a[68:71], v[16:19]
    v_exp_f32 v24, v24
    v_exp_f32 v25, v25
    v_mfma_f32_16x16x32_bf16 v[16:19], a[104:107], a[72:75], v[16:19]
    v_mfma_f32_16x16x32_bf16 v[16:19], a[108:111], a[76:79], v[16:19]
    v_fma_f32 v26, v26, s43, v43
    v_fma_f32 v27, v27, s43, v43
    v_mfma_f32_16x16x32_bf16 v[20:23], a[112:115], a[64:67], 0
    s_waitcnt lgkmcnt(2)
    buffer_store_dwordx4 v[12:15], v58, s[24:27], s41 offen offset:1024 sc1
    v_exp_f32 v26, v26
    v_mfma_f32_16x16x32_bf16 v[20:23], a[116:119], a[68:71], v[20:23]
    ds_read_b64_tr_b16 a[192:193], v47
    ds_read_b64_tr_b16 a[194:195], v47 offset:512
    v_mfma_f32_16x16x32_bf16 v[20:23], a[120:123], a[72:75], v[20:23]
    v_exp_f32 v27, v27
    v_mfma_f32_16x16x32_bf16 v[20:23], a[124:127], a[76:79], v[20:23]
    v_fma_f32 v28, v28, s43, v43
    v_fma_f32 v29, v29, s43, v43
    v_mfma_f32_16x16x32_bf16 v[128:131], a[160:163], v[32:35], v[128:131]
    v_exp_f32 v28, v28
    v_exp_f32 v29, v29
    v_mfma_f32_16x16x32_bf16 v[132:135], a[164:167], v[32:35], v[132:135]
    v_mfma_f32_16x16x32_bf16 v[136:139], a[168:171], v[32:35], v[136:139]
    s_waitcnt lgkmcnt(2)
    buffer_store_dwordx4 v[8:11], v58, s[24:27], s41 offen offset:2048 sc1
    v_fma_f32 v30, v30, s43, v43
    v_fma_f32 v31, v31, s43, v43
    v_mfma_f32_16x16x32_bf16 v[140:143], a[172:175], v[32:35], v[140:143]
    ds_read_b64_tr_b16 a[196:197], v47 offset:32
    v_mfma_f32_16x16x32_bf16 v[144:147], a[176:179], v[32:35], v[144:147]
    v_exp_f32 v30, v30
    v_exp_f32 v31, v31
    v_mfma_f32_16x16x32_bf16 v[148:151], a[180:183], v[32:35], v[148:151]
    v_mfma_f32_16x16x32_bf16 v[152:155], a[184:187], v[32:35], v[152:155]
    v_cvt_pk_bf16_f32 v36, v24, v25
    v_cvt_pk_bf16_f32 v37, v26, v27
    v_mfma_f32_16x16x32_bf16 v[156:159], a[188:191], v[32:35], v[156:159]
    v_cvt_pk_bf16_f32 v38, v28, v29
    v_cvt_pk_bf16_f32 v39, v30, v31
    v_mfma_f32_16x16x32_bf16 a[232:235], a[248:251], v[32:35], a[232:235]
    ds_read_b64_tr_b16 a[198:199], v47 offset:544
    ds_read_b128 v[12:15], v51 offset:3072
    v_mfma_f32_16x16x32_bf16 v[24:27], a[96:99], a[80:83], 0
    v_fma_f32 v16, v16, s43, v44
    v_fma_f32 v17, v17, s43, v44
    v_mfma_f32_16x16x32_bf16 v[24:27], a[100:103], a[84:87], v[24:27]
    v_exp_f32 v16, v16
    v_exp_f32 v17, v17
    v_mfma_f32_16x16x32_bf16 v[24:27], a[104:107], a[88:91], v[24:27]
    v_mfma_f32_16x16x32_bf16 v[24:27], a[108:111], a[92:95], v[24:27]
    v_fma_f32 v18, v18, s43, v44
    v_fma_f32 v19, v19, s43, v44
    v_mfma_f32_16x16x32_bf16 v[28:31], a[112:115], a[80:83], 0
    s_waitcnt lgkmcnt(0)
    buffer_store_dwordx4 v[12:15], v58, s[24:27], s41 offen offset:3072 sc1
    s_add_u32 s41, s41, 4096
    v_exp_f32 v18, v18
    v_mfma_f32_16x16x32_bf16 v[28:31], a[116:119], a[84:87], v[28:31]
    ds_read_b64_tr_b16 a[200:201], v47 offset:64
    ds_read_b64_tr_b16 a[202:203], v47 offset:576
    v_mfma_f32_16x16x32_bf16 v[28:31], a[120:123], a[88:91], v[28:31]
    v_exp_f32 v19, v19
    v_mfma_f32_16x16x32_bf16 v[28:31], a[124:127], a[92:95], v[28:31]
    v_fma_f32 v20, v20, s43, v44
    v_fma_f32 v21, v21, s43, v44
    v_mfma_f32_16x16x32_bf16 v[160:163], a[160:163], v[36:39], v[160:163]
    v_exp_f32 v20, v20
    v_exp_f32 v21, v21
    v_mfma_f32_16x16x32_bf16 v[164:167], a[164:167], v[36:39], v[164:167]
    v_mfma_f32_16x16x32_bf16 v[168:171], a[168:171], v[36:39], v[168:171]
    v_fma_f32 v22, v22, s43, v44
    v_fma_f32 v23, v23, s43, v44
    v_mfma_f32_16x16x32_bf16 v[172:175], a[172:175], v[36:39], v[172:175]
    ds_read_b64_tr_b16 a[204:205], v47 offset:96
    ds_read_b128 v[8:11], v50 offset:16640
    v_mfma_f32_16x16x32_bf16 v[176:179], a[176:179], v[36:39], v[176:179]
    v_exp_f32 v22, v22
    v_exp_f32 v23, v23
    v_mfma_f32_16x16x32_bf16 v[180:183], a[180:183], v[36:39], v[180:183]
    v_mfma_f32_16x16x32_bf16 v[184:187], a[184:187], v[36:39], v[184:187]
    v_cvt_pk_bf16_f32 v32, v16, v17
    v_cvt_pk_bf16_f32 v33, v18, v19
    v_mfma_f32_16x16x32_bf16 v[188:191], a[188:191], v[36:39], v[188:191]
    v_cvt_pk_bf16_f32 v34, v20, v21
    v_cvt_pk_bf16_f32 v35, v22, v23
    v_mfma_f32_16x16x32_bf16 a[236:239], a[248:251], v[36:39], a[236:239]
    ds_read_b64_tr_b16 a[206:207], v47 offset:608
    ds_read_b128 v[12:15], v51 offset:17664
    s_waitcnt lgkmcnt(12)
    v_mfma_f32_16x16x32_bf16 v[16:19], a[128:131], a[0:3], 0
    v_fma_f32 v24, v24, s43, v45
    v_fma_f32 v25, v25, s43, v45
    v_mfma_f32_16x16x32_bf16 v[16:19], a[132:135], a[4:7], v[16:19]
    v_exp_f32 v24, v24
    v_exp_f32 v25, v25
    v_mfma_f32_16x16x32_bf16 v[16:19], a[136:139], a[8:11], v[16:19]
    v_mfma_f32_16x16x32_bf16 v[16:19], a[140:143], a[12:15], v[16:19]
    v_fma_f32 v26, v26, s43, v45
    v_fma_f32 v27, v27, s43, v45
    v_mfma_f32_16x16x32_bf16 v[20:23], a[144:147], a[0:3], 0
    s_waitcnt lgkmcnt(2)
    buffer_store_dwordx4 v[8:11], v58, s[24:27], s41 offen sc1
    v_exp_f32 v26, v26
    v_mfma_f32_16x16x32_bf16 v[20:23], a[148:151], a[4:7], v[20:23]
    ds_read_b64_tr_b16 a[208:209], v47 offset:128
    ds_read_b64_tr_b16 a[210:211], v47 offset:640
    v_mfma_f32_16x16x32_bf16 v[20:23], a[152:155], a[8:11], v[20:23]
    v_exp_f32 v27, v27
    v_mfma_f32_16x16x32_bf16 v[20:23], a[156:159], a[12:15], v[20:23]
    v_fma_f32 v28, v28, s43, v45
    v_fma_f32 v29, v29, s43, v45
    v_mfma_f32_16x16x32_bf16 v[192:195], a[160:163], v[32:35], v[192:195]
    v_exp_f32 v28, v28
    v_exp_f32 v29, v29
    v_mfma_f32_16x16x32_bf16 v[196:199], a[164:167], v[32:35], v[196:199]
    v_mfma_f32_16x16x32_bf16 v[200:203], a[168:171], v[32:35], v[200:203]
    s_waitcnt lgkmcnt(2)
    buffer_store_dwordx4 v[12:15], v58, s[24:27], s41 offen offset:1024 sc1
    v_fma_f32 v30, v30, s43, v45
    v_fma_f32 v31, v31, s43, v45
    v_mfma_f32_16x16x32_bf16 v[204:207], a[172:175], v[32:35], v[204:207]
    ds_read_b64_tr_b16 a[212:213], v47 offset:160
    v_mfma_f32_16x16x32_bf16 v[208:211], a[176:179], v[32:35], v[208:211]
    v_exp_f32 v30, v30
    v_exp_f32 v31, v31
    v_mfma_f32_16x16x32_bf16 v[212:215], a[180:183], v[32:35], v[212:215]
    v_mfma_f32_16x16x32_bf16 v[216:219], a[184:187], v[32:35], v[216:219]
    v_cvt_pk_bf16_f32 v36, v24, v25
    v_cvt_pk_bf16_f32 v37, v26, v27
    v_mfma_f32_16x16x32_bf16 v[220:223], a[188:191], v[32:35], v[220:223]
    v_cvt_pk_bf16_f32 v38, v28, v29
    v_cvt_pk_bf16_f32 v39, v30, v31
    v_mfma_f32_16x16x32_bf16 a[240:243], a[248:251], v[32:35], a[240:243]
    ds_read_b64_tr_b16 a[214:215], v47 offset:672
    ds_read_b128 v[8:11], v50 offset:18688
    v_mfma_f32_16x16x32_bf16 v[24:27], a[128:131], a[16:19], 0
    v_fma_f32 v16, v16, s43, v40
    v_fma_f32 v17, v17, s43, v40
    v_mfma_f32_16x16x32_bf16 v[24:27], a[132:135], a[20:23], v[24:27]
    v_exp_f32 v16, v16
    v_exp_f32 v17, v17
    v_mfma_f32_16x16x32_bf16 v[24:27], a[136:139], a[24:27], v[24:27]
    v_mfma_f32_16x16x32_bf16 v[24:27], a[140:143], a[28:31], v[24:27]
    v_fma_f32 v18, v18, s43, v40
    v_fma_f32 v19, v19, s43, v40
    v_mfma_f32_16x16x32_bf16 v[28:31], a[144:147], a[16:19], 0
    s_waitcnt lgkmcnt(0)
    buffer_store_dwordx4 v[8:11], v58, s[24:27], s41 offen offset:2048 sc1
    v_exp_f32 v18, v18
    v_mfma_f32_16x16x32_bf16 v[28:31], a[148:151], a[20:23], v[28:31]
    ds_read_b64_tr_b16 a[216:217], v47 offset:192
    ds_read_b64_tr_b16 a[218:219], v47 offset:704
    v_mfma_f32_16x16x32_bf16 v[28:31], a[152:155], a[24:27], v[28:31]
    v_exp_f32 v19, v19
    v_mfma_f32_16x16x32_bf16 v[28:31], a[156:159], a[28:31], v[28:31]
    v_fma_f32 v20, v20, s43, v40
    v_fma_f32 v21, v21, s43, v40
    v_mfma_f32_16x16x32_bf16 v[224:227], a[160:163], v[36:39], v[224:227]
    v_exp_f32 v20, v20
    v_exp_f32 v21, v21
    v_mfma_f32_16x16x32_bf16 v[228:231], a[164:167], v[36:39], v[228:231]
    v_mfma_f32_16x16x32_bf16 v[232:235], a[168:171], v[36:39], v[232:235]
    v_fma_f32 v22, v22, s43, v40
    v_fma_f32 v23, v23, s43, v40
    v_mfma_f32_16x16x32_bf16 v[236:239], a[172:175], v[36:39], v[236:239]
    ds_read_b64_tr_b16 a[220:221], v47 offset:224
    ds_read_b64_tr_b16 a[222:223], v47 offset:736
    ds_read_b128 v[12:15], v51 offset:19712
    v_mfma_f32_16x16x32_bf16 v[240:243], a[176:179], v[36:39], v[240:243]
    ds_read_b128 v[8:11], v50 offset:33280
    v_exp_f32 v22, v22
    v_exp_f32 v23, v23
    v_mfma_f32_16x16x32_bf16 v[244:247], a[180:183], v[36:39], v[244:247]
    v_mfma_f32_16x16x32_bf16 v[248:251], a[184:187], v[36:39], v[248:251]
    v_cvt_pk_bf16_f32 v32, v16, v17
    v_cvt_pk_bf16_f32 v33, v18, v19
    v_mfma_f32_16x16x32_bf16 v[252:255], a[188:191], v[36:39], v[252:255]
    v_cvt_pk_bf16_f32 v34, v20, v21
    v_cvt_pk_bf16_f32 v35, v22, v23
    v_mfma_f32_16x16x32_bf16 a[244:247], a[248:251], v[36:39], a[244:247]
    v_mfma_f32_16x16x32_bf16 v[16:19], a[128:131], a[32:35], 0
    s_waitcnt vmcnt(11) lgkmcnt(0)
    v_fma_f32 v24, v24, s43, v41
    v_fma_f32 v25, v25, s43, v41
    v_mfma_f32_16x16x32_bf16 v[16:19], a[132:135], a[36:39], v[16:19]
    s_barrier
    v_exp_f32 v24, v24
    v_exp_f32 v25, v25
    v_mfma_f32_16x16x32_bf16 v[16:19], a[136:139], a[40:43], v[16:19]
    s_xor_b32 s47, s47, s93
    v_mfma_f32_16x16x32_bf16 v[16:19], a[140:143], a[44:47], v[16:19]
    v_fma_f32 v26, v26, s43, v41
    v_fma_f32 v27, v27, s43, v41
    v_mfma_f32_16x16x32_bf16 v[20:23], a[144:147], a[32:35], 0
    s_waitcnt lgkmcnt(1)
    buffer_store_dwordx4 v[12:15], v58, s[24:27], s41 offen offset:3072 sc1
    s_add_u32 s41, s41, 4096
    v_exp_f32 v26, v26
    v_add_u32 v46, s47, v48
    v_add_u32 v47, s47, v49
    v_mfma_f32_16x16x32_bf16 v[20:23], a[148:151], a[36:39], v[20:23]
    ds_read_b128 a[96:99], v46
    ds_read_b128 a[100:103], v46 offset:64
    v_mfma_f32_16x16x32_bf16 v[20:23], a[152:155], a[40:43], v[20:23]
    v_exp_f32 v27, v27
    v_mfma_f32_16x16x32_bf16 v[20:23], a[156:159], a[44:47], v[20:23]
    v_fma_f32 v28, v28, s43, v41
    v_fma_f32 v29, v29, s43, v41
    v_mfma_f32_16x16x32_bf16 v[64:67], a[192:195], v[32:35], v[64:67]
    v_exp_f32 v28, v28
    v_exp_f32 v29, v29
    v_mfma_f32_16x16x32_bf16 v[68:71], a[196:199], v[32:35], v[68:71]
    v_mfma_f32_16x16x32_bf16 v[72:75], a[200:203], v[32:35], v[72:75]
    s_waitcnt lgkmcnt(2)
    buffer_store_dwordx4 v[8:11], v58, s[24:27], s41 offen sc1
    v_fma_f32 v30, v30, s43, v41
    v_fma_f32 v31, v31, s43, v41
    v_mfma_f32_16x16x32_bf16 v[76:79], a[204:207], v[32:35], v[76:79]
    ds_read_b128 a[104:107], v46 offset:128
    ds_read_b128 a[108:111], v46 offset:192
    v_mfma_f32_16x16x32_bf16 v[80:83], a[208:211], v[32:35], v[80:83]
    v_exp_f32 v30, v30
    v_exp_f32 v31, v31
    v_mfma_f32_16x16x32_bf16 v[84:87], a[212:215], v[32:35], v[84:87]
    v_mfma_f32_16x16x32_bf16 v[88:91], a[216:219], v[32:35], v[88:91]
    v_cvt_pk_bf16_f32 v36, v24, v25
    v_cvt_pk_bf16_f32 v37, v26, v27
    v_mfma_f32_16x16x32_bf16 v[92:95], a[220:223], v[32:35], v[92:95]
    v_cvt_pk_bf16_f32 v38, v28, v29
    v_cvt_pk_bf16_f32 v39, v30, v31
    v_mfma_f32_16x16x32_bf16 a[224:227], a[248:251], v[32:35], a[224:227]
    ds_read_b128 a[112:115], v46 offset:512
    ds_read_b128 v[12:15], v51 offset:34304
    v_mfma_f32_16x16x32_bf16 v[24:27], a[128:131], a[48:51], 0
    v_fma_f32 v16, v16, s43, v42
    v_fma_f32 v17, v17, s43, v42
    v_mfma_f32_16x16x32_bf16 v[24:27], a[132:135], a[52:55], v[24:27]
    v_exp_f32 v16, v16
    v_exp_f32 v17, v17
    v_mfma_f32_16x16x32_bf16 v[24:27], a[136:139], a[56:59], v[24:27]
    v_mfma_f32_16x16x32_bf16 v[24:27], a[140:143], a[60:63], v[24:27]
    v_fma_f32 v18, v18, s43, v42
    v_fma_f32 v19, v19, s43, v42
    v_mfma_f32_16x16x32_bf16 v[28:31], a[144:147], a[48:51], 0
Lpad10:
    s_cbranch_execz Lret10
    s_waitcnt lgkmcnt(0)
    buffer_store_dwordx4 v[12:15], v58, s[24:27], s41 offen offset:1024 sc1
    v_exp_f32 v18, v18
    v_add_u32 v52, s45, v48
    v_add_u32 v53, s45, v49
    v_mfma_f32_16x16x32_bf16 v[28:31], a[148:151], a[52:55], v[28:31]
    ds_read_b128 a[116:119], v46 offset:576
    ds_read_b128 a[120:123], v46 offset:640
    v_mfma_f32_16x16x32_bf16 v[28:31], a[152:155], a[56:59], v[28:31]
    v_exp_f32 v19, v19
    v_mfma_f32_16x16x32_bf16 v[28:31], a[156:159], a[60:63], v[28:31]
    v_fma_f32 v20, v20, s43, v42
    v_fma_f32 v21, v21, s43, v42
    v_mfma_f32_16x16x32_bf16 v[96:99], a[192:195], v[36:39], v[96:99]
    v_exp_f32 v20, v20
    v_exp_f32 v21, v21
    v_mfma_f32_16x16x32_bf16 v[100:103], a[196:199], v[36:39], v[100:103]
    v_mfma_f32_16x16x32_bf16 v[104:107], a[200:203], v[36:39], v[104:107]
    v_fma_f32 v22, v22, s43, v42
    v_fma_f32 v23, v23, s43, v42
    v_mfma_f32_16x16x32_bf16 v[108:111], a[204:207], v[36:39], v[108:111]
    ds_read_b128 a[124:127], v46 offset:704
    ds_read_b64_tr_b16 a[160:161], v47
    v_mfma_f32_16x16x32_bf16 v[112:115], a[208:211], v[36:39], v[112:115]
    v_exp_f32 v22, v22
    v_exp_f32 v23, v23
    v_mfma_f32_16x16x32_bf16 v[116:119], a[212:215], v[36:39], v[116:119]
    v_mfma_f32_16x16x32_bf16 v[120:123], a[216:219], v[36:39], v[120:123]
    ds_read_b128 v[8:11], v50 offset:35328
    v_cvt_pk_bf16_f32 v32, v16, v17
    v_cvt_pk_bf16_f32 v33, v18, v19
    v_mfma_f32_16x16x32_bf16 v[124:127], a[220:223], v[36:39], v[124:127]
    v_cvt_pk_bf16_f32 v34, v20, v21
    v_cvt_pk_bf16_f32 v35, v22, v23
    v_mfma_f32_16x16x32_bf16 a[228:231], a[248:251], v[36:39], a[228:231]
    ds_read_b64_tr_b16 a[162:163], v47 offset:512
    ds_read_b64_tr_b16 a[164:165], v47 offset:32
    v_mfma_f32_16x16x32_bf16 v[16:19], a[128:131], a[64:67], 0
    v_fma_f32 v24, v24, s43, v43
    v_fma_f32 v25, v25, s43, v43
    v_mfma_f32_16x16x32_bf16 v[16:19], a[132:135], a[68:71], v[16:19]
    v_exp_f32 v24, v24
    v_exp_f32 v25, v25
    v_mfma_f32_16x16x32_bf16 v[16:19], a[136:139], a[72:75], v[16:19]
    v_mfma_f32_16x16x32_bf16 v[16:19], a[140:143], a[76:79], v[16:19]
    v_fma_f32 v26, v26, s43, v43
    v_fma_f32 v27, v27, s43, v43
    v_mfma_f32_16x16x32_bf16 v[20:23], a[144:147], a[64:67], 0
    s_waitcnt lgkmcnt(2)
    buffer_store_dwordx4 v[8:11], v58, s[24:27], s41 offen offset:2048 sc1
    v_exp_f32 v26, v26
    v_mfma_f32_16x16x32_bf16 v[20:23], a[148:151], a[68:71], v[20:23]
    ds_read_b64_tr_b16 a[166:167], v47 offset:544
    ds_read_b64_tr_b16 a[168:169], v47 offset:64
    v_mfma_f32_16x16x32_bf16 v[20:23], a[152:155], a[72:75], v[20:23]
    v_exp_f32 v27, v27
    v_mfma_f32_16x16x32_bf16 v[20:23], a[156:159], a[76:79], v[20:23]
    v_fma_f32 v28, v28, s43, v43
    v_fma_f32 v29, v29, s43, v43
    v_mfma_f32_16x16x32_bf16 v[128:131], a[192:195], v[32:35], v[128:131]
    v_exp_f32 v28, v28
    v_exp_f32 v29, v29
    v_mfma_f32_16x16x32_bf16 v[132:135], a[196:199], v[32:35], v[132:135]
    v_mfma_f32_16x16x32_bf16 v[136:139], a[200:203], v[32:35], v[136:139]
    v_fma_f32 v30, v30, s43, v43
    v_fma_f32 v31, v31, s43, v43
    v_mfma_f32_16x16x32_bf16 v[140:143], a[204:207], v[32:35], v[140:143]
    ds_read_b64_tr_b16 a[170:171], v47 offset:576
    ds_read_b64_tr_b16 a[172:173], v47 offset:96
    v_mfma_f32_16x16x32_bf16 v[144:147], a[208:211], v[32:35], v[144:147]
    v_exp_f32 v30, v30
    v_exp_f32 v31, v31
    v_mfma_f32_16x16x32_bf16 v[148:151], a[212:215], v[32:35], v[148:151]
    v_mfma_f32_16x16x32_bf16 v[152:155], a[216:219], v[32:35], v[152:155]
    ds_read_b128 v[12:15], v51 offset:36352
    v_cvt_pk_bf16_f32 v36, v24, v25
    v_cvt_pk_bf16_f32 v37, v26, v27
    v_mfma_f32_16x16x32_bf16 v[156:159], a[220:223], v[32:35], v[156:159]
    v_cvt_pk_bf16_f32 v38, v28, v29
    v_cvt_pk_bf16_f32 v39, v30, v31
    v_mfma_f32_16x16x32_bf16 a[232:235], a[248:251], v[32:35], a[232:235]
    ds_read_b64_tr_b16 a[174:175], v47 offset:608
    ds_read_b64_tr_b16 a[176:177], v47 offset:128
    v_mfma_f32_16x16x32_bf16 v[24:27], a[128:131], a[80:83], 0
    v_fma_f32 v16, v16, s43, v44
    v_fma_f32 v17, v17, s43, v44
    v_mfma_f32_16x16x32_bf16 v[24:27], a[132:135], a[84:87], v[24:27]
    v_exp_f32 v16, v16
    v_exp_f32 v17, v17
    v_mfma_f32_16x16x32_bf16 v[24:27], a[136:139], a[88:91], v[24:27]
    v_mfma_f32_16x16x32_bf16 v[24:27], a[140:143], a[92:95], v[24:27]
    v_fma_f32 v18, v18, s43, v44
    v_fma_f32 v19, v19, s43, v44
    v_mfma_f32_16x16x32_bf16 v[28:31], a[144:147], a[80:83], 0
    s_waitcnt lgkmcnt(2)
    buffer_store_dwordx4 v[12:15], v58, s[24:27], s41 offen offset:3072 sc1
    s_add_u32 s41, s41, 4096
    v_exp_f32 v18, v18
    v_mfma_f32_16x16x32_bf16 v[28:31], a[148:151], a[84:87], v[28:31]
    ds_read_b64_tr_b16 a[178:179], v47 offset:640
    ds_read_b64_tr_b16 a[180:181], v47 offset:160
    v_mfma_f32_16x16x32_bf16 v[28:31], a[152:155], a[88:91], v[28:31]
    s_waitcnt vmcnt(12)
    v_exp_f32 v19, v19
    v_mfma_f32_16x16x32_bf16 v[28:31], a[156:159], a[92:95], v[28:31]
    s_barrier
    v_fma_f32 v20, v20, s43, v44
    v_fma_f32 v21, v21, s43, v44
    v_mfma_f32_16x16x32_bf16 v[160:163], a[192:195], v[36:39], v[160:163]
    v_exp_f32 v20, v20
    v_exp_f32 v21, v21
    v_mfma_f32_16x16x32_bf16 v[164:167], a[196:199], v[36:39], v[164:167]
    v_mfma_f32_16x16x32_bf16 v[168:171], a[200:203], v[36:39], v[168:171]
    v_fma_f32 v22, v22, s43, v44
    v_fma_f32 v23, v23, s43, v44
    v_mfma_f32_16x16x32_bf16 v[172:175], a[204:207], v[36:39], v[172:175]
    ds_read_b64_tr_b16 a[182:183], v47 offset:672
    ds_read_b64_tr_b16 a[184:185], v47 offset:192
    v_mfma_f32_16x16x32_bf16 v[176:179], a[208:211], v[36:39], v[176:179]
    v_exp_f32 v22, v22
    v_exp_f32 v23, v23
    v_mfma_f32_16x16x32_bf16 v[180:183], a[212:215], v[36:39], v[180:183]
    v_mfma_f32_16x16x32_bf16 v[184:187], a[216:219], v[36:39], v[184:187]
    ds_read_b128 v[8:11], v50 offset:49920
    v_cvt_pk_bf16_f32 v32, v16, v17
    v_cvt_pk_bf16_f32 v33, v18, v19
    v_mfma_f32_16x16x32_bf16 v[188:191], a[220:223], v[36:39], v[188:191]
    v_cvt_pk_bf16_f32 v34, v20, v21
    v_cvt_pk_bf16_f32 v35, v22, v23
    v_mfma_f32_16x16x32_bf16 a[236:239], a[248:251], v[36:39], a[236:239]
    ds_read_b128 a[128:131], v52 offset:33280
    ds_read_b128 a[132:135], v52 offset:33344
    s_waitcnt lgkmcnt(15)
    v_mfma_f32_16x16x32_bf16 v[16:19], a[96:99], a[0:3], 0
    v_fma_f32 v24, v24, s43, v45
    v_fma_f32 v25, v25, s43, v45
    v_mfma_f32_16x16x32_bf16 v[16:19], a[100:103], a[4:7], v[16:19]
    ds_read_b128 a[136:139], v52 offset:33408
    v_exp_f32 v24, v24
    v_exp_f32 v25, v25
    v_mfma_f32_16x16x32_bf16 v[16:19], a[104:107], a[8:11], v[16:19]
    v_mfma_f32_16x16x32_bf16 v[16:19], a[108:111], a[12:15], v[16:19]
    v_fma_f32 v26, v26, s43, v45
    v_fma_f32 v27, v27, s43, v45
    v_mfma_f32_16x16x32_bf16 v[20:23], a[112:115], a[0:3], 0
    s_waitcnt lgkmcnt(3)
    buffer_store_dwordx4 v[8:11], v58, s[24:27], s41 offen sc1
    v_exp_f32 v26, v26
    v_mfma_f32_16x16x32_bf16 v[20:23], a[116:119], a[4:7], v[20:23]
    ds_read_b128 a[140:143], v52 offset:33472
    ds_read_b128 a[144:147], v52 offset:33792
    v_mfma_f32_16x16x32_bf16 v[20:23], a[120:123], a[8:11], v[20:23]
    v_exp_f32 v27, v27
    v_mfma_f32_16x16x32_bf16 v[20:23], a[124:127], a[12:15], v[20:23]
    ds_read_b128 a[148:151], v52 offset:33856
    v_fma_f32 v28, v28, s43, v45
    v_fma_f32 v29, v29, s43, v45
    v_mfma_f32_16x16x32_bf16 v[192:195], a[192:195], v[32:35], v[192:195]
    v_exp_f32 v28, v28
    v_exp_f32 v29, v29
    v_mfma_f32_16x16x32_bf16 v[196:199], a[196:199], v[32:35], v[196:199]
    v_mfma_f32_16x16x32_bf16 v[200:203], a[200:203], v[32:35], v[200:203]
    v_fma_f32 v30, v30, s43, v45
    v_fma_f32 v31, v31, s43, v45
    v_mfma_f32_16x16x32_bf16 v[204:207], a[204:207], v[32:35], v[204:207]
    ds_read_b128 a[152:155], v52 offset:33920
    ds_read_b128 a[156:159], v52 offset:33984
    v_mfma_f32_16x16x32_bf16 v[208:211], a[208:211], v[32:35], v[208:211]
    ds_read_b128 v[12:15], v51 offset:50944
    v_exp_f32 v30, v30
    v_exp_f32 v31, v31
    v_mfma_f32_16x16x32_bf16 v[212:215], a[212:215], v[32:35], v[212:215]
    v_mfma_f32_16x16x32_bf16 v[216:219], a[216:219], v[32:35], v[216:219]
    v_cvt_pk_bf16_f32 v36, v24, v25
    v_cvt_pk_bf16_f32 v37, v26, v27
    v_mfma_f32_16x16x32_bf16 v[220:223], a[220:223], v[32:35], v[220:223]
    v_cvt_pk_bf16_f32 v38, v28, v29
    v_cvt_pk_bf16_f32 v39, v30, v31
    v_mfma_f32_16x16x32_bf16 a[240:243], a[248:251], v[32:35], a[240:243]
    s_waitcnt lgkmcnt(1)
    v_mfma_f32_16x16x32_bf16 v[24:27], a[128:131], a[0:3], 0
    v_fma_f32 v16, v16, s43, v40
    v_fma_f32 v17, v17, s43, v40
    v_mfma_f32_16x16x32_bf16 v[24:27], a[132:135], a[4:7], v[24:27]
    v_exp_f32 v16, v16
    v_exp_f32 v17, v17
    v_mfma_f32_16x16x32_bf16 v[24:27], a[136:139], a[8:11], v[24:27]
    v_mfma_f32_16x16x32_bf16 v[24:27], a[140:143], a[12:15], v[24:27]
    v_fma_f32 v18, v18, s43, v40
    v_fma_f32 v19, v19, s43, v40
    v_mfma_f32_16x16x32_bf16 v[28:31], a[144:147], a[0:3], 0
    s_waitcnt lgkmcnt(0)
    buffer_store_dwordx4 v[12:15], v58, s[24:27], s41 offen offset:1024 sc1
    v_exp_f32 v18, v18
    v_mfma_f32_16x16x32_bf16 v[28:31], a[148:151], a[4:7], v[28:31]
    ds_read_b64_tr_b16 a[186:187], v47 offset:704
    v_mfma_f32_16x16x32_bf16 v[28:31], a[152:155], a[8:11], v[28:31]
    v_exp_f32 v19, v19
    v_mfma_f32_16x16x32_bf16 v[28:31], a[156:159], a[12:15], v[28:31]
    v_fma_f32 v20, v20, s43, v40
    v_fma_f32 v21, v21, s43, v40
    v_mfma_f32_16x16x32_bf16 v[224:227], a[192:195], v[36:39], v[224:227]
    v_exp_f32 v20, v20
    v_exp_f32 v21, v21
    v_mfma_f32_16x16x32_bf16 v[228:231], a[196:199], v[36:39], v[228:231]
    v_mfma_f32_16x16x32_bf16 v[232:235], a[200:203], v[36:39], v[232:235]
    v_fma_f32 v22, v22, s43, v40
    v_fma_f32 v23, v23, s43, v40
    v_mfma_f32_16x16x32_bf16 v[236:239], a[204:207], v[36:39], v[236:239]
    ds_read_b64_tr_b16 a[188:189], v47 offset:224
    ds_read_b64_tr_b16 a[190:191], v47 offset:736
    v_mfma_f32_16x16x32_bf16 v[240:243], a[208:211], v[36:39], v[240:243]
    v_exp_f32 v22, v22
    v_exp_f32 v23, v23
    v_mfma_f32_16x16x32_bf16 v[244:247], a[212:215], v[36:39], v[244:247]
    v_mfma_f32_16x16x32_bf16 v[248:251], a[216:219], v[36:39], v[248:251]
    v_cvt_pk_bf16_f32 v32, v16, v17
    v_cvt_pk_bf16_f32 v33, v18, v19
    v_mfma_f32_16x16x32_bf16 v[252:255], a[220:223], v[36:39], v[252:255]
    v_cvt_pk_bf16_f32 v34, v20, v21
    v_cvt_pk_bf16_f32 v35, v22, v23
    v_mfma_f32_16x16x32_bf16 a[244:247], a[248:251], v[36:39], a[244:247]
    ds_read_b128 v[8:11], v50 offset:51968
    v_mfma_f32_16x16x32_bf16 v[16:19], a[96:99], a[16:19], 0
    v_fma_f32 v24, v24, s43, v40
    v_fma_f32 v25, v25, s43, v40
    v_mfma_f32_16x16x32_bf16 v[16:19], a[100:103], a[20:23], v[16:19]
    ds_read_b64_tr_b16 a[192:193], v53 offset:33280
    v_exp_f32 v24, v24
    v_mfma_f32_16x16x32_bf16 v[16:19], a[104:107], a[24:27], v[16:19]
    ds_read_b64_tr_b16 a[194:195], v53 offset:33792
    v_exp_f32 v25, v25
    v_mfma_f32_16x16x32_bf16 v[16:19], a[108:111], a[28:31], v[16:19]
    v_fma_f32 v26, v26, s43, v40
    v_fma_f32 v27, v27, s43, v40
    v_mfma_f32_16x16x32_bf16 v[20:23], a[112:115], a[16:19], 0
    s_waitcnt lgkmcnt(2)
    buffer_store_dwordx4 v[8:11], v58, s[24:27], s41 offen offset:2048 sc1
    v_exp_f32 v26, v26
    v_mfma_f32_16x16x32_bf16 v[20:23], a[116:119], a[20:23], v[20:23]
    ds_read_b64_tr_b16 a[196:197], v53 offset:33312
    ds_read_b64_tr_b16 a[198:199], v53 offset:33824
    v_mfma_f32_16x16x32_bf16 v[20:23], a[120:123], a[24:27], v[20:23]
    v_exp_f32 v27, v27
    v_mfma_f32_16x16x32_bf16 v[20:23], a[124:127], a[28:31], v[20:23]
    s_waitcnt lgkmcnt(5)
    ds_read_b64_tr_b16 a[200:201], v53 offset:33344
    v_fma_f32 v28, v28, s43, v40
    v_fma_f32 v29, v29, s43, v40
    v_mfma_f32_16x16x32_bf16 v[64:67], a[160:163], v[32:35], v[64:67]
    v_exp_f32 v28, v28
    v_mfma_f32_16x16x32_bf16 v[68:71], a[164:167], v[32:35], v[68:71]
    ds_read_b64_tr_b16 a[202:203], v53 offset:33856
    v_exp_f32 v29, v29
    v_mfma_f32_16x16x32_bf16 v[72:75], a[168:171], v[32:35], v[72:75]
    v_fma_f32 v30, v30, s43, v40
    v_fma_f32 v31, v31, s43, v40
    v_mfma_f32_16x16x32_bf16 v[76:79], a[172:175], v[32:35], v[76:79]
    ds_read_b64_tr_b16 a[204:205], v53 offset:33376
    ds_read_b64_tr_b16 a[206:207], v53 offset:33888
    v_mfma_f32_16x16x32_bf16 v[80:83], a[176:179], v[32:35], v[80:83]
    v_exp_f32 v30, v30
    v_mfma_f32_16x16x32_bf16 v[84:87], a[180:183], v[32:35], v[84:87]
    v_exp_f32 v31, v31
    v_mfma_f32_16x16x32_bf16 v[88:91], a[184:187], v[32:35], v[88:91]
    ds_read_b128 v[12:15], v51 offset:52992
    v_cvt_pk_bf16_f32 v36, v24, v25
    v_cvt_pk_bf16_f32 v37, v26, v27
    v_mfma_f32_16x16x32_bf16 v[92:95], a[188:191], v[32:35], v[92:95]
    v_cvt_pk_bf16_f32 v38, v28, v29
    v_cvt_pk_bf16_f32 v39, v30, v31
    v_mfma_f32_16x16x32_bf16 a[224:227], a[248:251], v[32:35], a[224:227]
    ds_read_b64_tr_b16 a[208:209], v53 offset:33408
    ds_read_b64_tr_b16 a[210:211], v53 offset:33920
    v_mfma_f32_16x16x32_bf16 v[24:27], a[128:131], a[16:19], 0
    ds_read_b64_tr_b16 a[212:213], v53 offset:33440
    v_fma_f32 v16, v16, s43, v41
    v_fma_f32 v17, v17, s43, v41
    v_mfma_f32_16x16x32_bf16 v[24:27], a[132:135], a[20:23], v[24:27]
    ds_read_b64_tr_b16 a[214:215], v53 offset:33952
    v_exp_f32 v16, v16
    v_mfma_f32_16x16x32_bf16 v[24:27], a[136:139], a[24:27], v[24:27]
    ds_read_b64_tr_b16 a[216:217], v53 offset:33472
    v_exp_f32 v17, v17
    v_mfma_f32_16x16x32_bf16 v[24:27], a[140:143], a[28:31], v[24:27]
    ds_read_b64_tr_b16 a[218:219], v53 offset:33984
    v_fma_f32 v18, v18, s43, v41
    v_fma_f32 v19, v19, s43, v41
    v_mfma_f32_16x16x32_bf16 v[28:31], a[144:147], a[16:19], 0
    s_waitcnt lgkmcnt(6)
    buffer_store_dwordx4 v[12:15], v58, s[24:27], s41 offen offset:3072 sc1
    s_add_u32 s41, s41, 4096
    v_exp_f32 v18, v18
    v_mfma_f32_16x16x32_bf16 v[28:31], a[148:151], a[20:23], v[28:31]
    ds_read_b64_tr_b16 a[220:221], v53 offset:33504
    ds_read_b64_tr_b16 a[222:223], v53 offset:34016
    v_mfma_f32_16x16x32_bf16 v[28:31], a[152:155], a[24:27], v[28:31]
    v_exp_f32 v19, v19
    v_mfma_f32_16x16x32_bf16 v[28:31], a[156:159], a[28:31], v[28:31]
    v_fma_f32 v20, v20, s43, v41
    v_fma_f32 v21, v21, s43, v41
    v_mfma_f32_16x16x32_bf16 a[224:227], a[248:251], v[36:39], a[224:227]
    s_waitcnt lgkmcnt(6)
    v_exp_f32 v20, v20
    v_mfma_f32_16x16x32_bf16 v[64:67], a[192:195], v[36:39], v[64:67]
    v_exp_f32 v21, v21
    v_mfma_f32_16x16x32_bf16 v[68:71], a[196:199], v[36:39], v[68:71]
    v_fma_f32 v22, v22, s43, v41
    v_fma_f32 v23, v23, s43, v41
    v_mfma_f32_16x16x32_bf16 v[72:75], a[200:203], v[36:39], v[72:75]
    v_mfma_f32_16x16x32_bf16 v[76:79], a[204:207], v[36:39], v[76:79]
    v_exp_f32 v22, v22
    v_mfma_f32_16x16x32_bf16 v[80:83], a[208:211], v[36:39], v[80:83]
    s_waitcnt lgkmcnt(0)
    v_exp_f32 v23, v23
    v_accvgpr_read_b32 v3, a224
    v_mfma_f32_16x16x32_bf16 v[84:87], a[212:215], v[36:39], v[84:87]
    v_cvt_pk_bf16_f32 v32, v16, v17
    v_cvt_pk_bf16_f32 v33, v18, v19
    v_rcp_f32 v2, v3
    v_mfma_f32_16x16x32_bf16 v[88:91], a[216:219], v[36:39], v[88:91]
    v_cvt_pk_bf16_f32 v34, v20, v21
    v_cvt_pk_bf16_f32 v35, v22, v23
    v_mfma_f32_16x16x32_bf16 v[92:95], a[220:223], v[36:39], v[92:95]
    v_subrev_u32 v3, 0.5, v3
    v_max_u32 v61, v61, v3
    v_pk_mul_f32 v[64:65], v[64:65], v[2:3] op_sel_hi:[1,0]
    v_pk_mul_f32 v[66:67], v[66:67], v[2:3] op_sel_hi:[1,0]
    v_pk_mul_f32 v[68:69], v[68:69], v[2:3] op_sel_hi:[1,0]
    v_pk_mul_f32 v[70:71], v[70:71], v[2:3] op_sel_hi:[1,0]
    v_pk_mul_f32 v[72:73], v[72:73], v[2:3] op_sel_hi:[1,0]
    v_pk_mul_f32 v[74:75], v[74:75], v[2:3] op_sel_hi:[1,0]
    v_pk_mul_f32 v[76:77], v[76:77], v[2:3] op_sel_hi:[1,0]
    v_pk_mul_f32 v[78:79], v[78:79], v[2:3] op_sel_hi:[1,0]
    v_pk_mul_f32 v[80:81], v[80:81], v[2:3] op_sel_hi:[1,0]
    v_pk_mul_f32 v[82:83], v[82:83], v[2:3] op_sel_hi:[1,0]
    v_pk_mul_f32 v[84:85], v[84:85], v[2:3] op_sel_hi:[1,0]
    v_pk_mul_f32 v[86:87], v[86:87], v[2:3] op_sel_hi:[1,0]
    v_pk_mul_f32 v[88:89], v[88:89], v[2:3] op_sel_hi:[1,0]
    v_pk_mul_f32 v[90:91], v[90:91], v[2:3] op_sel_hi:[1,0]
    v_pk_mul_f32 v[92:93], v[92:93], v[2:3] op_sel_hi:[1,0]
    v_pk_mul_f32 v[94:95], v[94:95], v[2:3] op_sel_hi:[1,0]
    v_cvt_pk_bf16_f32 v64, v64, v65
    v_cvt_pk_bf16_f32 v65, v66, v67
    v_cvt_pk_bf16_f32 v68, v68, v69
    v_cvt_pk_bf16_f32 v69, v70, v71
    v_cvt_pk_bf16_f32 v72, v72, v73
    v_cvt_pk_bf16_f32 v73, v74, v75
    v_cvt_pk_bf16_f32 v76, v76, v77
    v_cvt_pk_bf16_f32 v77, v78, v79
    v_cvt_pk_bf16_f32 v80, v80, v81
    v_cvt_pk_bf16_f32 v81, v82, v83
    v_cvt_pk_bf16_f32 v84, v84, v85
    v_cvt_pk_bf16_f32 v85, v86, v87
    v_cvt_pk_bf16_f32 v88, v88, v89
    v_cvt_pk_bf16_f32 v89, v90, v91
    v_cvt_pk_bf16_f32 v92, v92, v93
    v_cvt_pk_bf16_f32 v93, v94, v95
    v_mfma_f32_16x16x32_bf16 v[16:19], a[96:99], a[32:35], 0
    v_fma_f32 v24, v24, s43, v41
    v_fma_f32 v25, v25, s43, v41
    v_mfma_f32_16x16x32_bf16 v[16:19], a[100:103], a[36:39], v[16:19]
    ds_write_b64 v5, v[64:65] offset:16640
    v_exp_f32 v24, v24
    v_mfma_f32_16x16x32_bf16 v[16:19], a[104:107], a[40:43], v[16:19]
    ds_write_b64 v6, v[68:69] offset:16640
    v_exp_f32 v25, v25
    v_mfma_f32_16x16x32_bf16 v[16:19], a[108:111], a[44:47], v[16:19]
    ds_write_b64 v7, v[72:73] offset:16640
    v_fma_f32 v26, v26, s43, v41
    v_fma_f32 v27, v27, s43, v41
    v_mfma_f32_16x16x32_bf16 v[20:23], a[112:115], a[32:35], 0
    v_exp_f32 v26, v26
    v_mfma_f32_16x16x32_bf16 v[20:23], a[116:119], a[36:39], v[20:23]
    ds_write_b64 v62, v[76:77] offset:16640
    v_mfma_f32_16x16x32_bf16 v[20:23], a[120:123], a[40:43], v[20:23]
    ds_write_b64 v5, v[80:81] offset:16768
    v_exp_f32 v27, v27
    v_mfma_f32_16x16x32_bf16 v[20:23], a[124:127], a[44:47], v[20:23]
    ds_write_b64 v6, v[84:85] offset:16768
    v_fma_f32 v28, v28, s43, v41
    v_fma_f32 v29, v29, s43, v41
    v_mfma_f32_16x16x32_bf16 v[96:99], a[160:163], v[32:35], v[96:99]
    v_exp_f32 v28, v28
    v_mfma_f32_16x16x32_bf16 v[100:103], a[164:167], v[32:35], v[100:103]
    ds_write_b64 v7, v[88:89] offset:16768
    v_exp_f32 v29, v29
    v_mfma_f32_16x16x32_bf16 v[104:107], a[168:171], v[32:35], v[104:107]
    v_fma_f32 v30, v30, s43, v41
    v_fma_f32 v31, v31, s43, v41
    v_mfma_f32_16x16x32_bf16 v[108:111], a[172:175], v[32:35], v[108:111]
    ds_write_b64 v62, v[92:93] offset:16768
    v_mfma_f32_16x16x32_bf16 v[112:115], a[176:179], v[32:35], v[112:115]
    ds_read_b128 v[64:67], v56 offset:16640
    v_exp_f32 v30, v30
    v_mfma_f32_16x16x32_bf16 v[116:119], a[180:183], v[32:35], v[116:119]
    ds_read_b128 v[72:75], v63 offset:17664
    v_exp_f32 v31, v31
    v_mfma_f32_16x16x32_bf16 v[120:123], a[184:187], v[32:35], v[120:123]
    v_cvt_pk_bf16_f32 v36, v24, v25
    v_cvt_pk_bf16_f32 v37, v26, v27
    v_mfma_f32_16x16x32_bf16 v[124:127], a[188:191], v[32:35], v[124:127]
    v_cvt_pk_bf16_f32 v38, v28, v29
    v_cvt_pk_bf16_f32 v39, v30, v31
    v_mfma_f32_16x16x32_bf16 a[228:231], a[248:251], v[32:35], a[228:231]
    ds_read_b128 v[80:83], v56 offset:18688
    ds_read_b128 v[88:91], v63 offset:19712
    v_mfma_f32_16x16x32_bf16 v[24:27], a[128:131], a[32:35], 0
    v_fma_f32 v16, v16, s43, v42
    v_fma_f32 v17, v17, s43, v42
    v_mfma_f32_16x16x32_bf16 v[24:27], a[132:135], a[36:39], v[24:27]
    v_exp_f32 v16, v16
    v_mfma_f32_16x16x32_bf16 v[24:27], a[136:139], a[40:43], v[24:27]
    s_waitcnt lgkmcnt(2)
    buffer_store_dwordx4 v[64:67], v58, s[24:27], s57 offen sc1 nt
    v_exp_f32 v17, v17
    v_mfma_f32_16x16x32_bf16 v[24:27], a[140:143], a[44:47], v[24:27]
    v_fma_f32 v18, v18, s43, v42
    v_fma_f32 v19, v19, s43, v42
    v_mfma_f32_16x16x32_bf16 v[28:31], a[144:147], a[32:35], 0
    v_exp_f32 v18, v18
    v_mfma_f32_16x16x32_bf16 v[28:31], a[148:151], a[36:39], v[28:31]
    v_mfma_f32_16x16x32_bf16 v[28:31], a[152:155], a[40:43], v[28:31]
    buffer_store_dwordx4 v[72:75], v58, s[24:27], s57 offen offset:1024 sc1 nt
    v_exp_f32 v19, v19
    v_mfma_f32_16x16x32_bf16 v[28:31], a[156:159], a[44:47], v[28:31]
    v_fma_f32 v20, v20, s43, v42
    v_fma_f32 v21, v21, s43, v42
    v_mfma_f32_16x16x32_bf16 a[228:231], a[248:251], v[36:39], a[228:231]
    v_exp_f32 v20, v20
    v_mfma_f32_16x16x32_bf16 v[96:99], a[192:195], v[36:39], v[96:99]
    s_waitcnt lgkmcnt(0)
    buffer_store_dwordx4 v[80:83], v58, s[24:27], s57 offen offset:2048 sc1 nt
    v_exp_f32 v21, v21
    v_mfma_f32_16x16x32_bf16 v[100:103], a[196:199], v[36:39], v[100:103]
    v_fma_f32 v22, v22, s43, v42
    v_fma_f32 v23, v23, s43, v42
    v_mfma_f32_16x16x32_bf16 v[104:107], a[200:203], v[36:39], v[104:107]
    buffer_store_dwordx4 v[88:91], v58, s[24:27], s57 offen offset:3072 sc1 nt
    s_add_u32 s57, s57, 4096
    v_mfma_f32_16x16x32_bf16 v[108:111], a[204:207], v[36:39], v[108:111]
    v_exp_f32 v22, v22
    v_mfma_f32_16x16x32_bf16 v[112:115], a[208:211], v[36:39], v[112:115]
    v_exp_f32 v23, v23
    v_accvgpr_read_b32 v3, a228
    v_mfma_f32_16x16x32_bf16 v[116:119], a[212:215], v[36:39], v[116:119]
    v_cvt_pk_bf16_f32 v32, v16, v17
    v_cvt_pk_bf16_f32 v33, v18, v19
    v_rcp_f32 v2, v3
    v_mfma_f32_16x16x32_bf16 v[120:123], a[216:219], v[36:39], v[120:123]
    v_cvt_pk_bf16_f32 v34, v20, v21
    v_cvt_pk_bf16_f32 v35, v22, v23
    v_mfma_f32_16x16x32_bf16 v[124:127], a[220:223], v[36:39], v[124:127]
    v_subrev_u32 v3, 0.5, v3
    v_max_u32 v61, v61, v3
    v_pk_mul_f32 v[96:97], v[96:97], v[2:3] op_sel_hi:[1,0]
    v_pk_mul_f32 v[98:99], v[98:99], v[2:3] op_sel_hi:[1,0]
    v_pk_mul_f32 v[100:101], v[100:101], v[2:3] op_sel_hi:[1,0]
    v_pk_mul_f32 v[102:103], v[102:103], v[2:3] op_sel_hi:[1,0]
    v_pk_mul_f32 v[104:105], v[104:105], v[2:3] op_sel_hi:[1,0]
    v_pk_mul_f32 v[106:107], v[106:107], v[2:3] op_sel_hi:[1,0]
    v_pk_mul_f32 v[108:109], v[108:109], v[2:3] op_sel_hi:[1,0]
    v_pk_mul_f32 v[110:111], v[110:111], v[2:3] op_sel_hi:[1,0]
    v_pk_mul_f32 v[112:113], v[112:113], v[2:3] op_sel_hi:[1,0]
    v_pk_mul_f32 v[114:115], v[114:115], v[2:3] op_sel_hi:[1,0]
    v_pk_mul_f32 v[116:117], v[116:117], v[2:3] op_sel_hi:[1,0]
    v_pk_mul_f32 v[118:119], v[118:119], v[2:3] op_sel_hi:[1,0]
    v_pk_mul_f32 v[120:121], v[120:121], v[2:3] op_sel_hi:[1,0]
    v_pk_mul_f32 v[122:123], v[122:123], v[2:3] op_sel_hi:[1,0]
    v_pk_mul_f32 v[124:125], v[124:125], v[2:3] op_sel_hi:[1,0]
    v_pk_mul_f32 v[126:127], v[126:127], v[2:3] op_sel_hi:[1,0]
    v_cvt_pk_bf16_f32 v96, v96, v97
    v_cvt_pk_bf16_f32 v97, v98, v99
    v_cvt_pk_bf16_f32 v100, v100, v101
    v_cvt_pk_bf16_f32 v101, v102, v103
    v_cvt_pk_bf16_f32 v104, v104, v105
    v_cvt_pk_bf16_f32 v105, v106, v107
    v_cvt_pk_bf16_f32 v108, v108, v109
    v_cvt_pk_bf16_f32 v109, v110, v111
    v_cvt_pk_bf16_f32 v112, v112, v113
    v_cvt_pk_bf16_f32 v113, v114, v115
    v_cvt_pk_bf16_f32 v116, v116, v117
    v_cvt_pk_bf16_f32 v117, v118, v119
    v_cvt_pk_bf16_f32 v120, v120, v121
    v_cvt_pk_bf16_f32 v121, v122, v123
    v_cvt_pk_bf16_f32 v124, v124, v125
    v_cvt_pk_bf16_f32 v125, v126, v127
    v_mfma_f32_16x16x32_bf16 v[16:19], a[96:99], a[48:51], 0
    v_fma_f32 v24, v24, s43, v42
    v_fma_f32 v25, v25, s43, v42
    v_mfma_f32_16x16x32_bf16 v[16:19], a[100:103], a[52:55], v[16:19]
    ds_write_b64 v5, v[96:97] offset:33280
    v_exp_f32 v24, v24
    v_mfma_f32_16x16x32_bf16 v[16:19], a[104:107], a[56:59], v[16:19]
    ds_write_b64 v6, v[100:101] offset:33280
    v_exp_f32 v25, v25
    v_mfma_f32_16x16x32_bf16 v[16:19], a[108:111], a[60:63], v[16:19]
    ds_write_b64 v7, v[104:105] offset:33280
    v_fma_f32 v26, v26, s43, v42
    v_fma_f32 v27, v27, s43, v42
    v_mfma_f32_16x16x32_bf16 v[20:23], a[112:115], a[48:51], 0
    v_exp_f32 v26, v26
    v_mfma_f32_16x16x32_bf16 v[20:23], a[116:119], a[52:55], v[20:23]
    ds_write_b64 v62, v[108:109] offset:33280
    v_mfma_f32_16x16x32_bf16 v[20:23], a[120:123], a[56:59], v[20:23]
    ds_write_b64 v5, v[112:113] offset:33408
    v_exp_f32 v27, v27
    v_mfma_f32_16x16x32_bf16 v[20:23], a[124:127], a[60:63], v[20:23]
    ds_write_b64 v6, v[116:117] offset:33408
    v_fma_f32 v28, v28, s43, v42
    v_fma_f32 v29, v29, s43, v42
    v_mfma_f32_16x16x32_bf16 v[128:131], a[160:163], v[32:35], v[128:131]
    v_exp_f32 v28, v28
    v_mfma_f32_16x16x32_bf16 v[132:135], a[164:167], v[32:35], v[132:135]
    ds_write_b64 v7, v[120:121] offset:33408
    v_exp_f32 v29, v29
    v_mfma_f32_16x16x32_bf16 v[136:139], a[168:171], v[32:35], v[136:139]
    v_fma_f32 v30, v30, s43, v42
    v_fma_f32 v31, v31, s43, v42
    v_mfma_f32_16x16x32_bf16 v[140:143], a[172:175], v[32:35], v[140:143]
    ds_write_b64 v62, v[124:125] offset:33408
    v_mfma_f32_16x16x32_bf16 v[144:147], a[176:179], v[32:35], v[144:147]
    ds_read_b128 v[96:99], v56 offset:33280
    v_exp_f32 v30, v30
    v_mfma_f32_16x16x32_bf16 v[148:151], a[180:183], v[32:35], v[148:151]
    ds_read_b128 v[104:107], v63 offset:34304
    v_exp_f32 v31, v31
    v_mfma_f32_16x16x32_bf16 v[152:155], a[184:187], v[32:35], v[152:155]
    v_cvt_pk_bf16_f32 v36, v24, v25
    v_cvt_pk_bf16_f32 v37, v26, v27
    v_mfma_f32_16x16x32_bf16 v[156:159], a[188:191], v[32:35], v[156:159]
    v_cvt_pk_bf16_f32 v38, v28, v29
    v_cvt_pk_bf16_f32 v39, v30, v31
    v_mfma_f32_16x16x32_bf16 a[232:235], a[248:251], v[32:35], a[232:235]
    ds_read_b128 v[112:115], v56 offset:35328
    ds_read_b128 v[120:123], v63 offset:36352
    v_mfma_f32_16x16x32_bf16 v[24:27], a[128:131], a[48:51], 0
    v_fma_f32 v16, v16, s43, v43
    v_fma_f32 v17, v17, s43, v43
    v_mfma_f32_16x16x32_bf16 v[24:27], a[132:135], a[52:55], v[24:27]
    v_exp_f32 v16, v16
    v_mfma_f32_16x16x32_bf16 v[24:27], a[136:139], a[56:59], v[24:27]
    s_waitcnt lgkmcnt(2)
    buffer_store_dwordx4 v[96:99], v58, s[24:27], s57 offen sc1 nt
    v_exp_f32 v17, v17
    v_mfma_f32_16x16x32_bf16 v[24:27], a[140:143], a[60:63], v[24:27]
    v_fma_f32 v18, v18, s43, v43
    v_fma_f32 v19, v19, s43, v43
    v_mfma_f32_16x16x32_bf16 v[28:31], a[144:147], a[48:51], 0
    v_exp_f32 v18, v18
    v_mfma_f32_16x16x32_bf16 v[28:31], a[148:151], a[52:55], v[28:31]
    v_mfma_f32_16x16x32_bf16 v[28:31], a[152:155], a[56:59], v[28:31]
    buffer_store_dwordx4 v[104:107], v58, s[24:27], s57 offen offset:1024 sc1 nt
    v_exp_f32 v19, v19
    v_mfma_f32_16x16x32_bf16 v[28:31], a[156:159], a[60:63], v[28:31]
    v_fma_f32 v20, v20, s43, v43
    v_fma_f32 v21, v21, s43, v43
    v_mfma_f32_16x16x32_bf16 a[232:235], a[248:251], v[36:39], a[232:235]
    v_exp_f32 v20, v20
    v_mfma_f32_16x16x32_bf16 v[128:131], a[192:195], v[36:39], v[128:131]
    s_waitcnt lgkmcnt(0)
    buffer_store_dwordx4 v[112:115], v58, s[24:27], s57 offen offset:2048 sc1 nt
    v_exp_f32 v21, v21
    v_mfma_f32_16x16x32_bf16 v[132:135], a[196:199], v[36:39], v[132:135]
    v_fma_f32 v22, v22, s43, v43
    v_fma_f32 v23, v23, s43, v43
    v_mfma_f32_16x16x32_bf16 v[136:139], a[200:203], v[36:39], v[136:139]
Lpad11:
    s_cbranch_execz Lret11
    buffer_store_dwordx4 v[120:123], v58, s[24:27], s57 offen offset:3072 sc1 nt
    s_add_u32 s57, s57, 4096
    v_mfma_f32_16x16x32_bf16 v[140:143], a[204:207], v[36:39], v[140:143]
    v_exp_f32 v22, v22
    v_mfma_f32_16x16x32_bf16 v[144:147], a[208:211], v[36:39], v[144:147]
    v_exp_f32 v23, v23
    v_accvgpr_read_b32 v3, a232
    v_mfma_f32_16x16x32_bf16 v[148:151], a[212:215], v[36:39], v[148:151]
    v_cvt_pk_bf16_f32 v32, v16, v17
    v_cvt_pk_bf16_f32 v33, v18, v19
    v_rcp_f32 v2, v3
    v_mfma_f32_16x16x32_bf16 v[152:155], a[216:219], v[36:39], v[152:155]
    v_cvt_pk_bf16_f32 v34, v20, v21
    v_cvt_pk_bf16_f32 v35, v22, v23
    v_mfma_f32_16x16x32_bf16 v[156:159], a[220:223], v[36:39], v[156:159]
    v_subrev_u32 v3, 0.5, v3
    v_max_u32 v61, v61, v3
    v_pk_mul_f32 v[128:129], v[128:129], v[2:3] op_sel_hi:[1,0]
    v_pk_mul_f32 v[130:131], v[130:131], v[2:3] op_sel_hi:[1,0]
    v_pk_mul_f32 v[132:133], v[132:133], v[2:3] op_sel_hi:[1,0]
    v_pk_mul_f32 v[134:135], v[134:135], v[2:3] op_sel_hi:[1,0]
    v_pk_mul_f32 v[136:137], v[136:137], v[2:3] op_sel_hi:[1,0]
    v_pk_mul_f32 v[138:139], v[138:139], v[2:3] op_sel_hi:[1,0]
    v_pk_mul_f32 v[140:141], v[140:141], v[2:3] op_sel_hi:[1,0]
    v_pk_mul_f32 v[142:143], v[142:143], v[2:3] op_sel_hi:[1,0]
    v_pk_mul_f32 v[144:145], v[144:145], v[2:3] op_sel_hi:[1,0]
    v_pk_mul_f32 v[146:147], v[146:147], v[2:3] op_sel_hi:[1,0]
    v_pk_mul_f32 v[148:149], v[148:149], v[2:3] op_sel_hi:[1,0]
    v_pk_mul_f32 v[150:151], v[150:151], v[2:3] op_sel_hi:[1,0]
    v_pk_mul_f32 v[152:153], v[152:153], v[2:3] op_sel_hi:[1,0]
    v_pk_mul_f32 v[154:155], v[154:155], v[2:3] op_sel_hi:[1,0]
    v_pk_mul_f32 v[156:157], v[156:157], v[2:3] op_sel_hi:[1,0]
    v_pk_mul_f32 v[158:159], v[158:159], v[2:3] op_sel_hi:[1,0]
    v_cvt_pk_bf16_f32 v128, v128, v129
    v_cvt_pk_bf16_f32 v129, v130, v131
    v_cvt_pk_bf16_f32 v132, v132, v133
    v_cvt_pk_bf16_f32 v133, v134, v135
    v_cvt_pk_bf16_f32 v136, v136, v137
    v_cvt_pk_bf16_f32 v137, v138, v139
    v_cvt_pk_bf16_f32 v140, v140, v141
    v_cvt_pk_bf16_f32 v141, v142, v143
    v_cvt_pk_bf16_f32 v144, v144, v145
    v_cvt_pk_bf16_f32 v145, v146, v147
    v_cvt_pk_bf16_f32 v148, v148, v149
    v_cvt_pk_bf16_f32 v149, v150, v151
    v_cvt_pk_bf16_f32 v152, v152, v153
    v_cvt_pk_bf16_f32 v153, v154, v155
    v_cvt_pk_bf16_f32 v156, v156, v157
    v_cvt_pk_bf16_f32 v157, v158, v159
    v_mfma_f32_16x16x32_bf16 v[16:19], a[96:99], a[64:67], 0
    v_fma_f32 v24, v24, s43, v43
    v_fma_f32 v25, v25, s43, v43
    v_mfma_f32_16x16x32_bf16 v[16:19], a[100:103], a[68:71], v[16:19]
    ds_write_b64 v5, v[128:129] offset:16640
    v_exp_f32 v24, v24
    v_mfma_f32_16x16x32_bf16 v[16:19], a[104:107], a[72:75], v[16:19]
    ds_write_b64 v6, v[132:133] offset:16640
    v_exp_f32 v25, v25
    v_mfma_f32_16x16x32_bf16 v[16:19], a[108:111], a[76:79], v[16:19]
    ds_write_b64 v7, v[136:137] offset:16640
    v_fma_f32 v26, v26, s43, v43
    v_fma_f32 v27, v27, s43, v43
    v_mfma_f32_16x16x32_bf16 v[20:23], a[112:115], a[64:67], 0
    v_exp_f32 v26, v26
    v_mfma_f32_16x16x32_bf16 v[20:23], a[116:119], a[68:71], v[20:23]
    ds_write_b64 v62, v[140:141] offset:16640
    v_mfma_f32_16x16x32_bf16 v[20:23], a[120:123], a[72:75], v[20:23]
    ds_write_b64 v5, v[144:145] offset:16768
    v_exp_f32 v27, v27
    v_mfma_f32_16x16x32_bf16 v[20:23], a[124:127], a[76:79], v[20:23]
    ds_write_b64 v6, v[148:149] offset:16768
    v_fma_f32 v28, v28, s43, v43
    v_fma_f32 v29, v29, s43, v43
    v_mfma_f32_16x16x32_bf16 v[160:163], a[160:163], v[32:35], v[160:163]
    v_exp_f32 v28, v28
    v_mfma_f32_16x16x32_bf16 v[164:167], a[164:167], v[32:35], v[164:167]
    ds_write_b64 v7, v[152:153] offset:16768
    v_exp_f32 v29, v29
    v_mfma_f32_16x16x32_bf16 v[168:171], a[168:171], v[32:35], v[168:171]
    v_fma_f32 v30, v30, s43, v43
    v_fma_f32 v31, v31, s43, v43
    v_mfma_f32_16x16x32_bf16 v[172:175], a[172:175], v[32:35], v[172:175]
    ds_write_b64 v62, v[156:157] offset:16768
    v_mfma_f32_16x16x32_bf16 v[176:179], a[176:179], v[32:35], v[176:179]
    ds_read_b128 v[128:131], v56 offset:16640
    v_exp_f32 v30, v30
    v_mfma_f32_16x16x32_bf16 v[180:183], a[180:183], v[32:35], v[180:183]
    ds_read_b128 v[136:139], v63 offset:17664
    v_exp_f32 v31, v31
    v_mfma_f32_16x16x32_bf16 v[184:187], a[184:187], v[32:35], v[184:187]
    v_cvt_pk_bf16_f32 v36, v24, v25
    v_cvt_pk_bf16_f32 v37, v26, v27
    v_mfma_f32_16x16x32_bf16 v[188:191], a[188:191], v[32:35], v[188:191]
    v_cvt_pk_bf16_f32 v38, v28, v29
    v_cvt_pk_bf16_f32 v39, v30, v31
    v_mfma_f32_16x16x32_bf16 a[236:239], a[248:251], v[32:35], a[236:239]
    ds_read_b128 v[144:147], v56 offset:18688
    ds_read_b128 v[152:155], v63 offset:19712
    v_mfma_f32_16x16x32_bf16 v[24:27], a[128:131], a[64:67], 0
    v_fma_f32 v16, v16, s43, v44
    v_fma_f32 v17, v17, s43, v44
    v_mfma_f32_16x16x32_bf16 v[24:27], a[132:135], a[68:71], v[24:27]
    v_exp_f32 v16, v16
    v_mfma_f32_16x16x32_bf16 v[24:27], a[136:139], a[72:75], v[24:27]
    s_waitcnt lgkmcnt(2)
    buffer_store_dwordx4 v[128:131], v58, s[24:27], s57 offen sc1 nt
    v_exp_f32 v17, v17
    v_mfma_f32_16x16x32_bf16 v[24:27], a[140:143], a[76:79], v[24:27]
    v_fma_f32 v18, v18, s43, v44
    v_fma_f32 v19, v19, s43, v44
    v_mfma_f32_16x16x32_bf16 v[28:31], a[144:147], a[64:67], 0
    v_exp_f32 v18, v18
    v_mfma_f32_16x16x32_bf16 v[28:31], a[148:151], a[68:71], v[28:31]
    v_mfma_f32_16x16x32_bf16 v[28:31], a[152:155], a[72:75], v[28:31]
    buffer_store_dwordx4 v[136:139], v58, s[24:27], s57 offen offset:1024 sc1 nt
    v_exp_f32 v19, v19
    v_mfma_f32_16x16x32_bf16 v[28:31], a[156:159], a[76:79], v[28:31]
    v_fma_f32 v20, v20, s43, v44
    v_fma_f32 v21, v21, s43, v44
    v_mfma_f32_16x16x32_bf16 a[236:239], a[248:251], v[36:39], a[236:239]
    v_exp_f32 v20, v20
    v_mfma_f32_16x16x32_bf16 v[160:163], a[192:195], v[36:39], v[160:163]
    s_waitcnt lgkmcnt(0)
    buffer_store_dwordx4 v[144:147], v58, s[24:27], s57 offen offset:2048 sc1 nt
    v_exp_f32 v21, v21
    v_mfma_f32_16x16x32_bf16 v[164:167], a[196:199], v[36:39], v[164:167]
    v_fma_f32 v22, v22, s43, v44
    v_fma_f32 v23, v23, s43, v44
    v_mfma_f32_16x16x32_bf16 v[168:171], a[200:203], v[36:39], v[168:171]
    buffer_store_dwordx4 v[152:155], v58, s[24:27], s57 offen offset:3072 sc1 nt
    s_add_u32 s57, s57, 4096
    v_mfma_f32_16x16x32_bf16 v[172:175], a[204:207], v[36:39], v[172:175]
    v_exp_f32 v22, v22
    v_mfma_f32_16x16x32_bf16 v[176:179], a[208:211], v[36:39], v[176:179]
    v_exp_f32 v23, v23
    v_accvgpr_read_b32 v3, a236
    v_mfma_f32_16x16x32_bf16 v[180:183], a[212:215], v[36:39], v[180:183]
    v_cvt_pk_bf16_f32 v32, v16, v17
    v_cvt_pk_bf16_f32 v33, v18, v19
    v_rcp_f32 v2, v3
    v_mfma_f32_16x16x32_bf16 v[184:187], a[216:219], v[36:39], v[184:187]
    v_cvt_pk_bf16_f32 v34, v20, v21
    v_cvt_pk_bf16_f32 v35, v22, v23
    v_mfma_f32_16x16x32_bf16 v[188:191], a[220:223], v[36:39], v[188:191]
    v_subrev_u32 v3, 0.5, v3
    v_max_u32 v61, v61, v3
    v_pk_mul_f32 v[160:161], v[160:161], v[2:3] op_sel_hi:[1,0]
    v_pk_mul_f32 v[162:163], v[162:163], v[2:3] op_sel_hi:[1,0]
    v_pk_mul_f32 v[164:165], v[164:165], v[2:3] op_sel_hi:[1,0]
    v_pk_mul_f32 v[166:167], v[166:167], v[2:3] op_sel_hi:[1,0]
    v_pk_mul_f32 v[168:169], v[168:169], v[2:3] op_sel_hi:[1,0]
    v_pk_mul_f32 v[170:171], v[170:171], v[2:3] op_sel_hi:[1,0]
    v_pk_mul_f32 v[172:173], v[172:173], v[2:3] op_sel_hi:[1,0]
    v_pk_mul_f32 v[174:175], v[174:175], v[2:3] op_sel_hi:[1,0]
    v_pk_mul_f32 v[176:177], v[176:177], v[2:3] op_sel_hi:[1,0]
    v_pk_mul_f32 v[178:179], v[178:179], v[2:3] op_sel_hi:[1,0]
    v_pk_mul_f32 v[180:181], v[180:181], v[2:3] op_sel_hi:[1,0]
    v_pk_mul_f32 v[182:183], v[182:183], v[2:3] op_sel_hi:[1,0]
    v_pk_mul_f32 v[184:185], v[184:185], v[2:3] op_sel_hi:[1,0]
    v_pk_mul_f32 v[186:187], v[186:187], v[2:3] op_sel_hi:[1,0]
    v_pk_mul_f32 v[188:189], v[188:189], v[2:3] op_sel_hi:[1,0]
    v_pk_mul_f32 v[190:191], v[190:191], v[2:3] op_sel_hi:[1,0]
    v_cvt_pk_bf16_f32 v160, v160, v161
    v_cvt_pk_bf16_f32 v161, v162, v163
    v_cvt_pk_bf16_f32 v164, v164, v165
    v_cvt_pk_bf16_f32 v165, v166, v167
    v_cvt_pk_bf16_f32 v168, v168, v169
    v_cvt_pk_bf16_f32 v169, v170, v171
    v_cvt_pk_bf16_f32 v172, v172, v173
    v_cvt_pk_bf16_f32 v173, v174, v175
    v_cvt_pk_bf16_f32 v176, v176, v177
    v_cvt_pk_bf16_f32 v177, v178, v179
    v_cvt_pk_bf16_f32 v180, v180, v181
    v_cvt_pk_bf16_f32 v181, v182, v183
    v_cvt_pk_bf16_f32 v184, v184, v185
    v_cvt_pk_bf16_f32 v185, v186, v187
    v_cvt_pk_bf16_f32 v188, v188, v189
    v_cvt_pk_bf16_f32 v189, v190, v191
    v_mfma_f32_16x16x32_bf16 v[16:19], a[96:99], a[80:83], 0
    v_fma_f32 v24, v24, s43, v44
    v_fma_f32 v25, v25, s43, v44
    v_mfma_f32_16x16x32_bf16 v[16:19], a[100:103], a[84:87], v[16:19]
    ds_write_b64 v5, v[160:161] offset:33280
    v_exp_f32 v24, v24
    v_mfma_f32_16x16x32_bf16 v[16:19], a[104:107], a[88:91], v[16:19]
    ds_write_b64 v6, v[164:165] offset:33280
    v_exp_f32 v25, v25
    v_mfma_f32_16x16x32_bf16 v[16:19], a[108:111], a[92:95], v[16:19]
    ds_write_b64 v7, v[168:169] offset:33280
    v_fma_f32 v26, v26, s43, v44
    v_fma_f32 v27, v27, s43, v44
    v_mfma_f32_16x16x32_bf16 v[20:23], a[112:115], a[80:83], 0
    v_exp_f32 v26, v26
    v_mfma_f32_16x16x32_bf16 v[20:23], a[116:119], a[84:87], v[20:23]
    ds_write_b64 v62, v[172:173] offset:33280
    v_mfma_f32_16x16x32_bf16 v[20:23], a[120:123], a[88:91], v[20:23]
    ds_write_b64 v5, v[176:177] offset:33408
    v_exp_f32 v27, v27
    v_mfma_f32_16x16x32_bf16 v[20:23], a[124:127], a[92:95], v[20:23]
    ds_write_b64 v6, v[180:181] offset:33408
    v_fma_f32 v28, v28, s43, v44
    v_fma_f32 v29, v29, s43, v44
    v_mfma_f32_16x16x32_bf16 v[192:195], a[160:163], v[32:35], v[192:195]
    v_exp_f32 v28, v28
    v_mfma_f32_16x16x32_bf16 v[196:199], a[164:167], v[32:35], v[196:199]
    ds_write_b64 v7, v[184:185] offset:33408
    v_exp_f32 v29, v29
    v_mfma_f32_16x16x32_bf16 v[200:203], a[168:171], v[32:35], v[200:203]
    v_fma_f32 v30, v30, s43, v44
    v_fma_f32 v31, v31, s43, v44
    v_mfma_f32_16x16x32_bf16 v[204:207], a[172:175], v[32:35], v[204:207]
    ds_write_b64 v62, v[188:189] offset:33408
    v_mfma_f32_16x16x32_bf16 v[208:211], a[176:179], v[32:35], v[208:211]
    ds_read_b128 v[160:163], v56 offset:33280
    v_exp_f32 v30, v30
    v_mfma_f32_16x16x32_bf16 v[212:215], a[180:183], v[32:35], v[212:215]
    ds_read_b128 v[168:171], v63 offset:34304
    v_exp_f32 v31, v31
    v_mfma_f32_16x16x32_bf16 v[216:219], a[184:187], v[32:35], v[216:219]
    v_cvt_pk_bf16_f32 v36, v24, v25
    v_cvt_pk_bf16_f32 v37, v26, v27
    v_mfma_f32_16x16x32_bf16 v[220:223], a[188:191], v[32:35], v[220:223]
    v_cvt_pk_bf16_f32 v38, v28, v29
    v_cvt_pk_bf16_f32 v39, v30, v31
    v_mfma_f32_16x16x32_bf16 a[240:243], a[248:251], v[32:35], a[240:243]
    ds_read_b128 v[176:179], v56 offset:35328
    ds_read_b128 v[184:187], v63 offset:36352
    v_mfma_f32_16x16x32_bf16 v[24:27], a[128:131], a[80:83], 0
    v_fma_f32 v16, v16, s43, v45
    v_fma_f32 v17, v17, s43, v45
    v_mfma_f32_16x16x32_bf16 v[24:27], a[132:135], a[84:87], v[24:27]
    v_exp_f32 v16, v16
    v_mfma_f32_16x16x32_bf16 v[24:27], a[136:139], a[88:91], v[24:27]
    s_waitcnt lgkmcnt(2)
    buffer_store_dwordx4 v[160:163], v58, s[24:27], s57 offen sc1 nt
    v_exp_f32 v17, v17
    v_mfma_f32_16x16x32_bf16 v[24:27], a[140:143], a[92:95], v[24:27]
    v_fma_f32 v18, v18, s43, v45
    v_fma_f32 v19, v19, s43, v45
    v_mfma_f32_16x16x32_bf16 v[28:31], a[144:147], a[80:83], 0
    v_exp_f32 v18, v18
    v_mfma_f32_16x16x32_bf16 v[28:31], a[148:151], a[84:87], v[28:31]
    v_mfma_f32_16x16x32_bf16 v[28:31], a[152:155], a[88:91], v[28:31]
    buffer_store_dwordx4 v[168:171], v58, s[24:27], s57 offen offset:1024 sc1 nt
    v_exp_f32 v19, v19
    v_mfma_f32_16x16x32_bf16 v[28:31], a[156:159], a[92:95], v[28:31]
    v_fma_f32 v20, v20, s43, v45
    v_fma_f32 v21, v21, s43, v45
    v_mfma_f32_16x16x32_bf16 a[240:243], a[248:251], v[36:39], a[240:243]
    v_exp_f32 v20, v20
    v_mfma_f32_16x16x32_bf16 v[192:195], a[192:195], v[36:39], v[192:195]
    s_waitcnt lgkmcnt(0)
    buffer_store_dwordx4 v[176:179], v58, s[24:27], s57 offen offset:2048 sc1 nt
    v_exp_f32 v21, v21
    v_mfma_f32_16x16x32_bf16 v[196:199], a[196:199], v[36:39], v[196:199]
    v_fma_f32 v22, v22, s43, v45
    v_fma_f32 v23, v23, s43, v45
    v_mfma_f32_16x16x32_bf16 v[200:203], a[200:203], v[36:39], v[200:203]
    buffer_store_dwordx4 v[184:187], v58, s[24:27], s57 offen offset:3072 sc1 nt
    s_add_u32 s57, s57, 4096
    v_mfma_f32_16x16x32_bf16 v[204:207], a[204:207], v[36:39], v[204:207]
    v_exp_f32 v22, v22
    v_mfma_f32_16x16x32_bf16 v[208:211], a[208:211], v[36:39], v[208:211]
    v_exp_f32 v23, v23
    v_accvgpr_read_b32 v3, a240
    v_mfma_f32_16x16x32_bf16 v[212:215], a[212:215], v[36:39], v[212:215]
    v_cvt_pk_bf16_f32 v32, v16, v17
    v_cvt_pk_bf16_f32 v33, v18, v19
    v_rcp_f32 v2, v3
    v_mfma_f32_16x16x32_bf16 v[216:219], a[216:219], v[36:39], v[216:219]
    v_cvt_pk_bf16_f32 v34, v20, v21
    v_cvt_pk_bf16_f32 v35, v22, v23
    v_mfma_f32_16x16x32_bf16 v[220:223], a[220:223], v[36:39], v[220:223]
    v_subrev_u32 v3, 0.5, v3
    v_max_u32 v61, v61, v3
    v_pk_mul_f32 v[192:193], v[192:193], v[2:3] op_sel_hi:[1,0]
    v_pk_mul_f32 v[194:195], v[194:195], v[2:3] op_sel_hi:[1,0]
    v_pk_mul_f32 v[196:197], v[196:197], v[2:3] op_sel_hi:[1,0]
    v_pk_mul_f32 v[198:199], v[198:199], v[2:3] op_sel_hi:[1,0]
    v_pk_mul_f32 v[200:201], v[200:201], v[2:3] op_sel_hi:[1,0]
    v_pk_mul_f32 v[202:203], v[202:203], v[2:3] op_sel_hi:[1,0]
    v_pk_mul_f32 v[204:205], v[204:205], v[2:3] op_sel_hi:[1,0]
    v_pk_mul_f32 v[206:207], v[206:207], v[2:3] op_sel_hi:[1,0]
    v_pk_mul_f32 v[208:209], v[208:209], v[2:3] op_sel_hi:[1,0]
    v_pk_mul_f32 v[210:211], v[210:211], v[2:3] op_sel_hi:[1,0]
    v_pk_mul_f32 v[212:213], v[212:213], v[2:3] op_sel_hi:[1,0]
    v_pk_mul_f32 v[214:215], v[214:215], v[2:3] op_sel_hi:[1,0]
    v_pk_mul_f32 v[216:217], v[216:217], v[2:3] op_sel_hi:[1,0]
    v_pk_mul_f32 v[218:219], v[218:219], v[2:3] op_sel_hi:[1,0]
    v_pk_mul_f32 v[220:221], v[220:221], v[2:3] op_sel_hi:[1,0]
    v_pk_mul_f32 v[222:223], v[222:223], v[2:3] op_sel_hi:[1,0]
    v_cvt_pk_bf16_f32 v192, v192, v193
    v_cvt_pk_bf16_f32 v193, v194, v195
    v_cvt_pk_bf16_f32 v196, v196, v197
    v_cvt_pk_bf16_f32 v197, v198, v199
    v_cvt_pk_bf16_f32 v200, v200, v201
    v_cvt_pk_bf16_f32 v201, v202, v203
    v_cvt_pk_bf16_f32 v204, v204, v205
    v_cvt_pk_bf16_f32 v205, v206, v207
    v_cvt_pk_bf16_f32 v208, v208, v209
    v_cvt_pk_bf16_f32 v209, v210, v211
    v_cvt_pk_bf16_f32 v212, v212, v213
    v_cvt_pk_bf16_f32 v213, v214, v215
    v_cvt_pk_bf16_f32 v216, v216, v217
    v_cvt_pk_bf16_f32 v217, v218, v219
    v_cvt_pk_bf16_f32 v220, v220, v221
    v_cvt_pk_bf16_f32 v221, v222, v223
    v_fma_f32 v24, v24, s43, v45
    v_fma_f32 v25, v25, s43, v45
    v_exp_f32 v24, v24
    v_exp_f32 v25, v25
    v_fma_f32 v26, v26, s43, v45
    v_fma_f32 v27, v27, s43, v45
    v_exp_f32 v26, v26
    v_exp_f32 v27, v27
    v_fma_f32 v28, v28, s43, v45
    v_fma_f32 v29, v29, s43, v45
    v_mfma_f32_16x16x32_bf16 v[224:227], a[160:163], v[32:35], v[224:227]
    ds_write_b64 v5, v[192:193] offset:16640
    v_exp_f32 v28, v28
    v_mfma_f32_16x16x32_bf16 v[228:231], a[164:167], v[32:35], v[228:231]
    ds_write_b64 v6, v[196:197] offset:16640
    v_exp_f32 v29, v29
    v_mfma_f32_16x16x32_bf16 v[232:235], a[168:171], v[32:35], v[232:235]
    ds_write_b64 v7, v[200:201] offset:16640
    v_fma_f32 v30, v30, s43, v45
    v_fma_f32 v31, v31, s43, v45
    v_mfma_f32_16x16x32_bf16 v[236:239], a[172:175], v[32:35], v[236:239]
    ds_write_b64 v62, v[204:205] offset:16640
    ds_write_b64 v5, v[208:209] offset:16768
    ds_write_b64 v6, v[212:213] offset:16768
    v_mfma_f32_16x16x32_bf16 v[240:243], a[176:179], v[32:35], v[240:243]
    ds_write_b64 v7, v[216:217] offset:16768
    v_exp_f32 v30, v30
    v_mfma_f32_16x16x32_bf16 v[244:247], a[180:183], v[32:35], v[244:247]
    ds_write_b64 v62, v[220:221] offset:16768
    v_exp_f32 v31, v31
    v_mfma_f32_16x16x32_bf16 v[248:251], a[184:187], v[32:35], v[248:251]
    ds_read_b128 v[192:195], v56 offset:16640
    v_cvt_pk_bf16_f32 v36, v24, v25
    v_cvt_pk_bf16_f32 v37, v26, v27
    v_mfma_f32_16x16x32_bf16 v[252:255], a[188:191], v[32:35], v[252:255]
    ds_read_b128 v[200:203], v63 offset:17664
    v_cvt_pk_bf16_f32 v38, v28, v29
    v_cvt_pk_bf16_f32 v39, v30, v31
    v_mfma_f32_16x16x32_bf16 a[244:247], a[248:251], v[32:35], a[244:247]
    ds_read_b128 v[208:211], v56 offset:18688
    ds_read_b128 v[216:219], v63 offset:19712
    v_mfma_f32_16x16x32_bf16 a[244:247], a[248:251], v[36:39], a[244:247]
    v_mfma_f32_16x16x32_bf16 v[224:227], a[192:195], v[36:39], v[224:227]
    s_waitcnt lgkmcnt(2)
    buffer_store_dwordx4 v[192:195], v58, s[24:27], s57 offen sc1 nt
    v_mfma_f32_16x16x32_bf16 v[228:231], a[196:199], v[36:39], v[228:231]
    v_mfma_f32_16x16x32_bf16 v[232:235], a[200:203], v[36:39], v[232:235]
    buffer_store_dwordx4 v[200:203], v58, s[24:27], s57 offen offset:1024 sc1 nt
    v_mfma_f32_16x16x32_bf16 v[236:239], a[204:207], v[36:39], v[236:239]
    s_waitcnt lgkmcnt(0)
    buffer_store_dwordx4 v[208:211], v58, s[24:27], s57 offen offset:2048 sc1 nt
    v_mfma_f32_16x16x32_bf16 v[240:243], a[208:211], v[36:39], v[240:243]
    v_mfma_f32_16x16x32_bf16 v[244:247], a[212:215], v[36:39], v[244:247]
    buffer_store_dwordx4 v[216:219], v58, s[24:27], s57 offen offset:3072 sc1 nt
    s_add_u32 s57, s57, 4096
    v_mfma_f32_16x16x32_bf16 v[248:251], a[216:219], v[36:39], v[248:251]
    v_mfma_f32_16x16x32_bf16 v[252:255], a[220:223], v[36:39], v[252:255]
    v_accvgpr_read_b32 v3, a244
    v_rcp_f32 v2, v3
    v_subrev_u32 v3, 0.5, v3
    v_max_u32 v61, v61, v3
    v_pk_mul_f32 v[224:225], v[224:225], v[2:3] op_sel_hi:[1,0]
    v_pk_mul_f32 v[226:227], v[226:227], v[2:3] op_sel_hi:[1,0]
    v_pk_mul_f32 v[228:229], v[228:229], v[2:3] op_sel_hi:[1,0]
    v_pk_mul_f32 v[230:231], v[230:231], v[2:3] op_sel_hi:[1,0]
    v_pk_mul_f32 v[232:233], v[232:233], v[2:3] op_sel_hi:[1,0]
    v_pk_mul_f32 v[234:235], v[234:235], v[2:3] op_sel_hi:[1,0]
    v_pk_mul_f32 v[236:237], v[236:237], v[2:3] op_sel_hi:[1,0]
    v_pk_mul_f32 v[238:239], v[238:239], v[2:3] op_sel_hi:[1,0]
    v_cvt_pk_bf16_f32 v224, v224, v225
    v_cvt_pk_bf16_f32 v225, v226, v227
    v_cvt_pk_bf16_f32 v228, v228, v229
    v_cvt_pk_bf16_f32 v229, v230, v231
    v_cvt_pk_bf16_f32 v232, v232, v233
    v_cvt_pk_bf16_f32 v233, v234, v235
    v_cvt_pk_bf16_f32 v236, v236, v237
    v_cvt_pk_bf16_f32 v237, v238, v239
    ds_write_b64 v5, v[224:225] offset:49920
    ds_write_b64 v6, v[228:229] offset:49920
    ds_write_b64 v7, v[232:233] offset:49920
    ds_write_b64 v62, v[236:237] offset:49920
    v_pk_mul_f32 v[240:241], v[240:241], v[2:3] op_sel_hi:[1,0]
    v_pk_mul_f32 v[242:243], v[242:243], v[2:3] op_sel_hi:[1,0]
    v_pk_mul_f32 v[244:245], v[244:245], v[2:3] op_sel_hi:[1,0]
    v_pk_mul_f32 v[246:247], v[246:247], v[2:3] op_sel_hi:[1,0]
    v_pk_mul_f32 v[248:249], v[248:249], v[2:3] op_sel_hi:[1,0]
    v_pk_mul_f32 v[250:251], v[250:251], v[2:3] op_sel_hi:[1,0]
    v_pk_mul_f32 v[252:253], v[252:253], v[2:3] op_sel_hi:[1,0]
    v_pk_mul_f32 v[254:255], v[254:255], v[2:3] op_sel_hi:[1,0]
    v_cvt_pk_bf16_f32 v240, v240, v241
    v_cvt_pk_bf16_f32 v241, v242, v243
    v_cvt_pk_bf16_f32 v244, v244, v245
    v_cvt_pk_bf16_f32 v245, v246, v247
    v_cvt_pk_bf16_f32 v248, v248, v249
    v_cvt_pk_bf16_f32 v249, v250, v251
    v_cvt_pk_bf16_f32 v252, v252, v253
    v_cvt_pk_bf16_f32 v253, v254, v255
    ds_write_b64 v5, v[240:241] offset:50048
    ds_write_b64 v6, v[244:245] offset:50048
    ds_write_b64 v7, v[248:249] offset:50048
    ds_write_b64 v62, v[252:253] offset:50048
    ds_read_b128 v[224:227], v56 offset:49920
    ds_read_b128 v[232:235], v63 offset:50944
    ds_read_b128 v[240:243], v56 offset:51968
    ds_read_b128 v[248:251], v63 offset:52992
    s_waitcnt lgkmcnt(3)
    buffer_store_dwordx4 v[224:227], v58, s[24:27], s57 offen sc1 nt
    s_waitcnt lgkmcnt(2)
    buffer_store_dwordx4 v[232:235], v58, s[24:27], s57 offen offset:1024 sc1 nt
    s_waitcnt lgkmcnt(1)
    buffer_store_dwordx4 v[240:243], v58, s[24:27], s57 offen offset:2048 sc1 nt
    s_waitcnt lgkmcnt(0)
    buffer_store_dwordx4 v[248:251], v58, s[24:27], s57 offen offset:3072 sc1 nt
    v_cmp_lt_u32 s[52:53], s51, v0
    v_cmp_lt_u32 s[96:97], s51, v61
    s_or_b64 s[62:63], s[52:53], s[96:97]
    s_barrier
    s_cbranch_scc1 Lslow_entry
Lfin:
Lend:
    s_endpgm
Lslow_entry:
    s_cmp_lg_u64 s[52:53], 0
    s_cbranch_scc1 Lslow
Lslow_ret:
    s_cmp_eq_u64 s[96:97], 0
    s_cbranch_scc1 Lfin
    s_mov_b64 s[96:97], 0
    s_mov_b32 s44, s59
Lslow:
    s_waitcnt vmcnt(0) lgkmcnt(0)
    s_mul_i32 s42, s3, 16640
    s_add_u32 s55, s42, s45
    v_add_u32 v46, s55, v48
    v_add_u32 v47, s55, v49
    v_lshrrev_b32 v0, 4, v58
    v_lshrrev_b32 v2, 4, v0
    v_and_b32 v4, 3, v0
    v_bfe_u32 v3, v0, 2, 1
    v_mul_u32_u24 v9, 2080, v3
    v_bfe_u32 v3, v0, 3, 1
    v_lshl_add_u32 v9, v3, 10, v9
    v_lshl_add_u32 v9, v4, 8, v9
    v_lshl_add_u32 v9, v2, 4, v9
    v_add_u32 v9, s55, v9
    v_xor_b32 v3, 0, v4
    v_lshl_add_u32 v52, v3, 6, v9
    v_xor_b32 v3, 1, v4
    v_lshl_add_u32 v53, v3, 6, v9
    v_xor_b32 v3, 2, v4
    v_lshl_add_u32 v54, v3, 6, v9
    v_xor_b32 v3, 3, v4
    v_lshl_add_u32 v55, v3, 6, v9
    v_and_b32 v8, 15, v0
    v_xor_b32 v9, v8, v2
    v_lshlrev_b32 v10, 8, v2
    v_add_u32 v10, s55, v10
    v_lshl_add_u32 v56, v9, 4, v10
    v_xor_b32 v9, 4, v9
    v_lshl_add_u32 v63, v9, 4, v10
    v_lshlrev_b32 v10, 8, v8
    v_and_b32 v9, 1, v2
    v_lshl_add_u32 v10, v9, 3, v10
    v_add_u32 v10, s55, v10
    v_lshrrev_b32 v9, 1, v2
    v_and_b32 v8, 7, v0
    v_xor_b32 v9, v9, v8
    v_xor_b32 v8, 0, v9
    v_lshl_add_u32 v5, v8, 4, v10
    v_xor_b32 v8, 2, v9
    v_lshl_add_u32 v6, v8, 4, v10
    v_xor_b32 v8, 4, v9
    v_lshl_add_u32 v7, v8, 4, v10
    v_xor_b32 v8, 6, v9
    v_lshl_add_u32 v62, v8, 4, v10
    s_mov_b32 m0, s55
    s_add_u32 s40, s44, s50
    buffer_load_dwordx4 v59, s[16:19], s40 offen nt lds
    buffer_load_dwordx4 v59, s[20:23], s40 offen offset:1024 nt lds
    buffer_load_dwordx4 v60, s[16:19], s40 offen offset:2080 nt lds
    buffer_load_dwordx4 v60, s[20:23], s40 offen offset:3104 nt lds
    s_waitcnt vmcnt(0)
    ds_read_b128 a[0:3], v52
    ds_read_b128 a[4:7], v53
    ds_read_b128 a[8:11], v54
    ds_read_b128 a[12:15], v55
    s_add_u32 s40, s40, 4096
    s_waitcnt lgkmcnt(0)
    buffer_load_dwordx4 v59, s[16:19], s40 offen nt lds
    buffer_load_dwordx4 v59, s[20:23], s40 offen offset:1024 nt lds
    buffer_load_dwordx4 v60, s[16:19], s40 offen offset:2080 nt lds
    buffer_load_dwordx4 v60, s[20:23], s40 offen offset:3104 nt lds
    s_waitcnt vmcnt(0)
    ds_read_b128 a[16:19], v52
    ds_read_b128 a[20:23], v53
    ds_read_b128 a[24:27], v54
    ds_read_b128 a[28:31], v55
    s_add_u32 s40, s40, 4096
    s_waitcnt lgkmcnt(0)
    buffer_load_dwordx4 v59, s[16:19], s40 offen nt lds
    buffer_load_dwordx4 v59, s[20:23], s40 offen offset:1024 nt lds
    buffer_load_dwordx4 v60, s[16:19], s40 offen offset:2080 nt lds
    buffer_load_dwordx4 v60, s[20:23], s40 offen offset:3104 nt lds
    s_waitcnt vmcnt(0)
    ds_read_b128 a[32:35], v52
    ds_read_b128 a[36:39], v53
    ds_read_b128 a[40:43], v54
    ds_read_b128 a[44:47], v55
    s_add_u32 s40, s40, 4096
    s_waitcnt lgkmcnt(0)
    buffer_load_dwordx4 v59, s[16:19], s40 offen nt lds
    buffer_load_dwordx4 v59, s[20:23], s40 offen offset:1024 nt lds
    buffer_load_dwordx4 v60, s[16:19], s40 offen offset:2080 nt lds
    buffer_load_dwordx4 v60, s[20:23], s40 offen offset:3104 nt lds
    s_waitcnt vmcnt(0)
    ds_read_b128 a[48:51], v52
    ds_read_b128 a[52:55], v53
    ds_read_b128 a[56:59], v54
    ds_read_b128 a[60:63], v55
    s_add_u32 s40, s40, 4096
    s_waitcnt lgkmcnt(0)
    buffer_load_dwordx4 v59, s[16:19], s40 offen nt lds
    buffer_load_dwordx4 v59, s[20:23], s40 offen offset:1024 nt lds
    buffer_load_dwordx4 v60, s[16:19], s40 offen offset:2080 nt lds
    buffer_load_dwordx4 v60, s[20:23], s40 offen offset:3104 nt lds
    s_waitcnt vmcnt(0)
    ds_read_b128 a[64:67], v52
    ds_read_b128 a[68:71], v53
    ds_read_b128 a[72:75], v54
    ds_read_b128 a[76:79], v55
    s_add_u32 s40, s40, 4096
    s_waitcnt lgkmcnt(0)
    buffer_load_dwordx4 v59, s[16:19], s40 offen nt lds
    buffer_load_dwordx4 v59, s[20:23], s40 offen offset:1024 nt lds
    buffer_load_dwordx4 v60, s[16:19], s40 offen offset:2080 nt lds
    buffer_load_dwordx4 v60, s[20:23], s40 offen offset:3104 nt lds
    s_waitcnt vmcnt(0)
    ds_read_b128 a[80:83], v52
    ds_read_b128 a[84:87], v53
    ds_read_b128 a[88:91], v54
    ds_read_b128 a[92:95], v55
    s_add_u32 s40, s40, 4096
    s_waitcnt lgkmcnt(0)
    v_mov_b32 v40, 0xff800000
    v_mov_b32 v41, 0xff800000
    v_mov_b32 v42, 0xff800000
    v_mov_b32 v43, 0xff800000
    v_mov_b32 v44, 0xff800000
    v_mov_b32 v45, 0xff800000
    s_mov_b32 s40, s44
    s_mov_b32 s46, 0
Lslow1:
    s_add_u32 m0, s42, 0
    s_nop 0
    buffer_load_dwordx4 v57, s[8:11], s40 offen nt lds
    buffer_load_dwordx4 v57, s[12:15], s40 offen offset:1024 nt lds
    buffer_load_dwordx4 v58, s[8:11], s40 offen offset:2080 nt lds
    buffer_load_dwordx4 v58, s[12:15], s40 offen offset:3104 nt lds
    s_add_u32 s40, s40, 2048
    s_add_u32 m0, s42, 4160
    s_nop 0
    buffer_load_dwordx4 v57, s[8:11], s40 offen nt lds
    buffer_load_dwordx4 v57, s[12:15], s40 offen offset:1024 nt lds
    buffer_load_dwordx4 v58, s[8:11], s40 offen offset:2080 nt lds
    buffer_load_dwordx4 v58, s[12:15], s40 offen offset:3104 nt lds
    s_add_u32 s40, s40, 2048
    s_add_u32 m0, s42, 8320
    s_nop 0
    buffer_load_dwordx4 v57, s[8:11], s40 offen nt lds
    buffer_load_dwordx4 v57, s[12:15], s40 offen offset:1024 nt lds
    buffer_load_dwordx4 v58, s[8:11], s40 offen offset:2080 nt lds
    buffer_load_dwordx4 v58, s[12:15], s40 offen offset:3104 nt lds
    s_add_u32 s40, s40, 2048
    s_add_u32 m0, s42, 12480
    s_nop 0
    buffer_load_dwordx4 v57, s[8:11], s40 offen nt lds
    buffer_load_dwordx4 v57, s[12:15], s40 offen offset:1024 nt lds
    buffer_load_dwordx4 v58, s[8:11], s40 offen offset:2080 nt lds
    buffer_load_dwordx4 v58, s[12:15], s40 offen offset:3104 nt lds
    s_add_u32 s40, s40, 2048
    s_waitcnt vmcnt(0)
    ds_read_b128 a[96:99], v46
    ds_read_b128 a[100:103], v46 offset:64
    ds_read_b128 a[104:107], v46 offset:128
    ds_read_b128 a[108:111], v46 offset:192
    ds_read_b128 a[112:115], v46 offset:512
    ds_read_b128 a[116:119], v46 offset:576
    ds_read_b128 a[120:123], v46 offset:640
    ds_read_b128 a[124:127], v46 offset:704
    s_waitcnt lgkmcnt(0)
    v_mfma_f32_16x16x32_bf16 v[16:19], a[96:99], a[0:3], 0
    v_mfma_f32_16x16x32_bf16 v[16:19], a[100:103], a[4:7], v[16:19]
    v_mfma_f32_16x16x32_bf16 v[16:19], a[104:107], a[8:11], v[16:19]
    v_mfma_f32_16x16x32_bf16 v[16:19], a[108:111], a[12:15], v[16:19]
    v_mfma_f32_16x16x32_bf16 v[20:23], a[112:115], a[0:3], 0
    v_mfma_f32_16x16x32_bf16 v[20:23], a[116:119], a[4:7], v[20:23]
    v_mfma_f32_16x16x32_bf16 v[20:23], a[120:123], a[8:11], v[20:23]
    v_mfma_f32_16x16x32_bf16 v[20:23], a[124:127], a[12:15], v[20:23]
    s_nop 7
    v_max3_f32 v40, v40, v16, v17
    v_max3_f32 v40, v40, v18, v19
    v_max3_f32 v40, v40, v20, v21
    v_max3_f32 v40, v40, v22, v23
    v_mfma_f32_16x16x32_bf16 v[16:19], a[96:99], a[16:19], 0
    v_mfma_f32_16x16x32_bf16 v[16:19], a[100:103], a[20:23], v[16:19]
    v_mfma_f32_16x16x32_bf16 v[16:19], a[104:107], a[24:27], v[16:19]
    v_mfma_f32_16x16x32_bf16 v[16:19], a[108:111], a[28:31], v[16:19]
    v_mfma_f32_16x16x32_bf16 v[20:23], a[112:115], a[16:19], 0
    v_mfma_f32_16x16x32_bf16 v[20:23], a[116:119], a[20:23], v[20:23]
    v_mfma_f32_16x16x32_bf16 v[20:23], a[120:123], a[24:27], v[20:23]
    v_mfma_f32_16x16x32_bf16 v[20:23], a[124:127], a[28:31], v[20:23]
    s_nop 7
    v_max3_f32 v41, v41, v16, v17
    v_max3_f32 v41, v41, v18, v19
    v_max3_f32 v41, v41, v20, v21
    v_max3_f32 v41, v41, v22, v23
    v_mfma_f32_16x16x32_bf16 v[16:19], a[96:99], a[32:35], 0
    v_mfma_f32_16x16x32_bf16 v[16:19], a[100:103], a[36:39], v[16:19]
    v_mfma_f32_16x16x32_bf16 v[16:19], a[104:107], a[40:43], v[16:19]
    v_mfma_f32_16x16x32_bf16 v[16:19], a[108:111], a[44:47], v[16:19]
    v_mfma_f32_16x16x32_bf16 v[20:23], a[112:115], a[32:35], 0
    v_mfma_f32_16x16x32_bf16 v[20:23], a[116:119], a[36:39], v[20:23]
    v_mfma_f32_16x16x32_bf16 v[20:23], a[120:123], a[40:43], v[20:23]
    v_mfma_f32_16x16x32_bf16 v[20:23], a[124:127], a[44:47], v[20:23]
    s_nop 7
    v_max3_f32 v42, v42, v16, v17
    v_max3_f32 v42, v42, v18, v19
    v_max3_f32 v42, v42, v20, v21
    v_max3_f32 v42, v42, v22, v23
    v_mfma_f32_16x16x32_bf16 v[16:19], a[96:99], a[48:51], 0
    v_mfma_f32_16x16x32_bf16 v[16:19], a[100:103], a[52:55], v[16:19]
    v_mfma_f32_16x16x32_bf16 v[16:19], a[104:107], a[56:59], v[16:19]
    v_mfma_f32_16x16x32_bf16 v[16:19], a[108:111], a[60:63], v[16:19]
    v_mfma_f32_16x16x32_bf16 v[20:23], a[112:115], a[48:51], 0
    v_mfma_f32_16x16x32_bf16 v[20:23], a[116:119], a[52:55], v[20:23]
    v_mfma_f32_16x16x32_bf16 v[20:23], a[120:123], a[56:59], v[20:23]
    v_mfma_f32_16x16x32_bf16 v[20:23], a[124:127], a[60:63], v[20:23]
    s_nop 7
    v_max3_f32 v43, v43, v16, v17
    v_max3_f32 v43, v43, v18, v19
    v_max3_f32 v43, v43, v20, v21
    v_max3_f32 v43, v43, v22, v23
    v_mfma_f32_16x16x32_bf16 v[16:19], a[96:99], a[64:67], 0
    v_mfma_f32_16x16x32_bf16 v[16:19], a[100:103], a[68:71], v[16:19]
    v_mfma_f32_16x16x32_bf16 v[16:19], a[104:107], a[72:75], v[16:19]
    v_mfma_f32_16x16x32_bf16 v[16:19], a[108:111], a[76:79], v[16:19]
    v_mfma_f32_16x16x32_bf16 v[20:23], a[112:115], a[64:67], 0
    v_mfma_f32_16x16x32_bf16 v[20:23], a[116:119], a[68:71], v[20:23]
    v_mfma_f32_16x16x32_bf16 v[20:23], a[120:123], a[72:75], v[20:23]
    v_mfma_f32_16x16x32_bf16 v[20:23], a[124:127], a[76:79], v[20:23]
    s_nop 7
    v_max3_f32 v44, v44, v16, v17
    v_max3_f32 v44, v44, v18, v19
    v_max3_f32 v44, v44, v20, v21
    v_max3_f32 v44, v44, v22, v23
    v_mfma_f32_16x16x32_bf16 v[16:19], a[96:99], a[80:83], 0
    v_mfma_f32_16x16x32_bf16 v[16:19], a[100:103], a[84:87], v[16:19]
    v_mfma_f32_16x16x32_bf16 v[16:19], a[104:107], a[88:91], v[16:19]
    v_mfma_f32_16x16x32_bf16 v[16:19], a[108:111], a[92:95], v[16:19]
    v_mfma_f32_16x16x32_bf16 v[20:23], a[112:115], a[80:83], 0
    v_mfma_f32_16x16x32_bf16 v[20:23], a[116:119], a[84:87], v[20:23]
    v_mfma_f32_16x16x32_bf16 v[20:23], a[120:123], a[88:91], v[20:23]
    v_mfma_f32_16x16x32_bf16 v[20:23], a[124:127], a[92:95], v[20:23]
    s_nop 7
    v_max3_f32 v45, v45, v16, v17
    v_max3_f32 v45, v45, v18, v19
    v_max3_f32 v45, v45, v20, v21
    v_max3_f32 v45, v45, v22, v23
    s_add_u32 s46, s46, 1
    s_cmp_lt_u32 s46, 12
    s_cbranch_scc1 Lslow1
    v_mov_b32 v2, v40
    s_nop 1
    v_permlane16_swap_b32 v40, v2
    v_max_f32 v40, v40, v2
    v_mov_b32 v2, v40
    s_nop 1
    v_permlane32_swap_b32 v40, v2
    v_max_f32 v40, v40, v2
    v_mov_b32 v2, v41
    s_nop 1
    v_permlane16_swap_b32 v41, v2
    v_max_f32 v41, v41, v2
    v_mov_b32 v2, v41
    s_nop 1
    v_permlane32_swap_b32 v41, v2
    v_max_f32 v41, v41, v2
    v_mov_b32 v2, v42
    s_nop 1
    v_permlane16_swap_b32 v42, v2
    v_max_f32 v42, v42, v2
    v_mov_b32 v2, v42
    s_nop 1
    v_permlane32_swap_b32 v42, v2
    v_max_f32 v42, v42, v2
    v_mov_b32 v2, v43
    s_nop 1
    v_permlane16_swap_b32 v43, v2
    v_max_f32 v43, v43, v2
    v_mov_b32 v2, v43
    s_nop 1
    v_permlane32_swap_b32 v43, v2
    v_max_f32 v43, v43, v2
    v_mov_b32 v2, v44
    s_nop 1
    v_permlane16_swap_b32 v44, v2
    v_max_f32 v44, v44, v2
    v_mov_b32 v2, v44
    s_nop 1
    v_permlane32_swap_b32 v44, v2
    v_max_f32 v44, v44, v2
    v_mov_b32 v2, v45
    s_nop 1
    v_permlane16_swap_b32 v45, v2
    v_max_f32 v45, v45, v2
    v_mov_b32 v2, v45
    s_nop 1
    v_permlane32_swap_b32 v45, v2
    v_max_f32 v45, v45, v2
    v_mov_b32 v64, 0
    v_mov_b32 v65, 0
    v_mov_b32 v66, 0
    v_mov_b32 v67, 0
    v_mov_b32 v68, 0
    v_mov_b32 v69, 0
    v_mov_b32 v70, 0
    v_mov_b32 v71, 0
    v_mov_b32 v72, 0
    v_mov_b32 v73, 0
    v_mov_b32 v74, 0
    v_mov_b32 v75, 0
    v_mov_b32 v76, 0
    v_mov_b32 v77, 0
    v_mov_b32 v78, 0
    v_mov_b32 v79, 0
    v_mov_b32 v80, 0
    v_mov_b32 v81, 0
    v_mov_b32 v82, 0
    v_mov_b32 v83, 0
    v_mov_b32 v84, 0
    v_mov_b32 v85, 0
    v_mov_b32 v86, 0
    v_mov_b32 v87, 0
    v_mov_b32 v88, 0
    v_mov_b32 v89, 0
    v_mov_b32 v90, 0
    v_mov_b32 v91, 0
    v_mov_b32 v92, 0
    v_mov_b32 v93, 0
    v_mov_b32 v94, 0
    v_mov_b32 v95, 0
    v_mov_b32 v96, 0
    v_mov_b32 v97, 0
    v_mov_b32 v98, 0
    v_mov_b32 v99, 0
    v_mov_b32 v100, 0
    v_mov_b32 v101, 0
    v_mov_b32 v102, 0
    v_mov_b32 v103, 0
    v_mov_b32 v104, 0
    v_mov_b32 v105, 0
    v_mov_b32 v106, 0
    v_mov_b32 v107, 0
    v_mov_b32 v108, 0
    v_mov_b32 v109, 0
    v_mov_b32 v110, 0
    v_mov_b32 v111, 0
    v_mov_b32 v112, 0
    v_mov_b32 v113, 0
    v_mov_b32 v114, 0
    v_mov_b32 v115, 0
    v_mov_b32 v116, 0
    v_mov_b32 v117, 0
    v_mov_b32 v118, 0
    v_mov_b32 v119, 0
    v_mov_b32 v120, 0
    v_mov_b32 v121, 0
    v_mov_b32 v122, 0
    v_mov_b32 v123, 0
    v_mov_b32 v124, 0
    v_mov_b32 v125, 0
    v_mov_b32 v126, 0
    v_mov_b32 v127, 0
    v_mov_b32 v128, 0
    v_mov_b32 v129, 0
    v_mov_b32 v130, 0
    v_mov_b32 v131, 0
    v_mov_b32 v132, 0
    v_mov_b32 v133, 0
    v_mov_b32 v134, 0
    v_mov_b32 v135, 0
    v_mov_b32 v136, 0
    v_mov_b32 v137, 0
    v_mov_b32 v138, 0
    v_mov_b32 v139, 0
    v_mov_b32 v140, 0
    v_mov_b32 v141, 0
    v_mov_b32 v142, 0
    v_mov_b32 v143, 0
    v_mov_b32 v144, 0
    v_mov_b32 v145, 0
    v_mov_b32 v146, 0
    v_mov_b32 v147, 0
    v_mov_b32 v148, 0
    v_mov_b32 v149, 0
    v_mov_b32 v150, 0
    v_mov_b32 v151, 0
    v_mov_b32 v152, 0
    v_mov_b32 v153, 0
    v_mov_b32 v154, 0
    v_mov_b32 v155, 0
    v_mov_b32 v156, 0
    v_mov_b32 v157, 0
    v_mov_b32 v158, 0
    v_mov_b32 v159, 0
    v_mov_b32 v160, 0
    v_mov_b32 v161, 0
    v_mov_b32 v162, 0
    v_mov_b32 v163, 0
    v_mov_b32 v164, 0
    v_mov_b32 v165, 0
    v_mov_b32 v166, 0
    v_mov_b32 v167, 0
    v_mov_b32 v168, 0
    v_mov_b32 v169, 0
    v_mov_b32 v170, 0
    v_mov_b32 v171, 0
    v_mov_b32 v172, 0
    v_mov_b32 v173, 0
    v_mov_b32 v174, 0
    v_mov_b32 v175, 0
    v_mov_b32 v176, 0
    v_mov_b32 v177, 0
    v_mov_b32 v178, 0
    v_mov_b32 v179, 0
    v_mov_b32 v180, 0
    v_mov_b32 v181, 0
    v_mov_b32 v182, 0
    v_mov_b32 v183, 0
    v_mov_b32 v184, 0
    v_mov_b32 v185, 0
    v_mov_b32 v186, 0
    v_mov_b32 v187, 0
    v_mov_b32 v188, 0
    v_mov_b32 v189, 0
    v_mov_b32 v190, 0
    v_mov_b32 v191, 0
    v_mov_b32 v192, 0
    v_mov_b32 v193, 0
    v_mov_b32 v194, 0
    v_mov_b32 v195, 0
    v_mov_b32 v196, 0
    v_mov_b32 v197, 0
    v_mov_b32 v198, 0
    v_mov_b32 v199, 0
    v_mov_b32 v200, 0
    v_mov_b32 v201, 0
    v_mov_b32 v202, 0
    v_mov_b32 v203, 0
    v_mov_b32 v204, 0
    v_mov_b32 v205, 0
    v_mov_b32 v206, 0
    v_mov_b32 v207, 0
    v_mov_b32 v208, 0
    v_mov_b32 v209, 0
    v_mov_b32 v210, 0
    v_mov_b32 v211, 0
    v_mov_b32 v212, 0
    v_mov_b32 v213, 0
    v_mov_b32 v214, 0
    v_mov_b32 v215, 0
    v_mov_b32 v216, 0
    v_mov_b32 v217, 0
    v_mov_b32 v218, 0
    v_mov_b32 v219, 0
    v_mov_b32 v220, 0
    v_mov_b32 v221, 0
    v_mov_b32 v222, 0
    v_mov_b32 v223, 0
    v_mov_b32 v224, 0
    v_mov_b32 v225, 0
    v_mov_b32 v226, 0
    v_mov_b32 v227, 0
    v_mov_b32 v228, 0
    v_mov_b32 v229, 0
    v_mov_b32 v230, 0
    v_mov_b32 v231, 0
    v_mov_b32 v232, 0
    v_mov_b32 v233, 0
    v_mov_b32 v234, 0
    v_mov_b32 v235, 0
    v_mov_b32 v236, 0
    v_mov_b32 v237, 0
    v_mov_b32 v238, 0
    v_mov_b32 v239, 0
    v_mov_b32 v240, 0
    v_mov_b32 v241, 0
    v_mov_b32 v242, 0
    v_mov_b32 v243, 0
    v_mov_b32 v244, 0
    v_mov_b32 v245, 0
    v_mov_b32 v246, 0
    v_mov_b32 v247, 0
    v_mov_b32 v248, 0
    v_mov_b32 v249, 0
    v_mov_b32 v250, 0
    v_mov_b32 v251, 0
    v_mov_b32 v252, 0
    v_mov_b32 v253, 0
    v_mov_b32 v254, 0
    v_mov_b32 v255, 0
    v_accvgpr_write_b32 a224, 0
    v_accvgpr_write_b32 a225, 0
    v_accvgpr_write_b32 a226, 0
    v_accvgpr_write_b32 a227, 0
    v_accvgpr_write_b32 a228, 0
    v_accvgpr_write_b32 a229, 0
    v_accvgpr_write_b32 a230, 0
    v_accvgpr_write_b32 a231, 0
    v_accvgpr_write_b32 a232, 0
    v_accvgpr_write_b32 a233, 0
    v_accvgpr_write_b32 a234, 0
    v_accvgpr_write_b32 a235, 0
    v_accvgpr_write_b32 a236, 0
    v_accvgpr_write_b32 a237, 0
    v_accvgpr_write_b32 a238, 0
    v_accvgpr_write_b32 a239, 0
    v_accvgpr_write_b32 a240, 0
    v_accvgpr_write_b32 a241, 0
    v_accvgpr_write_b32 a242, 0
    v_accvgpr_write_b32 a243, 0
    v_accvgpr_write_b32 a244, 0
    v_accvgpr_write_b32 a245, 0
    v_accvgpr_write_b32 a246, 0
    v_accvgpr_write_b32 a247, 0
    s_mov_b32 s40, s44
    s_mov_b32 s46, 0
Lslow2:
    s_add_u32 m0, s42, 0
    s_nop 0
    buffer_load_dwordx4 v57, s[8:11], s40 offen nt lds
    buffer_load_dwordx4 v57, s[12:15], s40 offen offset:1024 nt lds
    buffer_load_dwordx4 v58, s[8:11], s40 offen offset:2080 nt lds
    buffer_load_dwordx4 v58, s[12:15], s40 offen offset:3104 nt lds
    s_add_u32 s40, s40, 2048
    s_add_u32 m0, s42, 4160
    s_nop 0
    buffer_load_dwordx4 v57, s[8:11], s40 offen nt lds
    buffer_load_dwordx4 v57, s[12:15], s40 offen offset:1024 nt lds
    buffer_load_dwordx4 v58, s[8:11], s40 offen offset:2080 nt lds
    buffer_load_dwordx4 v58, s[12:15], s40 offen offset:3104 nt lds
    s_add_u32 s40, s40, 2048
    s_add_u32 m0, s42, 8320
    s_nop 0
    buffer_load_dwordx4 v57, s[8:11], s40 offen nt lds
    buffer_load_dwordx4 v57, s[12:15], s40 offen offset:1024 nt lds
    buffer_load_dwordx4 v58, s[8:11], s40 offen offset:2080 nt lds
    buffer_load_dwordx4 v58, s[12:15], s40 offen offset:3104 nt lds
    s_add_u32 s40, s40, 2048
    s_add_u32 m0, s42, 12480
    s_nop 0
    buffer_load_dwordx4 v57, s[8:11], s40 offen nt lds
    buffer_load_dwordx4 v57, s[12:15], s40 offen offset:1024 nt lds
    buffer_load_dwordx4 v58, s[8:11], s40 offen offset:2080 nt lds
    buffer_load_dwordx4 v58, s[12:15], s40 offen offset:3104 nt lds
    s_add_u32 s40, s40, 2048
    s_waitcnt vmcnt(0)
    ds_read_b128 a[96:99], v46
    ds_read_b128 a[100:103], v46 offset:64
    ds_read_b128 a[104:107], v46 offset:128
    ds_read_b128 a[108:111], v46 offset:192
    ds_read_b128 a[112:115], v46 offset:512
    ds_read_b128 a[116:119], v46 offset:576
    ds_read_b128 a[120:123], v46 offset:640
    ds_read_b128 a[124:127], v46 offset:704
    s_waitcnt lgkmcnt(0)
    ds_read_b64_tr_b16 a[160:161], v47
    ds_read_b64_tr_b16 a[162:163], v47 offset:512
    ds_read_b64_tr_b16 a[164:165], v47 offset:32
    ds_read_b64_tr_b16 a[166:167], v47 offset:544
    ds_read_b64_tr_b16 a[168:169], v47 offset:64
    ds_read_b64_tr_b16 a[170:171], v47 offset:576
    ds_read_b64_tr_b16 a[172:173], v47 offset:96
    ds_read_b64_tr_b16 a[174:175], v47 offset:608
    s_waitcnt lgkmcnt(0)
    ds_read_b64_tr_b16 a[176:177], v47 offset:128
    ds_read_b64_tr_b16 a[178:179], v47 offset:640
    ds_read_b64_tr_b16 a[180:181], v47 offset:160
    ds_read_b64_tr_b16 a[182:183], v47 offset:672
    ds_read_b64_tr_b16 a[184:185], v47 offset:192
    ds_read_b64_tr_b16 a[186:187], v47 offset:704
    ds_read_b64_tr_b16 a[188:189], v47 offset:224
    ds_read_b64_tr_b16 a[190:191], v47 offset:736
    s_waitcnt lgkmcnt(0)
    v_mfma_f32_16x16x32_bf16 v[16:19], a[96:99], a[0:3], 0
    v_mfma_f32_16x16x32_bf16 v[16:19], a[100:103], a[4:7], v[16:19]
    v_mfma_f32_16x16x32_bf16 v[16:19], a[104:107], a[8:11], v[16:19]
    v_mfma_f32_16x16x32_bf16 v[16:19], a[108:111], a[12:15], v[16:19]
    v_mfma_f32_16x16x32_bf16 v[20:23], a[112:115], a[0:3], 0
    v_mfma_f32_16x16x32_bf16 v[20:23], a[116:119], a[4:7], v[20:23]
    v_mfma_f32_16x16x32_bf16 v[20:23], a[120:123], a[8:11], v[20:23]
    v_mfma_f32_16x16x32_bf16 v[20:23], a[124:127], a[12:15], v[20:23]
    s_nop 7
    v_sub_f32 v16, v16, v40
    v_sub_f32 v17, v17, v40
    v_sub_f32 v18, v18, v40
    v_sub_f32 v19, v19, v40
    v_sub_f32 v20, v20, v40
    v_sub_f32 v21, v21, v40
    v_sub_f32 v22, v22, v40
    v_sub_f32 v23, v23, v40
    v_mul_f32 v16, s43, v16
    v_mul_f32 v17, s43, v17
    v_mul_f32 v18, s43, v18
    v_mul_f32 v19, s43, v19
    v_mul_f32 v20, s43, v20
    v_mul_f32 v21, s43, v21
    v_mul_f32 v22, s43, v22
    v_mul_f32 v23, s43, v23
    v_exp_f32 v16, v16
    v_exp_f32 v17, v17
    v_exp_f32 v18, v18
    v_exp_f32 v19, v19
    v_exp_f32 v20, v20
    v_exp_f32 v21, v21
    v_exp_f32 v22, v22
    v_exp_f32 v23, v23
    v_cvt_pk_bf16_f32 v32, v16, v17
    v_cvt_pk_bf16_f32 v33, v18, v19
    v_cvt_pk_bf16_f32 v34, v20, v21
    v_cvt_pk_bf16_f32 v35, v22, v23
    s_nop 1
    v_mfma_f32_16x16x32_bf16 v[64:67], a[160:163], v[32:35], v[64:67]
    v_mfma_f32_16x16x32_bf16 v[68:71], a[164:167], v[32:35], v[68:71]
    v_mfma_f32_16x16x32_bf16 v[72:75], a[168:171], v[32:35], v[72:75]
    v_mfma_f32_16x16x32_bf16 v[76:79], a[172:175], v[32:35], v[76:79]
    v_mfma_f32_16x16x32_bf16 v[80:83], a[176:179], v[32:35], v[80:83]
    v_mfma_f32_16x16x32_bf16 v[84:87], a[180:183], v[32:35], v[84:87]
    v_mfma_f32_16x16x32_bf16 v[88:91], a[184:187], v[32:35], v[88:91]
    v_mfma_f32_16x16x32_bf16 v[92:95], a[188:191], v[32:35], v[92:95]
    v_mfma_f32_16x16x32_bf16 a[224:227], a[248:251], v[32:35], a[224:227]
    v_mfma_f32_16x16x32_bf16 v[16:19], a[96:99], a[16:19], 0
    v_mfma_f32_16x16x32_bf16 v[16:19], a[100:103], a[20:23], v[16:19]
    v_mfma_f32_16x16x32_bf16 v[16:19], a[104:107], a[24:27], v[16:19]
    v_mfma_f32_16x16x32_bf16 v[16:19], a[108:111], a[28:31], v[16:19]
    v_mfma_f32_16x16x32_bf16 v[20:23], a[112:115], a[16:19], 0
    v_mfma_f32_16x16x32_bf16 v[20:23], a[116:119], a[20:23], v[20:23]
    v_mfma_f32_16x16x32_bf16 v[20:23], a[120:123], a[24:27], v[20:23]
    v_mfma_f32_16x16x32_bf16 v[20:23], a[124:127], a[28:31], v[20:23]
    s_nop 7
    v_sub_f32 v16, v16, v41
    v_sub_f32 v17, v17, v41
    v_sub_f32 v18, v18, v41
    v_sub_f32 v19, v19, v41
    v_sub_f32 v20, v20, v41
    v_sub_f32 v21, v21, v41
    v_sub_f32 v22, v22, v41
    v_sub_f32 v23, v23, v41
    v_mul_f32 v16, s43, v16
    v_mul_f32 v17, s43, v17
    v_mul_f32 v18, s43, v18
    v_mul_f32 v19, s43, v19
    v_mul_f32 v20, s43, v20
    v_mul_f32 v21, s43, v21
    v_mul_f32 v22, s43, v22
    v_mul_f32 v23, s43, v23
    v_exp_f32 v16, v16
    v_exp_f32 v17, v17
    v_exp_f32 v18, v18
    v_exp_f32 v19, v19
    v_exp_f32 v20, v20
    v_exp_f32 v21, v21
    v_exp_f32 v22, v22
    v_exp_f32 v23, v23
    v_cvt_pk_bf16_f32 v32, v16, v17
    v_cvt_pk_bf16_f32 v33, v18, v19
    v_cvt_pk_bf16_f32 v34, v20, v21
    v_cvt_pk_bf16_f32 v35, v22, v23
    s_nop 1
    v_mfma_f32_16x16x32_bf16 v[96:99], a[160:163], v[32:35], v[96:99]
    v_mfma_f32_16x16x32_bf16 v[100:103], a[164:167], v[32:35], v[100:103]
    v_mfma_f32_16x16x32_bf16 v[104:107], a[168:171], v[32:35], v[104:107]
    v_mfma_f32_16x16x32_bf16 v[108:111], a[172:175], v[32:35], v[108:111]
    v_mfma_f32_16x16x32_bf16 v[112:115], a[176:179], v[32:35], v[112:115]
    v_mfma_f32_16x16x32_bf16 v[116:119], a[180:183], v[32:35], v[116:119]
    v_mfma_f32_16x16x32_bf16 v[120:123], a[184:187], v[32:35], v[120:123]
    v_mfma_f32_16x16x32_bf16 v[124:127], a[188:191], v[32:35], v[124:127]
    v_mfma_f32_16x16x32_bf16 a[228:231], a[248:251], v[32:35], a[228:231]
    v_mfma_f32_16x16x32_bf16 v[16:19], a[96:99], a[32:35], 0
    v_mfma_f32_16x16x32_bf16 v[16:19], a[100:103], a[36:39], v[16:19]
    v_mfma_f32_16x16x32_bf16 v[16:19], a[104:107], a[40:43], v[16:19]
    v_mfma_f32_16x16x32_bf16 v[16:19], a[108:111], a[44:47], v[16:19]
    v_mfma_f32_16x16x32_bf16 v[20:23], a[112:115], a[32:35], 0
    v_mfma_f32_16x16x32_bf16 v[20:23], a[116:119], a[36:39], v[20:23]
    v_mfma_f32_16x16x32_bf16 v[20:23], a[120:123], a[40:43], v[20:23]
    v_mfma_f32_16x16x32_bf16 v[20:23], a[124:127], a[44:47], v[20:23]
    s_nop 7
    v_sub_f32 v16, v16, v42
    v_sub_f32 v17, v17, v42
    v_sub_f32 v18, v18, v42
    v_sub_f32 v19, v19, v42
    v_sub_f32 v20, v20, v42
    v_sub_f32 v21, v21, v42
    v_sub_f32 v22, v22, v42
    v_sub_f32 v23, v23, v42
    v_mul_f32 v16, s43, v16
    v_mul_f32 v17, s43, v17
    v_mul_f32 v18, s43, v18
    v_mul_f32 v19, s43, v19
    v_mul_f32 v20, s43, v20
    v_mul_f32 v21, s43, v21
    v_mul_f32 v22, s43, v22
    v_mul_f32 v23, s43, v23
    v_exp_f32 v16, v16
    v_exp_f32 v17, v17
    v_exp_f32 v18, v18
    v_exp_f32 v19, v19
    v_exp_f32 v20, v20
    v_exp_f32 v21, v21
    v_exp_f32 v22, v22
    v_exp_f32 v23, v23
    v_cvt_pk_bf16_f32 v32, v16, v17
    v_cvt_pk_bf16_f32 v33, v18, v19
    v_cvt_pk_bf16_f32 v34, v20, v21
    v_cvt_pk_bf16_f32 v35, v22, v23
    s_nop 1
    v_mfma_f32_16x16x32_bf16 v[128:131], a[160:163], v[32:35], v[128:131]
    v_mfma_f32_16x16x32_bf16 v[132:135], a[164:167], v[32:35], v[132:135]
    v_mfma_f32_16x16x32_bf16 v[136:139], a[168:171], v[32:35], v[136:139]
    v_mfma_f32_16x16x32_bf16 v[140:143], a[172:175], v[32:35], v[140:143]
    v_mfma_f32_16x16x32_bf16 v[144:147], a[176:179], v[32:35], v[144:147]
    v_mfma_f32_16x16x32_bf16 v[148:151], a[180:183], v[32:35], v[148:151]
    v_mfma_f32_16x16x32_bf16 v[152:155], a[184:187], v[32:35], v[152:155]
    v_mfma_f32_16x16x32_bf16 v[156:159], a[188:191], v[32:35], v[156:159]
    v_mfma_f32_16x16x32_bf16 a[232:235], a[248:251], v[32:35], a[232:235]
    v_mfma_f32_16x16x32_bf16 v[16:19], a[96:99], a[48:51], 0
    v_mfma_f32_16x16x32_bf16 v[16:19], a[100:103], a[52:55], v[16:19]
    v_mfma_f32_16x16x32_bf16 v[16:19], a[104:107], a[56:59], v[16:19]
    v_mfma_f32_16x16x32_bf16 v[16:19], a[108:111], a[60:63], v[16:19]
    v_mfma_f32_16x16x32_bf16 v[20:23], a[112:115], a[48:51], 0
    v_mfma_f32_16x16x32_bf16 v[20:23], a[116:119], a[52:55], v[20:23]
    v_mfma_f32_16x16x32_bf16 v[20:23], a[120:123], a[56:59], v[20:23]
    v_mfma_f32_16x16x32_bf16 v[20:23], a[124:127], a[60:63], v[20:23]
    s_nop 7
    v_sub_f32 v16, v16, v43
    v_sub_f32 v17, v17, v43
    v_sub_f32 v18, v18, v43
    v_sub_f32 v19, v19, v43
    v_sub_f32 v20, v20, v43
    v_sub_f32 v21, v21, v43
    v_sub_f32 v22, v22, v43
    v_sub_f32 v23, v23, v43
    v_mul_f32 v16, s43, v16
    v_mul_f32 v17, s43, v17
    v_mul_f32 v18, s43, v18
    v_mul_f32 v19, s43, v19
    v_mul_f32 v20, s43, v20
    v_mul_f32 v21, s43, v21
    v_mul_f32 v22, s43, v22
    v_mul_f32 v23, s43, v23
    v_exp_f32 v16, v16
    v_exp_f32 v17, v17
    v_exp_f32 v18, v18
    v_exp_f32 v19, v19
    v_exp_f32 v20, v20
    v_exp_f32 v21, v21
    v_exp_f32 v22, v22
    v_exp_f32 v23, v23
    v_cvt_pk_bf16_f32 v32, v16, v17
    v_cvt_pk_bf16_f32 v33, v18, v19
    v_cvt_pk_bf16_f32 v34, v20, v21
    v_cvt_pk_bf16_f32 v35, v22, v23
    s_nop 1
    v_mfma_f32_16x16x32_bf16 v[160:163], a[160:163], v[32:35], v[160:163]
    v_mfma_f32_16x16x32_bf16 v[164:167], a[164:167], v[32:35], v[164:167]
    v_mfma_f32_16x16x32_bf16 v[168:171], a[168:171], v[32:35], v[168:171]
    v_mfma_f32_16x16x32_bf16 v[172:175], a[172:175], v[32:35], v[172:175]
    v_mfma_f32_16x16x32_bf16 v[176:179], a[176:179], v[32:35], v[176:179]
    v_mfma_f32_16x16x32_bf16 v[180:183], a[180:183], v[32:35], v[180:183]
    v_mfma_f32_16x16x32_bf16 v[184:187], a[184:187], v[32:35], v[184:187]
    v_mfma_f32_16x16x32_bf16 v[188:191], a[188:191], v[32:35], v[188:191]
    v_mfma_f32_16x16x32_bf16 a[236:239], a[248:251], v[32:35], a[236:239]
    v_mfma_f32_16x16x32_bf16 v[16:19], a[96:99], a[64:67], 0
    v_mfma_f32_16x16x32_bf16 v[16:19], a[100:103], a[68:71], v[16:19]
    v_mfma_f32_16x16x32_bf16 v[16:19], a[104:107], a[72:75], v[16:19]
    v_mfma_f32_16x16x32_bf16 v[16:19], a[108:111], a[76:79], v[16:19]
    v_mfma_f32_16x16x32_bf16 v[20:23], a[112:115], a[64:67], 0
    v_mfma_f32_16x16x32_bf16 v[20:23], a[116:119], a[68:71], v[20:23]
    v_mfma_f32_16x16x32_bf16 v[20:23], a[120:123], a[72:75], v[20:23]
    v_mfma_f32_16x16x32_bf16 v[20:23], a[124:127], a[76:79], v[20:23]
    s_nop 7
    v_sub_f32 v16, v16, v44
    v_sub_f32 v17, v17, v44
    v_sub_f32 v18, v18, v44
    v_sub_f32 v19, v19, v44
    v_sub_f32 v20, v20, v44
    v_sub_f32 v21, v21, v44
    v_sub_f32 v22, v22, v44
    v_sub_f32 v23, v23, v44
    v_mul_f32 v16, s43, v16
    v_mul_f32 v17, s43, v17
    v_mul_f32 v18, s43, v18
    v_mul_f32 v19, s43, v19
    v_mul_f32 v20, s43, v20
    v_mul_f32 v21, s43, v21
    v_mul_f32 v22, s43, v22
    v_mul_f32 v23, s43, v23
    v_exp_f32 v16, v16
    v_exp_f32 v17, v17
    v_exp_f32 v18, v18
    v_exp_f32 v19, v19
    v_exp_f32 v20, v20
    v_exp_f32 v21, v21
    v_exp_f32 v22, v22
    v_exp_f32 v23, v23
    v_cvt_pk_bf16_f32 v32, v16, v17
    v_cvt_pk_bf16_f32 v33, v18, v19
    v_cvt_pk_bf16_f32 v34, v20, v21
    v_cvt_pk_bf16_f32 v35, v22, v23
    s_nop 1
    v_mfma_f32_16x16x32_bf16 v[192:195], a[160:163], v[32:35], v[192:195]
    v_mfma_f32_16x16x32_bf16 v[196:199], a[164:167], v[32:35], v[196:199]
    v_mfma_f32_16x16x32_bf16 v[200:203], a[168:171], v[32:35], v[200:203]
    v_mfma_f32_16x16x32_bf16 v[204:207], a[172:175], v[32:35], v[204:207]
    v_mfma_f32_16x16x32_bf16 v[208:211], a[176:179], v[32:35], v[208:211]
    v_mfma_f32_16x16x32_bf16 v[212:215], a[180:183], v[32:35], v[212:215]
    v_mfma_f32_16x16x32_bf16 v[216:219], a[184:187], v[32:35], v[216:219]
    v_mfma_f32_16x16x32_bf16 v[220:223], a[188:191], v[32:35], v[220:223]
    v_mfma_f32_16x16x32_bf16 a[240:243], a[248:251], v[32:35], a[240:243]
    v_mfma_f32_16x16x32_bf16 v[16:19], a[96:99], a[80:83], 0
    v_mfma_f32_16x16x32_bf16 v[16:19], a[100:103], a[84:87], v[16:19]
    v_mfma_f32_16x16x32_bf16 v[16:19], a[104:107], a[88:91], v[16:19]
    v_mfma_f32_16x16x32_bf16 v[16:19], a[108:111], a[92:95], v[16:19]
    v_mfma_f32_16x16x32_bf16 v[20:23], a[112:115], a[80:83], 0
    v_mfma_f32_16x16x32_bf16 v[20:23], a[116:119], a[84:87], v[20:23]
    v_mfma_f32_16x16x32_bf16 v[20:23], a[120:123], a[88:91], v[20:23]
    v_mfma_f32_16x16x32_bf16 v[20:23], a[124:127], a[92:95], v[20:23]
    s_nop 7
    v_sub_f32 v16, v16, v45
    v_sub_f32 v17, v17, v45
    v_sub_f32 v18, v18, v45
    v_sub_f32 v19, v19, v45
    v_sub_f32 v20, v20, v45
    v_sub_f32 v21, v21, v45
    v_sub_f32 v22, v22, v45
    v_sub_f32 v23, v23, v45
    v_mul_f32 v16, s43, v16
    v_mul_f32 v17, s43, v17
    v_mul_f32 v18, s43, v18
    v_mul_f32 v19, s43, v19
    v_mul_f32 v20, s43, v20
    v_mul_f32 v21, s43, v21
    v_mul_f32 v22, s43, v22
    v_mul_f32 v23, s43, v23
    v_exp_f32 v16, v16
    v_exp_f32 v17, v17
    v_exp_f32 v18, v18
    v_exp_f32 v19, v19
    v_exp_f32 v20, v20
    v_exp_f32 v21, v21
    v_exp_f32 v22, v22
    v_exp_f32 v23, v23
    v_cvt_pk_bf16_f32 v32, v16, v17
    v_cvt_pk_bf16_f32 v33, v18, v19
    v_cvt_pk_bf16_f32 v34, v20, v21
    v_cvt_pk_bf16_f32 v35, v22, v23
    s_nop 1
    v_mfma_f32_16x16x32_bf16 v[224:227], a[160:163], v[32:35], v[224:227]
    v_mfma_f32_16x16x32_bf16 v[228:231], a[164:167], v[32:35], v[228:231]
    v_mfma_f32_16x16x32_bf16 v[232:235], a[168:171], v[32:35], v[232:235]
    v_mfma_f32_16x16x32_bf16 v[236:239], a[172:175], v[32:35], v[236:239]
    v_mfma_f32_16x16x32_bf16 v[240:243], a[176:179], v[32:35], v[240:243]
    v_mfma_f32_16x16x32_bf16 v[244:247], a[180:183], v[32:35], v[244:247]
    v_mfma_f32_16x16x32_bf16 v[248:251], a[184:187], v[32:35], v[248:251]
    v_mfma_f32_16x16x32_bf16 v[252:255], a[188:191], v[32:35], v[252:255]
    v_mfma_f32_16x16x32_bf16 a[244:247], a[248:251], v[32:35], a[244:247]
    s_add_u32 s46, s46, 1
    s_cmp_lt_u32 s46, 12
    s_cbranch_scc1 Lslow2
    s_nop 7
    s_add_u32 s57, s44, s50
    v_accvgpr_read_b32 v3, a224
    v_rcp_f32 v2, v3
    s_nop 0
    v_pk_mul_f32 v[64:65], v[64:65], v[2:3] op_sel_hi:[1,0]
    v_pk_mul_f32 v[66:67], v[66:67], v[2:3] op_sel_hi:[1,0]
    v_pk_mul_f32 v[68:69], v[68:69], v[2:3] op_sel_hi:[1,0]
    v_pk_mul_f32 v[70:71], v[70:71], v[2:3] op_sel_hi:[1,0]
    v_pk_mul_f32 v[72:73], v[72:73], v[2:3] op_sel_hi:[1,0]
    v_pk_mul_f32 v[74:75], v[74:75], v[2:3] op_sel_hi:[1,0]
    v_pk_mul_f32 v[76:77], v[76:77], v[2:3] op_sel_hi:[1,0]
    v_pk_mul_f32 v[78:79], v[78:79], v[2:3] op_sel_hi:[1,0]
    v_pk_mul_f32 v[80:81], v[80:81], v[2:3] op_sel_hi:[1,0]
    v_pk_mul_f32 v[82:83], v[82:83], v[2:3] op_sel_hi:[1,0]
    v_pk_mul_f32 v[84:85], v[84:85], v[2:3] op_sel_hi:[1,0]
    v_pk_mul_f32 v[86:87], v[86:87], v[2:3] op_sel_hi:[1,0]
    v_pk_mul_f32 v[88:89], v[88:89], v[2:3] op_sel_hi:[1,0]
    v_pk_mul_f32 v[90:91], v[90:91], v[2:3] op_sel_hi:[1,0]
    v_pk_mul_f32 v[92:93], v[92:93], v[2:3] op_sel_hi:[1,0]
    v_pk_mul_f32 v[94:95], v[94:95], v[2:3] op_sel_hi:[1,0]
    v_cvt_pk_bf16_f32 v64, v64, v65
    v_cvt_pk_bf16_f32 v65, v66, v67
    v_cvt_pk_bf16_f32 v68, v68, v69
    v_cvt_pk_bf16_f32 v69, v70, v71
    v_cvt_pk_bf16_f32 v72, v72, v73
    v_cvt_pk_bf16_f32 v73, v74, v75
    v_cvt_pk_bf16_f32 v76, v76, v77
    v_cvt_pk_bf16_f32 v77, v78, v79
    v_cvt_pk_bf16_f32 v80, v80, v81
    v_cvt_pk_bf16_f32 v81, v82, v83
    v_cvt_pk_bf16_f32 v84, v84, v85
    v_cvt_pk_bf16_f32 v85, v86, v87
    v_cvt_pk_bf16_f32 v88, v88, v89
    v_cvt_pk_bf16_f32 v89, v90, v91
    v_cvt_pk_bf16_f32 v92, v92, v93
    v_cvt_pk_bf16_f32 v93, v94, v95
    ds_write_b64 v5, v[64:65]
    ds_write_b64 v6, v[68:69]
    ds_write_b64 v7, v[72:73]
    ds_write_b64 v62, v[76:77]
    ds_write_b64 v5, v[80:81] offset:128
    ds_write_b64 v6, v[84:85] offset:128
    ds_write_b64 v7, v[88:89] offset:128
    ds_write_b64 v62, v[92:93] offset:128
    ds_read_b128 v[64:67], v56
    ds_read_b128 v[72:75], v63 offset:1024
    ds_read_b128 v[80:83], v56 offset:2048
    ds_read_b128 v[88:91], v63 offset:3072
    s_waitcnt lgkmcnt(0)
    buffer_store_dwordx4 v[64:67], v58, s[24:27], s57 offen
    buffer_store_dwordx4 v[72:75], v58, s[24:27], s57 offen offset:1024
    buffer_store_dwordx4 v[80:83], v58, s[24:27], s57 offen offset:2048
    buffer_store_dwordx4 v[88:91], v58, s[24:27], s57 offen offset:3072
    s_add_u32 s57, s57, 4096
    v_accvgpr_read_b32 v3, a228
    v_rcp_f32 v2, v3
    s_nop 0
    v_pk_mul_f32 v[96:97], v[96:97], v[2:3] op_sel_hi:[1,0]
    v_pk_mul_f32 v[98:99], v[98:99], v[2:3] op_sel_hi:[1,0]
    v_pk_mul_f32 v[100:101], v[100:101], v[2:3] op_sel_hi:[1,0]
    v_pk_mul_f32 v[102:103], v[102:103], v[2:3] op_sel_hi:[1,0]
    v_pk_mul_f32 v[104:105], v[104:105], v[2:3] op_sel_hi:[1,0]
    v_pk_mul_f32 v[106:107], v[106:107], v[2:3] op_sel_hi:[1,0]
    v_pk_mul_f32 v[108:109], v[108:109], v[2:3] op_sel_hi:[1,0]
    v_pk_mul_f32 v[110:111], v[110:111], v[2:3] op_sel_hi:[1,0]
    v_pk_mul_f32 v[112:113], v[112:113], v[2:3] op_sel_hi:[1,0]
    v_pk_mul_f32 v[114:115], v[114:115], v[2:3] op_sel_hi:[1,0]
    v_pk_mul_f32 v[116:117], v[116:117], v[2:3] op_sel_hi:[1,0]
    v_pk_mul_f32 v[118:119], v[118:119], v[2:3] op_sel_hi:[1,0]
    v_pk_mul_f32 v[120:121], v[120:121], v[2:3] op_sel_hi:[1,0]
    v_pk_mul_f32 v[122:123], v[122:123], v[2:3] op_sel_hi:[1,0]
    v_pk_mul_f32 v[124:125], v[124:125], v[2:3] op_sel_hi:[1,0]
    v_pk_mul_f32 v[126:127], v[126:127], v[2:3] op_sel_hi:[1,0]
    v_cvt_pk_bf16_f32 v96, v96, v97
    v_cvt_pk_bf16_f32 v97, v98, v99
    v_cvt_pk_bf16_f32 v100, v100, v101
    v_cvt_pk_bf16_f32 v101, v102, v103
    v_cvt_pk_bf16_f32 v104, v104, v105
    v_cvt_pk_bf16_f32 v105, v106, v107
    v_cvt_pk_bf16_f32 v108, v108, v109
    v_cvt_pk_bf16_f32 v109, v110, v111
    v_cvt_pk_bf16_f32 v112, v112, v113
    v_cvt_pk_bf16_f32 v113, v114, v115
    v_cvt_pk_bf16_f32 v116, v116, v117
    v_cvt_pk_bf16_f32 v117, v118, v119
    v_cvt_pk_bf16_f32 v120, v120, v121
    v_cvt_pk_bf16_f32 v121, v122, v123
    v_cvt_pk_bf16_f32 v124, v124, v125
    v_cvt_pk_bf16_f32 v125, v126, v127
    ds_write_b64 v5, v[96:97]
    ds_write_b64 v6, v[100:101]
    ds_write_b64 v7, v[104:105]
    ds_write_b64 v62, v[108:109]
    ds_write_b64 v5, v[112:113] offset:128
    ds_write_b64 v6, v[116:117] offset:128
    ds_write_b64 v7, v[120:121] offset:128
    ds_write_b64 v62, v[124:125] offset:128
    ds_read_b128 v[96:99], v56
    ds_read_b128 v[104:107], v63 offset:1024
    ds_read_b128 v[112:115], v56 offset:2048
    ds_read_b128 v[120:123], v63 offset:3072
    s_waitcnt lgkmcnt(0)
    buffer_store_dwordx4 v[96:99], v58, s[24:27], s57 offen
    buffer_store_dwordx4 v[104:107], v58, s[24:27], s57 offen offset:1024
    buffer_store_dwordx4 v[112:115], v58, s[24:27], s57 offen offset:2048
    buffer_store_dwordx4 v[120:123], v58, s[24:27], s57 offen offset:3072
    s_add_u32 s57, s57, 4096
    v_accvgpr_read_b32 v3, a232
    v_rcp_f32 v2, v3
    s_nop 0
    v_pk_mul_f32 v[128:129], v[128:129], v[2:3] op_sel_hi:[1,0]
    v_pk_mul_f32 v[130:131], v[130:131], v[2:3] op_sel_hi:[1,0]
    v_pk_mul_f32 v[132:133], v[132:133], v[2:3] op_sel_hi:[1,0]
    v_pk_mul_f32 v[134:135], v[134:135], v[2:3] op_sel_hi:[1,0]
    v_pk_mul_f32 v[136:137], v[136:137], v[2:3] op_sel_hi:[1,0]
    v_pk_mul_f32 v[138:139], v[138:139], v[2:3] op_sel_hi:[1,0]
    v_pk_mul_f32 v[140:141], v[140:141], v[2:3] op_sel_hi:[1,0]
    v_pk_mul_f32 v[142:143], v[142:143], v[2:3] op_sel_hi:[1,0]
    v_pk_mul_f32 v[144:145], v[144:145], v[2:3] op_sel_hi:[1,0]
    v_pk_mul_f32 v[146:147], v[146:147], v[2:3] op_sel_hi:[1,0]
    v_pk_mul_f32 v[148:149], v[148:149], v[2:3] op_sel_hi:[1,0]
    v_pk_mul_f32 v[150:151], v[150:151], v[2:3] op_sel_hi:[1,0]
    v_pk_mul_f32 v[152:153], v[152:153], v[2:3] op_sel_hi:[1,0]
    v_pk_mul_f32 v[154:155], v[154:155], v[2:3] op_sel_hi:[1,0]
    v_pk_mul_f32 v[156:157], v[156:157], v[2:3] op_sel_hi:[1,0]
    v_pk_mul_f32 v[158:159], v[158:159], v[2:3] op_sel_hi:[1,0]
    v_cvt_pk_bf16_f32 v128, v128, v129
    v_cvt_pk_bf16_f32 v129, v130, v131
    v_cvt_pk_bf16_f32 v132, v132, v133
    v_cvt_pk_bf16_f32 v133, v134, v135
    v_cvt_pk_bf16_f32 v136, v136, v137
    v_cvt_pk_bf16_f32 v137, v138, v139
    v_cvt_pk_bf16_f32 v140, v140, v141
    v_cvt_pk_bf16_f32 v141, v142, v143
    v_cvt_pk_bf16_f32 v144, v144, v145
    v_cvt_pk_bf16_f32 v145, v146, v147
    v_cvt_pk_bf16_f32 v148, v148, v149
    v_cvt_pk_bf16_f32 v149, v150, v151
    v_cvt_pk_bf16_f32 v152, v152, v153
    v_cvt_pk_bf16_f32 v153, v154, v155
    v_cvt_pk_bf16_f32 v156, v156, v157
    v_cvt_pk_bf16_f32 v157, v158, v159
    ds_write_b64 v5, v[128:129]
    ds_write_b64 v6, v[132:133]
    ds_write_b64 v7, v[136:137]
    ds_write_b64 v62, v[140:141]
    ds_write_b64 v5, v[144:145] offset:128
    ds_write_b64 v6, v[148:149] offset:128
    ds_write_b64 v7, v[152:153] offset:128
    ds_write_b64 v62, v[156:157] offset:128
    ds_read_b128 v[128:131], v56
    ds_read_b128 v[136:139], v63 offset:1024
    ds_read_b128 v[144:147], v56 offset:2048
    ds_read_b128 v[152:155], v63 offset:3072
    s_waitcnt lgkmcnt(0)
    buffer_store_dwordx4 v[128:131], v58, s[24:27], s57 offen
    buffer_store_dwordx4 v[136:139], v58, s[24:27], s57 offen offset:1024
    buffer_store_dwordx4 v[144:147], v58, s[24:27], s57 offen offset:2048
    buffer_store_dwordx4 v[152:155], v58, s[24:27], s57 offen offset:3072
    s_add_u32 s57, s57, 4096
    v_accvgpr_read_b32 v3, a236
    v_rcp_f32 v2, v3
    s_nop 0
    v_pk_mul_f32 v[160:161], v[160:161], v[2:3] op_sel_hi:[1,0]
    v_pk_mul_f32 v[162:163], v[162:163], v[2:3] op_sel_hi:[1,0]
    v_pk_mul_f32 v[164:165], v[164:165], v[2:3] op_sel_hi:[1,0]
    v_pk_mul_f32 v[166:167], v[166:167], v[2:3] op_sel_hi:[1,0]
    v_pk_mul_f32 v[168:169], v[168:169], v[2:3] op_sel_hi:[1,0]
    v_pk_mul_f32 v[170:171], v[170:171], v[2:3] op_sel_hi:[1,0]
    v_pk_mul_f32 v[172:173], v[172:173], v[2:3] op_sel_hi:[1,0]
    v_pk_mul_f32 v[174:175], v[174:175], v[2:3] op_sel_hi:[1,0]
    v_pk_mul_f32 v[176:177], v[176:177], v[2:3] op_sel_hi:[1,0]
    v_pk_mul_f32 v[178:179], v[178:179], v[2:3] op_sel_hi:[1,0]
    v_pk_mul_f32 v[180:181], v[180:181], v[2:3] op_sel_hi:[1,0]
    v_pk_mul_f32 v[182:183], v[182:183], v[2:3] op_sel_hi:[1,0]
    v_pk_mul_f32 v[184:185], v[184:185], v[2:3] op_sel_hi:[1,0]
    v_pk_mul_f32 v[186:187], v[186:187], v[2:3] op_sel_hi:[1,0]
    v_pk_mul_f32 v[188:189], v[188:189], v[2:3] op_sel_hi:[1,0]
    v_pk_mul_f32 v[190:191], v[190:191], v[2:3] op_sel_hi:[1,0]
    v_cvt_pk_bf16_f32 v160, v160, v161
    v_cvt_pk_bf16_f32 v161, v162, v163
    v_cvt_pk_bf16_f32 v164, v164, v165
    v_cvt_pk_bf16_f32 v165, v166, v167
    v_cvt_pk_bf16_f32 v168, v168, v169
    v_cvt_pk_bf16_f32 v169, v170, v171
    v_cvt_pk_bf16_f32 v172, v172, v173
    v_cvt_pk_bf16_f32 v173, v174, v175
    v_cvt_pk_bf16_f32 v176, v176, v177
    v_cvt_pk_bf16_f32 v177, v178, v179
    v_cvt_pk_bf16_f32 v180, v180, v181
    v_cvt_pk_bf16_f32 v181, v182, v183
    v_cvt_pk_bf16_f32 v184, v184, v185
    v_cvt_pk_bf16_f32 v185, v186, v187
    v_cvt_pk_bf16_f32 v188, v188, v189
    v_cvt_pk_bf16_f32 v189, v190, v191
    ds_write_b64 v5, v[160:161]
    ds_write_b64 v6, v[164:165]
    ds_write_b64 v7, v[168:169]
    ds_write_b64 v62, v[172:173]
    ds_write_b64 v5, v[176:177] offset:128
    ds_write_b64 v6, v[180:181] offset:128
    ds_write_b64 v7, v[184:185] offset:128
    ds_write_b64 v62, v[188:189] offset:128
    ds_read_b128 v[160:163], v56
    ds_read_b128 v[168:171], v63 offset:1024
    ds_read_b128 v[176:179], v56 offset:2048
    ds_read_b128 v[184:187], v63 offset:3072
    s_waitcnt lgkmcnt(0)
    buffer_store_dwordx4 v[160:163], v58, s[24:27], s57 offen
    buffer_store_dwordx4 v[168:171], v58, s[24:27], s57 offen offset:1024
    buffer_store_dwordx4 v[176:179], v58, s[24:27], s57 offen offset:2048
    buffer_store_dwordx4 v[184:187], v58, s[24:27], s57 offen offset:3072
    s_add_u32 s57, s57, 4096
    v_accvgpr_read_b32 v3, a240
    v_rcp_f32 v2, v3
    s_nop 0
    v_pk_mul_f32 v[192:193], v[192:193], v[2:3] op_sel_hi:[1,0]
    v_pk_mul_f32 v[194:195], v[194:195], v[2:3] op_sel_hi:[1,0]
    v_pk_mul_f32 v[196:197], v[196:197], v[2:3] op_sel_hi:[1,0]
    v_pk_mul_f32 v[198:199], v[198:199], v[2:3] op_sel_hi:[1,0]
    v_pk_mul_f32 v[200:201], v[200:201], v[2:3] op_sel_hi:[1,0]
    v_pk_mul_f32 v[202:203], v[202:203], v[2:3] op_sel_hi:[1,0]
    v_pk_mul_f32 v[204:205], v[204:205], v[2:3] op_sel_hi:[1,0]
    v_pk_mul_f32 v[206:207], v[206:207], v[2:3] op_sel_hi:[1,0]
    v_pk_mul_f32 v[208:209], v[208:209], v[2:3] op_sel_hi:[1,0]
    v_pk_mul_f32 v[210:211], v[210:211], v[2:3] op_sel_hi:[1,0]
    v_pk_mul_f32 v[212:213], v[212:213], v[2:3] op_sel_hi:[1,0]
    v_pk_mul_f32 v[214:215], v[214:215], v[2:3] op_sel_hi:[1,0]
    v_pk_mul_f32 v[216:217], v[216:217], v[2:3] op_sel_hi:[1,0]
    v_pk_mul_f32 v[218:219], v[218:219], v[2:3] op_sel_hi:[1,0]
    v_pk_mul_f32 v[220:221], v[220:221], v[2:3] op_sel_hi:[1,0]
    v_pk_mul_f32 v[222:223], v[222:223], v[2:3] op_sel_hi:[1,0]
    v_cvt_pk_bf16_f32 v192, v192, v193
    v_cvt_pk_bf16_f32 v193, v194, v195
    v_cvt_pk_bf16_f32 v196, v196, v197
    v_cvt_pk_bf16_f32 v197, v198, v199
    v_cvt_pk_bf16_f32 v200, v200, v201
    v_cvt_pk_bf16_f32 v201, v202, v203
    v_cvt_pk_bf16_f32 v204, v204, v205
    v_cvt_pk_bf16_f32 v205, v206, v207
    v_cvt_pk_bf16_f32 v208, v208, v209
    v_cvt_pk_bf16_f32 v209, v210, v211
    v_cvt_pk_bf16_f32 v212, v212, v213
    v_cvt_pk_bf16_f32 v213, v214, v215
    v_cvt_pk_bf16_f32 v216, v216, v217
    v_cvt_pk_bf16_f32 v217, v218, v219
    v_cvt_pk_bf16_f32 v220, v220, v221
    v_cvt_pk_bf16_f32 v221, v222, v223
    ds_write_b64 v5, v[192:193]
    ds_write_b64 v6, v[196:197]
    ds_write_b64 v7, v[200:201]
    ds_write_b64 v62, v[204:205]
    ds_write_b64 v5, v[208:209] offset:128
    ds_write_b64 v6, v[212:213] offset:128
    ds_write_b64 v7, v[216:217] offset:128
    ds_write_b64 v62, v[220:221] offset:128
    ds_read_b128 v[192:195], v56
    ds_read_b128 v[200:203], v63 offset:1024
    ds_read_b128 v[208:211], v56 offset:2048
    ds_read_b128 v[216:219], v63 offset:3072
    s_waitcnt lgkmcnt(0)
    buffer_store_dwordx4 v[192:195], v58, s[24:27], s57 offen
    buffer_store_dwordx4 v[200:203], v58, s[24:27], s57 offen offset:1024
    buffer_store_dwordx4 v[208:211], v58, s[24:27], s57 offen offset:2048
    buffer_store_dwordx4 v[216:219], v58, s[24:27], s57 offen offset:3072
    s_add_u32 s57, s57, 4096
    v_accvgpr_read_b32 v3, a244
    v_rcp_f32 v2, v3
    s_nop 0
    v_pk_mul_f32 v[224:225], v[224:225], v[2:3] op_sel_hi:[1,0]
    v_pk_mul_f32 v[226:227], v[226:227], v[2:3] op_sel_hi:[1,0]
    v_pk_mul_f32 v[228:229], v[228:229], v[2:3] op_sel_hi:[1,0]
    v_pk_mul_f32 v[230:231], v[230:231], v[2:3] op_sel_hi:[1,0]
    v_pk_mul_f32 v[232:233], v[232:233], v[2:3] op_sel_hi:[1,0]
    v_pk_mul_f32 v[234:235], v[234:235], v[2:3] op_sel_hi:[1,0]
    v_pk_mul_f32 v[236:237], v[236:237], v[2:3] op_sel_hi:[1,0]
    v_pk_mul_f32 v[238:239], v[238:239], v[2:3] op_sel_hi:[1,0]
    v_pk_mul_f32 v[240:241], v[240:241], v[2:3] op_sel_hi:[1,0]
    v_pk_mul_f32 v[242:243], v[242:243], v[2:3] op_sel_hi:[1,0]
    v_pk_mul_f32 v[244:245], v[244:245], v[2:3] op_sel_hi:[1,0]
    v_pk_mul_f32 v[246:247], v[246:247], v[2:3] op_sel_hi:[1,0]
    v_pk_mul_f32 v[248:249], v[248:249], v[2:3] op_sel_hi:[1,0]
    v_pk_mul_f32 v[250:251], v[250:251], v[2:3] op_sel_hi:[1,0]
    v_pk_mul_f32 v[252:253], v[252:253], v[2:3] op_sel_hi:[1,0]
    v_pk_mul_f32 v[254:255], v[254:255], v[2:3] op_sel_hi:[1,0]
    v_cvt_pk_bf16_f32 v224, v224, v225
    v_cvt_pk_bf16_f32 v225, v226, v227
    v_cvt_pk_bf16_f32 v228, v228, v229
    v_cvt_pk_bf16_f32 v229, v230, v231
    v_cvt_pk_bf16_f32 v232, v232, v233
    v_cvt_pk_bf16_f32 v233, v234, v235
    v_cvt_pk_bf16_f32 v236, v236, v237
    v_cvt_pk_bf16_f32 v237, v238, v239
    v_cvt_pk_bf16_f32 v240, v240, v241
    v_cvt_pk_bf16_f32 v241, v242, v243
    v_cvt_pk_bf16_f32 v244, v244, v245
    v_cvt_pk_bf16_f32 v245, v246, v247
    v_cvt_pk_bf16_f32 v248, v248, v249
    v_cvt_pk_bf16_f32 v249, v250, v251
    v_cvt_pk_bf16_f32 v252, v252, v253
    v_cvt_pk_bf16_f32 v253, v254, v255
    ds_write_b64 v5, v[224:225]
    ds_write_b64 v6, v[228:229]
    ds_write_b64 v7, v[232:233]
    ds_write_b64 v62, v[236:237]
    ds_write_b64 v5, v[240:241] offset:128
    ds_write_b64 v6, v[244:245] offset:128
    ds_write_b64 v7, v[248:249] offset:128
    ds_write_b64 v62, v[252:253] offset:128
    ds_read_b128 v[224:227], v56
    ds_read_b128 v[232:235], v63 offset:1024
    ds_read_b128 v[240:243], v56 offset:2048
    ds_read_b128 v[248:251], v63 offset:3072
    s_waitcnt lgkmcnt(0)
    buffer_store_dwordx4 v[224:227], v58, s[24:27], s57 offen
    buffer_store_dwordx4 v[232:235], v58, s[24:27], s57 offen offset:1024
    buffer_store_dwordx4 v[240:243], v58, s[24:27], s57 offen offset:2048
    buffer_store_dwordx4 v[248:251], v58, s[24:27], s57 offen offset:3072
    s_add_u32 s57, s57, 4096
    s_branch Lslow_ret
.section .rodata,"a"
.p2align 6
.amdhsa_kernel standalone__gqa_softmax__near_ridge_kernel
  .amdhsa_next_free_vgpr 512
  .amdhsa_next_free_sgpr 102
  .amdhsa_accum_offset 256
  .amdhsa_group_segment_fixed_size 0
  .amdhsa_kernarg_size 48
  .amdhsa_user_sgpr_count 2
  .amdhsa_user_sgpr_kernarg_segment_ptr 1
  .amdhsa_system_sgpr_workgroup_id_x 1
  .amdhsa_float_denorm_mode_32 3
.end_amdhsa_kernel
```
